```python
import torch

def _softmax(x, axis=-1):
    return torch.softmax(x, dim=axis)
def _gelu(x):
    return torch.nn.functional.gelu(x, approximate="tanh")
def _silu(x):
    return torch.nn.functional.silu(x)
def _sigmoid(x):
    return torch.sigmoid(x)
def _layernorm(x, axis=-1, eps=1e-5):
    m = x.mean(dim=axis, keepdim=True)
    v = x.var(dim=axis, keepdim=True, unbiased=False)
    return (x - m) / torch.sqrt(v + eps)
def _scatter_add(tgt, idx, src, axis=0):
    return tgt.clone().index_add_(axis, idx, src)
def _segment_sum(src, seg, n):
    out = torch.zeros((n,) + src.shape[1:], dtype=src.dtype)
    return out.index_add_(0, seg, src)
def _pad(x, pw):
    flat = tuple(v for pair in reversed(pw) for v in pair)
    return torch.nn.functional.pad(x, flat)

kernel_name = 'standalone__gqa_block_cached__near_ridge'

def setup_inputs():

    _w = (lambda a: (lambda t: t.to(torch.bfloat16) if t.is_floating_point() else t)(torch.as_tensor(a)))
    B, Sq, D = 8, 144, 448
    Hq, Hkv, Sk, Dh = 16, 8, 1024, 256
    assert Hq % Hkv == 0, (Hq, Hkv)
    return {
        "x": _w((lambda *s: torch.randn(*s, dtype=torch.bfloat16) * 0.8)(B, Sq, D)),
        "k_cache": _w((lambda *s: torch.randn(*s, dtype=torch.bfloat16) * 0.8)(B, Hkv, Sk, Dh)),
        "v_cache": _w((lambda *s: torch.randn(*s, dtype=torch.bfloat16) * 0.05)(B, Hkv, Sk, Dh)),
        "wq": _w((lambda *s: torch.randn(*s, dtype=torch.bfloat16) * 0.8)(D, Hq * Dh) * (D ** -0.5)),
        "wo": _w((lambda *s: torch.randn(*s, dtype=torch.bfloat16) * 0.05)(Hq * Dh, D) * ((Hq * Dh) ** -0.5)),
    }

def reference(x, k_cache, v_cache, wq, wo):
    B, Sq, D = x.shape
    Hq, Dh = 16, 256
    Hkv = k_cache.shape[1]
    rep = Hq // Hkv
    q = (lambda x, *d: x.permute(*d))((x @ wq).reshape(B, Sq, Hq, Dh), 0, 2, 1, 3)
    k = (lambda x, n, axis: torch.repeat_interleave(x, n, dim=axis))(k_cache, rep, axis=1)
    v = (lambda x, n, axis: torch.repeat_interleave(x, n, dim=axis))(v_cache, rep, axis=1)
    scores = torch.einsum("bhqd,bhkd->bhqk", q, k) * (Dh ** -0.5)
    p = _softmax(scores, axis=-1)
    o = torch.einsum("bhqk,bhkd->bhqd", p, v)
    return (lambda x, *d: x.permute(*d))(o, 0, 2, 1, 3).reshape(B, Sq, Hq * Dh) @ wo
```

```asm
; @launch kernel=gqa_main_kernel grid=(256,1,1) block=(256,1,1) lds=163840
; @launch kernel=gqa_reduce_kernel grid=(320,1,1) block=(256,1,1) lds=0
.amdgcn_target "amdgcn-amd-amdhsa--gfx950"
.text
.globl gqa_main_kernel
.p2align 8
.type gqa_main_kernel,@function
gqa_main_kernel:
    s_cmp_ge_u32 s2, 256
    s_cbranch_scc1 L_main_done
    s_load_dwordx4 s[52:55], s[0:1], 0
    s_load_dwordx4 s[56:59], s[0:1], 16
    s_load_dwordx2 s[60:61], s[0:1], 32
    s_load_dwordx2 s[62:63], s[0:1], 56
    v_lshrrev_b32 v1, 6, v0
    v_and_b32 v2, 63, v0
    v_readfirstlane_b32 s28, v1
    v_and_b32 v3, 15, v2
    v_lshrrev_b32 v4, 4, v2
    s_and_b32 s64, s2, 7
    s_lshr_b32 s65, s2, 3
    s_lshr_b32 s66, s65, 2
    s_and_b32 s67, s65, 3
    s_lshr_b32 s68, s67, 1
    s_lshl_b32 s69, s64, 1
    s_add_u32 s50, s69, s68
    s_and_b32 s68, s67, 1
    s_mul_i32 s69, s66, 144
    s_mul_i32 s70, s68, 72
    s_add_u32 s51, s69, s70
    s_lshl_b32 s71, s66, 3
    s_add_u32 s71, s71, s64
    s_lshl_b32 s71, s71, 19
    s_mul_i32 s72, s50, 229376
    s_mul_i32 s73, s50, 1146880
    s_lshl_b32 s75, s66, 1
    s_add_u32 s75, s75, s68
    s_mul_i32 s75, s75, 71680
    s_add_u32 s73, s73, s75
    s_mul_i32 s29, s28, 25344
    s_add_u32 s29, s29, 62464
    s_mov_b32 s30, 0x3db8aa3b
    s_mov_b32 s46, 0x00ff00ff
    s_mov_b32 s47, 0x00ff00ff
    v_lshrrev_b32 v5, 1, v4
    v_lshlrev_b32 v5, 4, v5
    v_and_b32 v9, 1, v4
    v_lshl_add_u32 v5, v9, 2, v5
    v_bfe_u32 v9, v2, 3, 1
    v_add_u32 v5, v5, v9
    v_and_b32 v10, 7, v2
    v_lshlrev_b32 v7, 4, v10
    v_bfe_u32 v11, v2, 4, 1
    v_mul_u32_u24 v12, 12, v11
    v_lshl_add_u32 v13, v11, 2, 4
    v_cmp_eq_u32 vcc, 1, v9
    s_nop 1
    v_cndmask_b32 v12, v12, v13, vcc
    v_lshrrev_b32 v13, 5, v2
    v_lshl_add_u32 v6, v13, 4, v12
    v_xor_b32 v10, v10, v11
    v_lshlrev_b32 v8, 4, v10
    v_and_b32 v9, 1, v4
    v_lshlrev_b32 v9, 1, v9
    v_lshrrev_b32 v10, 3, v3
    v_add_u32 v9, v9, v10
    v_mul_u32_u24 v9, 1056, v9
    v_lshrrev_b32 v10, 1, v4
    v_lshl_add_u32 v9, v10, 9, v9
    v_bfe_u32 v10, v3, 2, 1
    v_lshl_add_u32 v9, v10, 7, v9
    v_and_b32 v10, 3, v3
    v_lshl_add_u32 v9, v10, 3, v9
    v_add_u32 v237, s29, v9
    v_lshrrev_b32 v9, 3, v3
    v_lshrrev_b32 v10, 2, v3
    v_xor_b32 v10, v10, v9
    v_and_b32 v10, 1, v10
    v_xor_b32 v11, v4, v9
    v_lshlrev_b32 v11, 4, v11
    v_lshl_add_u32 v11, v10, 7, v11
    v_lshl_add_u32 v13, v9, 8, v11
    v_and_b32 v12, 3, v3
    v_mul_u32_u24 v14, 1056, v12
    v_add_u32 v14, v14, v13
    v_mul_u32_u24 v15, 288, v12
    v_add_u32 v15, v15, v11
    v_add_u32 v232, s29, v14
    v_add_u32 v216, 0, v14
    v_add_u32 v217, 38400, v14
    v_add_u32 v218, 8448, v15
    v_add_u32 v219, 46848, v15
    v_lshlrev_b32 v9, 8, v3
    s_mov_b32 s74, 0
    v_add_u32 v10, s74, v4
    v_xor_b32 v10, v10, v3
    v_lshl_add_u32 v238, v10, 4, v9
    s_mov_b32 s74, 4
    v_add_u32 v10, s74, v4
    v_xor_b32 v10, v10, v3
    v_lshl_add_u32 v239, v10, 4, v9
    s_mov_b32 s74, 8
    v_add_u32 v10, s74, v4
    v_xor_b32 v10, v10, v3
    v_lshl_add_u32 v240, v10, 4, v9
    s_mov_b32 s74, 12
    v_add_u32 v10, s74, v4
    v_xor_b32 v10, v10, v3
    v_lshl_add_u32 v241, v10, 4, v9
    s_lshl_b32 s74, s28, 2
    v_lshrrev_b32 v11, 1, v4
    v_add_u32 v11, s74, v11
    v_and_b32 v12, 1, v4
    v_lshl_add_u32 v12, v12, 3, v9
    v_add_u32 v10, 0, v11
    v_xor_b32 v10, v10, v3
    v_lshl_add_u32 v242, v10, 4, v12
    v_add_u32 v10, 2, v11
    v_xor_b32 v10, v10, v3
    v_lshl_add_u32 v243, v10, 4, v12
    s_add_u32 s74, s51, s28
    v_add_u32 v9, s74, v6
    v_mul_u32_u24 v9, 896, v9
    v_add_u32 v220, v9, v8
    v_lshlrev_b32 v221, 7, v2
    s_lshl_b32 s74, s67, 2
    s_add_u32 s74, s74, s28
    s_and_b32 s75, s74, 7
    s_lshl_b32 s75, s75, 13
    v_add_u32 v221, s75, v221
    v_mov_b32 v254, v221
    s_lshr_b32 s84, s74, 3
    s_mov_b32 s85, 0
    s_add_u32 s74, s85, 0
    s_and_b32 s74, s74, 3
    s_lshl_b32 s92, s74, 7
    s_lshl_b32 s96, s74, 14
    s_add_u32 s74, s85, 1
    s_and_b32 s74, s74, 3
    s_lshl_b32 s93, s74, 7
    s_lshl_b32 s97, s74, 14
    s_add_u32 s74, s85, 2
    s_and_b32 s74, s74, 3
    s_lshl_b32 s94, s74, 7
    s_lshl_b32 s98, s74, 14
    s_add_u32 s74, s85, 3
    s_and_b32 s74, s74, 3
    s_lshl_b32 s95, s74, 7
    s_lshl_b32 s99, s74, 14
    s_waitcnt lgkmcnt(0)
    s_mov_b32 s4, s52
    s_mov_b32 s5, s53
    s_mov_b32 s6, 1032192
    s_mov_b32 s7, 0x00020000
    s_add_u32 s12, s54, s71
    s_addc_u32 s13, s55, 0
    s_sub_u32 s12, s12, 2048
    s_subb_u32 s13, s13, 0
    s_mov_b32 s14, 526336
    s_mov_b32 s15, 0x00020000
    s_add_u32 s16, s56, s71
    s_addc_u32 s17, s57, 0
    s_sub_u32 s16, s16, 128
    s_subb_u32 s17, s17, 0
    s_mov_b32 s18, 524416
    s_mov_b32 s19, 0x00020000
    s_mov_b32 s8, s58
    s_mov_b32 s9, s59
    s_sub_u32 s8, s8, 128
    s_subb_u32 s9, s9, 0
    s_mov_b32 s10, 3670144
    s_mov_b32 s11, 0x00020000
    s_add_u32 s20, s60, s72
    s_addc_u32 s21, s61, 0
    s_sub_u32 s20, s20, 128
    s_subb_u32 s21, s21, 0
    s_mov_b32 s22, 229504
    s_mov_b32 s23, 0x00020000
    s_add_u32 s24, s62, s73
    s_addc_u32 s25, s63, 0
    s_mov_b32 s26, 71680
    s_mov_b32 s27, 0x00020000
    s_cmp_eq_u32 s84, 0
    s_cselect_b32 s86, s54, s56
    s_cselect_b32 s87, s55, s57
    s_add_u32 s88, s86, s71
    s_addc_u32 s89, s87, 0
    s_mov_b32 s90, 524288
    s_mov_b32 s91, 0x00020000
    v_mov_b32 v1, 0xff800000
    v_accvgpr_write_b32 a192, v1
    v_accvgpr_write_b32 a193, v1
    v_accvgpr_write_b32 a194, v1
    v_accvgpr_write_b32 a195, v1
    v_accvgpr_write_b32 a196, v1
    s_mov_b32 s87, 0
    s_mul_i32 s86, s67, 0
    s_mov_b64 s[100:101], 0
    s_mov_b32 s32, 8192
    v_mad_u32_u24 v233, v5, s32, v7
    s_lshl_b32 s33, s50, 9
    s_lshl_b32 s34, s28, 7
    s_add_u32 s33, s33, s34
    v_add_u32 v233, s33, v233
    v_add_u32 v234, 15456, v233
    v_add_u32 v235, 63552, v233
    v_add_u32 v236, 78880, v233
    v_add_u32 v233, 128, v233
    s_mov_b32 s35, 512
    v_mad_u32_u24 v9, v6, s35, v8
    s_lshl_b32 s36, s28, 14
    v_add_u32 v9, s36, v9
    v_add_u32 v10, 1504, v9
    v_add_u32 v11, 960, v9
    v_add_u32 v12, 416, v9
    v_add_u32 v9, 2048, v9
    s_mul_i32 s37, s28, 1056
    s_add_u32 m0, s37, 0
    s_mov_b32 s38, 0
    buffer_load_dwordx4 v220, s[4:7], s38 offen lds
    s_mul_i32 s39, s28, 1056
    s_add_u32 m0, s39, 4224
    s_mov_b32 s32, 28672
    buffer_load_dwordx4 v220, s[4:7], s32 offen lds
    s_mul_i32 s33, s28, 288
    s_add_u32 m0, s33, 8448
    s_mov_b32 s34, 57344
    s_mov_b64 exec, 0xffff
    buffer_load_dwordx4 v220, s[4:7], s34 offen lds
    s_mov_b64 exec, -1
    s_add_u32 m0, s29, 8448
    s_mov_b32 s35, 0
    buffer_load_dwordx4 v233, s[8:11], s35 offen lds
    buffer_load_dwordx4 v234, s[8:11], s35 offen offset:1056 lds
    buffer_load_dwordx4 v235, s[8:11], s35 offen offset:2112 lds
    buffer_load_dwordx4 v236, s[8:11], s35 offen offset:3168 lds
    s_mul_i32 s36, s28, 1056
    s_add_u32 m0, s36, 9600
    s_mov_b32 s37, 128
    buffer_load_dwordx4 v220, s[4:7], s37 offen lds
    s_mul_i32 s38, s28, 1056
    s_add_u32 m0, s38, 13824
    s_mov_b32 s39, 28800
    buffer_load_dwordx4 v220, s[4:7], s39 offen lds
    s_mul_i32 s32, s28, 288
    s_add_u32 m0, s32, 18048
    s_mov_b32 s33, 57472
    s_mov_b64 exec, 0xffff
    buffer_load_dwordx4 v220, s[4:7], s33 offen lds
    s_mov_b64 exec, -1
    s_add_u32 m0, s29, 12672
    s_mov_b32 s34, 262144
    buffer_load_dwordx4 v233, s[8:11], s34 offen lds
    buffer_load_dwordx4 v234, s[8:11], s34 offen offset:1056 lds
    buffer_load_dwordx4 v235, s[8:11], s34 offen offset:2112 lds
    buffer_load_dwordx4 v236, s[8:11], s34 offen offset:3168 lds
    s_mul_i32 s35, s28, 1056
    s_add_u32 m0, s35, 19200
    s_mov_b32 s36, 256
    buffer_load_dwordx4 v220, s[4:7], s36 offen lds
    s_mul_i32 s37, s28, 1056
    s_add_u32 m0, s37, 23424
    s_mov_b32 s38, 28928
    buffer_load_dwordx4 v220, s[4:7], s38 offen lds
    s_mul_i32 s39, s28, 288
    s_add_u32 m0, s39, 27648
    s_mov_b32 s32, 57600
    s_mov_b64 exec, 0xffff
    buffer_load_dwordx4 v220, s[4:7], s32 offen lds
    s_mov_b64 exec, -1
    s_add_u32 m0, s29, 16896
    s_mov_b32 s33, 524288
    buffer_load_dwordx4 v233, s[8:11], s33 offen lds
    buffer_load_dwordx4 v234, s[8:11], s33 offen offset:1056 lds
    buffer_load_dwordx4 v235, s[8:11], s33 offen offset:2112 lds
    buffer_load_dwordx4 v236, s[8:11], s33 offen offset:3168 lds
    s_mul_i32 s34, s28, 1056
    s_add_u32 m0, s34, 28800
    s_mov_b32 s35, 384
    buffer_load_dwordx4 v220, s[4:7], s35 offen lds
    s_mul_i32 s36, s28, 1056
    s_add_u32 m0, s36, 33024
    s_mov_b32 s37, 29056
    buffer_load_dwordx4 v220, s[4:7], s37 offen lds
    s_mul_i32 s38, s28, 288
    s_add_u32 m0, s38, 37248
    s_mov_b32 s39, 57728
    s_mov_b64 exec, 0xffff
    buffer_load_dwordx4 v220, s[4:7], s39 offen lds
    s_mov_b64 exec, -1
    s_add_u32 m0, s29, 21120
    s_mov_b32 s32, 786432
    buffer_load_dwordx4 v233, s[8:11], s32 offen lds
    buffer_load_dwordx4 v234, s[8:11], s32 offen offset:1056 lds
    buffer_load_dwordx4 v235, s[8:11], s32 offen offset:2112 lds
    buffer_load_dwordx4 v236, s[8:11], s32 offen offset:3168 lds
    s_mul_i32 s33, s28, 1056
    s_add_u32 m0, s33, 38400
    s_mov_b32 s34, 512
    buffer_load_dwordx4 v220, s[4:7], s34 offen lds
    s_mul_i32 s35, s28, 1056
    s_add_u32 m0, s35, 42624
    s_mov_b32 s36, 29184
    buffer_load_dwordx4 v220, s[4:7], s36 offen lds
    s_mul_i32 s37, s28, 288
    s_add_u32 m0, s37, 46848
    s_mov_b32 s38, 57856
    s_mov_b64 exec, 0xffff
    buffer_load_dwordx4 v220, s[4:7], s38 offen lds
    s_mov_b64 exec, -1
    s_mul_i32 s39, s28, 1056
    s_add_u32 m0, s39, 48000
    s_mov_b32 s32, 640
    buffer_load_dwordx4 v220, s[4:7], s32 offen lds
    s_mul_i32 s33, s28, 1056
    s_add_u32 m0, s33, 52224
    s_mov_b32 s34, 29312
    buffer_load_dwordx4 v220, s[4:7], s34 offen lds
    s_mul_i32 s35, s28, 288
    s_add_u32 m0, s35, 56448
    s_mov_b32 s36, 57984
    s_mov_b64 exec, 0xffff
    buffer_load_dwordx4 v220, s[4:7], s36 offen lds
    s_mov_b64 exec, -1
    s_mul_i32 s37, s28, 1056
    s_add_u32 m0, s37, 57600
    s_mov_b32 s38, 768
    buffer_load_dwordx4 v220, s[4:7], s38 offen lds
    s_mul_i32 s39, s28, 1056
    s_add_u32 m0, s39, 61824
    s_mov_b32 s32, 29440
    buffer_load_dwordx4 v220, s[4:7], s32 offen lds
    s_mul_i32 s33, s28, 288
    s_add_u32 m0, s33, 66048
    s_mov_b32 s34, 58112
    s_mov_b64 exec, 0xffff
    buffer_load_dwordx4 v220, s[4:7], s34 offen lds
    s_mov_b64 exec, -1
    s_lshl_b32 s74, s66, 1
    s_add_u32 s74, s74, s68
    s_lshl_b32 s74, s74, 2
    s_add_u32 s74, s74, s28
    v_and_b32 v1, 63, v0
    v_min_u32 v1, 27, v1
    s_mul_i32 s75, s74, 7
    v_lshrrev_b32 v2, 2, v1
    v_add_u32 v2, s75, v2
    v_lshlrev_b32 v2, 13, v2
    v_and_b32 v13, 3, v1
    v_lshl_add_u32 v2, v13, 7, v2
    s_lshl_b32 s75, s50, 9
    s_add_u32 s75, s75, 128
    buffer_load_dword v255, v2, s[8:11], s75 offen
    s_waitcnt vmcnt(1)
    s_barrier
    ds_read_b64_tr_b16 a[224:225], v237 offset:8448
    ds_read_b64_tr_b16 a[226:227], v237 offset:8704
    ds_read_b128 v[176:179], v216 offset:0
    ds_read_b128 v[180:183], v216 offset:512
    ds_read_b128 v[184:187], v216 offset:4224
    ds_read_b128 v[188:191], v216 offset:4736
    ds_read_b128 v[192:195], v218 offset:0
    ds_read_b64_tr_b16 a[228:229], v237 offset:8480
    ds_read_b64_tr_b16 a[230:231], v237 offset:8736
    ds_read_b64_tr_b16 a[232:233], v237 offset:8512
    ds_read_b64_tr_b16 a[234:235], v237 offset:8768
    ds_read_b64_tr_b16 a[236:237], v237 offset:8544
    ds_read_b64_tr_b16 a[238:239], v237 offset:8800
    s_waitcnt lgkmcnt(10)
    v_mfma_f32_16x16x32_bf16 v[16:19], a[224:227], v[176:179], 0
    ds_read_b64_tr_b16 a[240:241], v237 offset:12672
    ds_read_b64_tr_b16 a[242:243], v237 offset:12928
    ds_read_b128 v[196:199], v216 offset:64
    s_waitcnt lgkmcnt(12)
    v_mfma_f32_16x16x32_bf16 v[20:23], a[224:227], v[180:183], 0
    ds_read_b128 v[200:203], v216 offset:576
    ds_read_b128 v[204:207], v216 offset:4288
    ds_read_b128 v[208:211], v216 offset:4800
    s_waitcnt lgkmcnt(14)
    v_mfma_f32_16x16x32_bf16 v[24:27], a[224:227], v[184:187], 0
    ds_read_b128 v[212:215], v218 offset:64
    ds_read_b64_tr_b16 a[244:245], v237 offset:12704
    ds_read_b64_tr_b16 a[246:247], v237 offset:12960
    s_waitcnt lgkmcnt(15)
    v_mfma_f32_16x16x32_bf16 v[28:31], a[224:227], v[188:191], 0
    ds_read_b64_tr_b16 a[248:249], v237 offset:12736
    ds_read_b64_tr_b16 a[250:251], v237 offset:12992
    ds_read_b64_tr_b16 a[252:253], v237 offset:12768
    v_mfma_f32_16x16x32_bf16 v[32:35], a[224:227], v[192:195], 0
    ds_read_b64_tr_b16 a[254:255], v237 offset:13024
    s_add_u32 m0, s29, 8448
    s_mov_b32 s35, 1048576
    s_waitcnt lgkmcnt(15)
    v_mfma_f32_16x16x32_bf16 v[36:39], a[228:231], v[176:179], 0
    s_waitcnt lgkmcnt(13)
    buffer_load_dwordx4 v233, s[8:11], s35 offen lds
    buffer_load_dwordx4 v234, s[8:11], s35 offen offset:1056 lds
    v_mfma_f32_16x16x32_bf16 v[40:43], a[228:231], v[180:183], 0
    v_mfma_f32_16x16x32_bf16 v[44:47], a[228:231], v[184:187], 0
    v_mfma_f32_16x16x32_bf16 v[48:51], a[228:231], v[188:191], 0
    buffer_load_dwordx4 v235, s[8:11], s35 offen offset:2112 lds
    v_mfma_f32_16x16x32_bf16 v[52:55], a[228:231], v[192:195], 0
    v_mfma_f32_16x16x32_bf16 v[56:59], a[232:235], v[176:179], 0
    v_mfma_f32_16x16x32_bf16 v[60:63], a[232:235], v[180:183], 0
    buffer_load_dwordx4 v236, s[8:11], s35 offen offset:3168 lds
    s_add_u32 m0, s29, 12672
    s_mov_b32 s36, 1310720
    v_mfma_f32_16x16x32_bf16 v[64:67], a[232:235], v[184:187], 0
    s_waitcnt lgkmcnt(0)
    buffer_load_dwordx4 v233, s[8:11], s36 offen lds
    buffer_load_dwordx4 v234, s[8:11], s36 offen offset:1056 lds
    v_mfma_f32_16x16x32_bf16 v[68:71], a[232:235], v[188:191], 0
    v_mfma_f32_16x16x32_bf16 v[72:75], a[232:235], v[192:195], 0
    v_mfma_f32_16x16x32_bf16 v[76:79], a[236:239], v[176:179], 0
    buffer_load_dwordx4 v235, s[8:11], s36 offen offset:2112 lds
    v_mfma_f32_16x16x32_bf16 v[80:83], a[236:239], v[180:183], 0
    v_mfma_f32_16x16x32_bf16 v[84:87], a[236:239], v[184:187], 0
    v_mfma_f32_16x16x32_bf16 v[88:91], a[236:239], v[188:191], 0
    buffer_load_dwordx4 v236, s[8:11], s36 offen offset:3168 lds
    v_mfma_f32_16x16x32_bf16 v[92:95], a[236:239], v[192:195], 0
    v_mfma_f32_16x16x32_bf16 v[16:19], a[240:243], v[196:199], v[16:19]
    ds_read_b64_tr_b16 a[224:225], v237 offset:16896
    ds_read_b64_tr_b16 a[226:227], v237 offset:17152
    ds_read_b128 v[176:179], v216 offset:9600
    v_mfma_f32_16x16x32_bf16 v[20:23], a[240:243], v[200:203], v[20:23]
    ds_read_b128 v[180:183], v216 offset:10112
    ds_read_b128 v[184:187], v216 offset:13824
    ds_read_b128 v[188:191], v216 offset:14336
    v_mfma_f32_16x16x32_bf16 v[24:27], a[240:243], v[204:207], v[24:27]
    ds_read_b128 v[192:195], v218 offset:9600
    ds_read_b64_tr_b16 a[228:229], v237 offset:16928
    ds_read_b64_tr_b16 a[230:231], v237 offset:17184
    v_mfma_f32_16x16x32_bf16 v[28:31], a[240:243], v[208:211], v[28:31]
    ds_read_b64_tr_b16 a[232:233], v237 offset:16960
    ds_read_b64_tr_b16 a[234:235], v237 offset:17216
    ds_read_b64_tr_b16 a[236:237], v237 offset:16992
    v_mfma_f32_16x16x32_bf16 v[32:35], a[240:243], v[212:215], v[32:35]
    ds_read_b64_tr_b16 a[238:239], v237 offset:17248
    v_mfma_f32_16x16x32_bf16 v[36:39], a[244:247], v[196:199], v[36:39]
    v_mfma_f32_16x16x32_bf16 v[40:43], a[244:247], v[200:203], v[40:43]
    v_mfma_f32_16x16x32_bf16 v[44:47], a[244:247], v[204:207], v[44:47]
    v_mfma_f32_16x16x32_bf16 v[48:51], a[244:247], v[208:211], v[48:51]
    v_mfma_f32_16x16x32_bf16 v[52:55], a[244:247], v[212:215], v[52:55]
    s_add_u32 m0, s29, 16896
    s_mov_b32 s37, 1572864
    s_waitcnt lgkmcnt(0)
    buffer_load_dwordx4 v233, s[8:11], s37 offen lds
    v_mfma_f32_16x16x32_bf16 v[56:59], a[248:251], v[196:199], v[56:59]
    v_mfma_f32_16x16x32_bf16 v[60:63], a[248:251], v[200:203], v[60:63]
    v_mfma_f32_16x16x32_bf16 v[64:67], a[248:251], v[204:207], v[64:67]
    buffer_load_dwordx4 v234, s[8:11], s37 offen offset:1056 lds
    v_mfma_f32_16x16x32_bf16 v[68:71], a[248:251], v[208:211], v[68:71]
    v_mfma_f32_16x16x32_bf16 v[72:75], a[248:251], v[212:215], v[72:75]
    v_mfma_f32_16x16x32_bf16 v[76:79], a[252:255], v[196:199], v[76:79]
    buffer_load_dwordx4 v235, s[8:11], s37 offen offset:2112 lds
    v_mfma_f32_16x16x32_bf16 v[80:83], a[252:255], v[200:203], v[80:83]
    v_mfma_f32_16x16x32_bf16 v[84:87], a[252:255], v[204:207], v[84:87]
    v_mfma_f32_16x16x32_bf16 v[88:91], a[252:255], v[208:211], v[88:91]
    buffer_load_dwordx4 v236, s[8:11], s37 offen offset:3168 lds
    v_mfma_f32_16x16x32_bf16 v[92:95], a[252:255], v[212:215], v[92:95]
    v_mfma_f32_16x16x32_bf16 v[16:19], a[224:227], v[176:179], v[16:19]
    ds_read_b64_tr_b16 a[240:241], v237 offset:21120
    ds_read_b64_tr_b16 a[242:243], v237 offset:21376
    ds_read_b128 v[196:199], v216 offset:9664
    v_mfma_f32_16x16x32_bf16 v[20:23], a[224:227], v[180:183], v[20:23]
    ds_read_b128 v[200:203], v216 offset:10176
    ds_read_b128 v[204:207], v216 offset:13888
    ds_read_b128 v[208:211], v216 offset:14400
    v_mfma_f32_16x16x32_bf16 v[24:27], a[224:227], v[184:187], v[24:27]
    ds_read_b128 v[212:215], v218 offset:9664
    ds_read_b64_tr_b16 a[244:245], v237 offset:21152
    ds_read_b64_tr_b16 a[246:247], v237 offset:21408
    v_mfma_f32_16x16x32_bf16 v[28:31], a[224:227], v[188:191], v[28:31]
    ds_read_b64_tr_b16 a[248:249], v237 offset:21184
    ds_read_b64_tr_b16 a[250:251], v237 offset:21440
    ds_read_b64_tr_b16 a[252:253], v237 offset:21216
    v_mfma_f32_16x16x32_bf16 v[32:35], a[224:227], v[192:195], v[32:35]
    ds_read_b64_tr_b16 a[254:255], v237 offset:21472
    v_mfma_f32_16x16x32_bf16 v[36:39], a[228:231], v[176:179], v[36:39]
    v_mfma_f32_16x16x32_bf16 v[40:43], a[228:231], v[180:183], v[40:43]
    v_mfma_f32_16x16x32_bf16 v[44:47], a[228:231], v[184:187], v[44:47]
    v_mfma_f32_16x16x32_bf16 v[48:51], a[228:231], v[188:191], v[48:51]
    v_mfma_f32_16x16x32_bf16 v[52:55], a[228:231], v[192:195], v[52:55]
    s_add_u32 m0, s29, 21120
    s_mov_b32 s38, 1835008
    s_waitcnt lgkmcnt(0)
    buffer_load_dwordx4 v233, s[8:11], s38 offen lds
    v_mfma_f32_16x16x32_bf16 v[56:59], a[232:235], v[176:179], v[56:59]
    v_mfma_f32_16x16x32_bf16 v[60:63], a[232:235], v[180:183], v[60:63]
    v_mfma_f32_16x16x32_bf16 v[64:67], a[232:235], v[184:187], v[64:67]
    buffer_load_dwordx4 v234, s[8:11], s38 offen offset:1056 lds
    v_mfma_f32_16x16x32_bf16 v[68:71], a[232:235], v[188:191], v[68:71]
    v_mfma_f32_16x16x32_bf16 v[72:75], a[232:235], v[192:195], v[72:75]
    v_mfma_f32_16x16x32_bf16 v[76:79], a[236:239], v[176:179], v[76:79]
    buffer_load_dwordx4 v235, s[8:11], s38 offen offset:2112 lds
    v_mfma_f32_16x16x32_bf16 v[80:83], a[236:239], v[180:183], v[80:83]
    v_mfma_f32_16x16x32_bf16 v[84:87], a[236:239], v[184:187], v[84:87]
    v_mfma_f32_16x16x32_bf16 v[88:91], a[236:239], v[188:191], v[88:91]
    buffer_load_dwordx4 v236, s[8:11], s38 offen offset:3168 lds
    v_mfma_f32_16x16x32_bf16 v[92:95], a[236:239], v[192:195], v[92:95]
    v_mfma_f32_16x16x32_bf16 v[16:19], a[240:243], v[196:199], v[16:19]
    s_waitcnt vmcnt(12)
    ds_read_b64_tr_b16 a[224:225], v237 offset:8448
    ds_read_b64_tr_b16 a[226:227], v237 offset:8704
    ds_read_b128 v[176:179], v216 offset:19200
    v_mfma_f32_16x16x32_bf16 v[20:23], a[240:243], v[200:203], v[20:23]
    ds_read_b128 v[180:183], v216 offset:19712
    ds_read_b128 v[184:187], v216 offset:23424
    ds_read_b128 v[188:191], v216 offset:23936
    v_mfma_f32_16x16x32_bf16 v[24:27], a[240:243], v[204:207], v[24:27]
    ds_read_b128 v[192:195], v218 offset:19200
    ds_read_b64_tr_b16 a[228:229], v237 offset:8480
    ds_read_b64_tr_b16 a[230:231], v237 offset:8736
    v_mfma_f32_16x16x32_bf16 v[28:31], a[240:243], v[208:211], v[28:31]
    ds_read_b64_tr_b16 a[232:233], v237 offset:8512
    ds_read_b64_tr_b16 a[234:235], v237 offset:8768
    ds_read_b64_tr_b16 a[236:237], v237 offset:8544
    v_mfma_f32_16x16x32_bf16 v[32:35], a[240:243], v[212:215], v[32:35]
    ds_read_b64_tr_b16 a[238:239], v237 offset:8800
    v_mfma_f32_16x16x32_bf16 v[36:39], a[244:247], v[196:199], v[36:39]
    v_mfma_f32_16x16x32_bf16 v[40:43], a[244:247], v[200:203], v[40:43]
    v_mfma_f32_16x16x32_bf16 v[44:47], a[244:247], v[204:207], v[44:47]
    v_mfma_f32_16x16x32_bf16 v[48:51], a[244:247], v[208:211], v[48:51]
    v_mfma_f32_16x16x32_bf16 v[52:55], a[244:247], v[212:215], v[52:55]
    s_add_u32 m0, s29, 8448
    s_mov_b32 s39, 2097152
    s_waitcnt lgkmcnt(0)
    buffer_load_dwordx4 v233, s[8:11], s39 offen lds
    v_mfma_f32_16x16x32_bf16 v[56:59], a[248:251], v[196:199], v[56:59]
    v_mfma_f32_16x16x32_bf16 v[60:63], a[248:251], v[200:203], v[60:63]
    v_mfma_f32_16x16x32_bf16 v[64:67], a[248:251], v[204:207], v[64:67]
    buffer_load_dwordx4 v234, s[8:11], s39 offen offset:1056 lds
    v_mfma_f32_16x16x32_bf16 v[68:71], a[248:251], v[208:211], v[68:71]
    v_mfma_f32_16x16x32_bf16 v[72:75], a[248:251], v[212:215], v[72:75]
    v_mfma_f32_16x16x32_bf16 v[76:79], a[252:255], v[196:199], v[76:79]
    buffer_load_dwordx4 v235, s[8:11], s39 offen offset:2112 lds
    v_mfma_f32_16x16x32_bf16 v[80:83], a[252:255], v[200:203], v[80:83]
    v_mfma_f32_16x16x32_bf16 v[84:87], a[252:255], v[204:207], v[84:87]
    v_mfma_f32_16x16x32_bf16 v[88:91], a[252:255], v[208:211], v[88:91]
    buffer_load_dwordx4 v236, s[8:11], s39 offen offset:3168 lds
    v_mfma_f32_16x16x32_bf16 v[92:95], a[252:255], v[212:215], v[92:95]
    v_mfma_f32_16x16x32_bf16 v[16:19], a[224:227], v[176:179], v[16:19]
    s_waitcnt vmcnt(12)
    ds_read_b64_tr_b16 a[240:241], v237 offset:12672
    ds_read_b64_tr_b16 a[242:243], v237 offset:12928
    ds_read_b128 v[196:199], v216 offset:19264
    v_mfma_f32_16x16x32_bf16 v[20:23], a[224:227], v[180:183], v[20:23]
    ds_read_b128 v[200:203], v216 offset:19776
    ds_read_b128 v[204:207], v216 offset:23488
    ds_read_b128 v[208:211], v216 offset:24000
    v_mfma_f32_16x16x32_bf16 v[24:27], a[224:227], v[184:187], v[24:27]
    ds_read_b128 v[212:215], v218 offset:19264
    ds_read_b64_tr_b16 a[244:245], v237 offset:12704
    ds_read_b64_tr_b16 a[246:247], v237 offset:12960
    v_mfma_f32_16x16x32_bf16 v[28:31], a[224:227], v[188:191], v[28:31]
    ds_read_b64_tr_b16 a[248:249], v237 offset:12736
    ds_read_b64_tr_b16 a[250:251], v237 offset:12992
    ds_read_b64_tr_b16 a[252:253], v237 offset:12768
    v_mfma_f32_16x16x32_bf16 v[32:35], a[224:227], v[192:195], v[32:35]
    ds_read_b64_tr_b16 a[254:255], v237 offset:13024
    v_mfma_f32_16x16x32_bf16 v[36:39], a[228:231], v[176:179], v[36:39]
    v_mfma_f32_16x16x32_bf16 v[40:43], a[228:231], v[180:183], v[40:43]
    v_mfma_f32_16x16x32_bf16 v[44:47], a[228:231], v[184:187], v[44:47]
    v_mfma_f32_16x16x32_bf16 v[48:51], a[228:231], v[188:191], v[48:51]
    v_mfma_f32_16x16x32_bf16 v[52:55], a[228:231], v[192:195], v[52:55]
    s_add_u32 m0, s29, 12672
    s_mov_b32 s32, 2359296
    s_waitcnt lgkmcnt(0)
    buffer_load_dwordx4 v233, s[8:11], s32 offen lds
    v_mfma_f32_16x16x32_bf16 v[56:59], a[232:235], v[176:179], v[56:59]
    v_mfma_f32_16x16x32_bf16 v[60:63], a[232:235], v[180:183], v[60:63]
    v_mfma_f32_16x16x32_bf16 v[64:67], a[232:235], v[184:187], v[64:67]
    buffer_load_dwordx4 v234, s[8:11], s32 offen offset:1056 lds
    v_mfma_f32_16x16x32_bf16 v[68:71], a[232:235], v[188:191], v[68:71]
    v_mfma_f32_16x16x32_bf16 v[72:75], a[232:235], v[192:195], v[72:75]
    v_mfma_f32_16x16x32_bf16 v[76:79], a[236:239], v[176:179], v[76:79]
    buffer_load_dwordx4 v235, s[8:11], s32 offen offset:2112 lds
    v_mfma_f32_16x16x32_bf16 v[80:83], a[236:239], v[180:183], v[80:83]
    v_mfma_f32_16x16x32_bf16 v[84:87], a[236:239], v[184:187], v[84:87]
    v_mfma_f32_16x16x32_bf16 v[88:91], a[236:239], v[188:191], v[88:91]
    buffer_load_dwordx4 v236, s[8:11], s32 offen offset:3168 lds
    v_mfma_f32_16x16x32_bf16 v[92:95], a[236:239], v[192:195], v[92:95]
    v_mfma_f32_16x16x32_bf16 v[16:19], a[240:243], v[196:199], v[16:19]
    s_waitcnt vmcnt(12)
    ds_read_b64_tr_b16 a[224:225], v237 offset:16896
    ds_read_b64_tr_b16 a[226:227], v237 offset:17152
    ds_read_b128 v[176:179], v216 offset:28800
    v_mfma_f32_16x16x32_bf16 v[20:23], a[240:243], v[200:203], v[20:23]
    ds_read_b128 v[180:183], v216 offset:29312
    ds_read_b128 v[184:187], v216 offset:33024
    ds_read_b128 v[188:191], v216 offset:33536
    v_mfma_f32_16x16x32_bf16 v[24:27], a[240:243], v[204:207], v[24:27]
    ds_read_b128 v[192:195], v218 offset:28800
    ds_read_b64_tr_b16 a[228:229], v237 offset:16928
    ds_read_b64_tr_b16 a[230:231], v237 offset:17184
    v_mfma_f32_16x16x32_bf16 v[28:31], a[240:243], v[208:211], v[28:31]
    ds_read_b64_tr_b16 a[232:233], v237 offset:16960
    ds_read_b64_tr_b16 a[234:235], v237 offset:17216
    ds_read_b64_tr_b16 a[236:237], v237 offset:16992
    v_mfma_f32_16x16x32_bf16 v[32:35], a[240:243], v[212:215], v[32:35]
    ds_read_b64_tr_b16 a[238:239], v237 offset:17248
    v_mfma_f32_16x16x32_bf16 v[36:39], a[244:247], v[196:199], v[36:39]
    v_mfma_f32_16x16x32_bf16 v[40:43], a[244:247], v[200:203], v[40:43]
    v_mfma_f32_16x16x32_bf16 v[44:47], a[244:247], v[204:207], v[44:47]
    v_mfma_f32_16x16x32_bf16 v[48:51], a[244:247], v[208:211], v[48:51]
    v_mfma_f32_16x16x32_bf16 v[52:55], a[244:247], v[212:215], v[52:55]
    s_add_u32 m0, s29, 16896
    s_mov_b32 s33, 2621440
    s_waitcnt lgkmcnt(0)
    buffer_load_dwordx4 v233, s[8:11], s33 offen lds
    v_mfma_f32_16x16x32_bf16 v[56:59], a[248:251], v[196:199], v[56:59]
    v_mfma_f32_16x16x32_bf16 v[60:63], a[248:251], v[200:203], v[60:63]
    v_mfma_f32_16x16x32_bf16 v[64:67], a[248:251], v[204:207], v[64:67]
    buffer_load_dwordx4 v234, s[8:11], s33 offen offset:1056 lds
    v_mfma_f32_16x16x32_bf16 v[68:71], a[248:251], v[208:211], v[68:71]
    v_mfma_f32_16x16x32_bf16 v[72:75], a[248:251], v[212:215], v[72:75]
    v_mfma_f32_16x16x32_bf16 v[76:79], a[252:255], v[196:199], v[76:79]
    buffer_load_dwordx4 v235, s[8:11], s33 offen offset:2112 lds
    v_mfma_f32_16x16x32_bf16 v[80:83], a[252:255], v[200:203], v[80:83]
    v_mfma_f32_16x16x32_bf16 v[84:87], a[252:255], v[204:207], v[84:87]
    v_mfma_f32_16x16x32_bf16 v[88:91], a[252:255], v[208:211], v[88:91]
    buffer_load_dwordx4 v236, s[8:11], s33 offen offset:3168 lds
    v_mfma_f32_16x16x32_bf16 v[92:95], a[252:255], v[212:215], v[92:95]
    v_mfma_f32_16x16x32_bf16 v[16:19], a[224:227], v[176:179], v[16:19]
    s_waitcnt vmcnt(12)
    ds_read_b64_tr_b16 a[240:241], v237 offset:21120
    ds_read_b64_tr_b16 a[242:243], v237 offset:21376
    ds_read_b128 v[196:199], v216 offset:28864
    v_mfma_f32_16x16x32_bf16 v[20:23], a[224:227], v[180:183], v[20:23]
    ds_read_b128 v[200:203], v216 offset:29376
    ds_read_b128 v[204:207], v216 offset:33088
    ds_read_b128 v[208:211], v216 offset:33600
    v_mfma_f32_16x16x32_bf16 v[24:27], a[224:227], v[184:187], v[24:27]
    ds_read_b128 v[212:215], v218 offset:28864
    ds_read_b64_tr_b16 a[244:245], v237 offset:21152
    ds_read_b64_tr_b16 a[246:247], v237 offset:21408
    v_mfma_f32_16x16x32_bf16 v[28:31], a[224:227], v[188:191], v[28:31]
    ds_read_b64_tr_b16 a[248:249], v237 offset:21184
    ds_read_b64_tr_b16 a[250:251], v237 offset:21440
    ds_read_b64_tr_b16 a[252:253], v237 offset:21216
    v_mfma_f32_16x16x32_bf16 v[32:35], a[224:227], v[192:195], v[32:35]
    ds_read_b64_tr_b16 a[254:255], v237 offset:21472
    v_mfma_f32_16x16x32_bf16 v[36:39], a[228:231], v[176:179], v[36:39]
    v_mfma_f32_16x16x32_bf16 v[40:43], a[228:231], v[180:183], v[40:43]
    v_mfma_f32_16x16x32_bf16 v[44:47], a[228:231], v[184:187], v[44:47]
    v_mfma_f32_16x16x32_bf16 v[48:51], a[228:231], v[188:191], v[48:51]
    v_mfma_f32_16x16x32_bf16 v[52:55], a[228:231], v[192:195], v[52:55]
    s_add_u32 m0, s29, 21120
    s_mov_b32 s34, 2883584
    s_waitcnt lgkmcnt(0)
    buffer_load_dwordx4 v233, s[8:11], s34 offen lds
    v_mfma_f32_16x16x32_bf16 v[56:59], a[232:235], v[176:179], v[56:59]
    v_mfma_f32_16x16x32_bf16 v[60:63], a[232:235], v[180:183], v[60:63]
    v_mfma_f32_16x16x32_bf16 v[64:67], a[232:235], v[184:187], v[64:67]
    buffer_load_dwordx4 v234, s[8:11], s34 offen offset:1056 lds
    v_mfma_f32_16x16x32_bf16 v[68:71], a[232:235], v[188:191], v[68:71]
    v_mfma_f32_16x16x32_bf16 v[72:75], a[232:235], v[192:195], v[72:75]
    v_mfma_f32_16x16x32_bf16 v[76:79], a[236:239], v[176:179], v[76:79]
    buffer_load_dwordx4 v235, s[8:11], s34 offen offset:2112 lds
    v_mfma_f32_16x16x32_bf16 v[80:83], a[236:239], v[180:183], v[80:83]
    v_mfma_f32_16x16x32_bf16 v[84:87], a[236:239], v[184:187], v[84:87]
    v_mfma_f32_16x16x32_bf16 v[88:91], a[236:239], v[188:191], v[88:91]
    buffer_load_dwordx4 v236, s[8:11], s34 offen offset:3168 lds
    v_mfma_f32_16x16x32_bf16 v[92:95], a[236:239], v[192:195], v[92:95]
    v_mfma_f32_16x16x32_bf16 v[16:19], a[240:243], v[196:199], v[16:19]
    s_waitcnt vmcnt(12)
    ds_read_b64_tr_b16 a[224:225], v237 offset:8448
    ds_read_b64_tr_b16 a[226:227], v237 offset:8704
    ds_read_b128 v[176:179], v217 offset:0
    v_mfma_f32_16x16x32_bf16 v[20:23], a[240:243], v[200:203], v[20:23]
    ds_read_b128 v[180:183], v217 offset:512
    ds_read_b128 v[184:187], v217 offset:4224
    ds_read_b128 v[188:191], v217 offset:4736
    v_mfma_f32_16x16x32_bf16 v[24:27], a[240:243], v[204:207], v[24:27]
    ds_read_b128 v[192:195], v219 offset:0
    ds_read_b64_tr_b16 a[228:229], v237 offset:8480
    ds_read_b64_tr_b16 a[230:231], v237 offset:8736
    v_mfma_f32_16x16x32_bf16 v[28:31], a[240:243], v[208:211], v[28:31]
    ds_read_b64_tr_b16 a[232:233], v237 offset:8512
    ds_read_b64_tr_b16 a[234:235], v237 offset:8768
    ds_read_b64_tr_b16 a[236:237], v237 offset:8544
    v_mfma_f32_16x16x32_bf16 v[32:35], a[240:243], v[212:215], v[32:35]
    ds_read_b64_tr_b16 a[238:239], v237 offset:8800
    v_mfma_f32_16x16x32_bf16 v[36:39], a[244:247], v[196:199], v[36:39]
    v_mfma_f32_16x16x32_bf16 v[40:43], a[244:247], v[200:203], v[40:43]
    v_mfma_f32_16x16x32_bf16 v[44:47], a[244:247], v[204:207], v[44:47]
    v_mfma_f32_16x16x32_bf16 v[48:51], a[244:247], v[208:211], v[48:51]
    v_mfma_f32_16x16x32_bf16 v[52:55], a[244:247], v[212:215], v[52:55]
    s_add_u32 m0, s29, 8448
    s_mov_b32 s35, 3145728
    s_waitcnt lgkmcnt(0)
    buffer_load_dwordx4 v233, s[8:11], s35 offen lds
    v_mfma_f32_16x16x32_bf16 v[56:59], a[248:251], v[196:199], v[56:59]
    v_mfma_f32_16x16x32_bf16 v[60:63], a[248:251], v[200:203], v[60:63]
    v_mfma_f32_16x16x32_bf16 v[64:67], a[248:251], v[204:207], v[64:67]
    buffer_load_dwordx4 v234, s[8:11], s35 offen offset:1056 lds
    v_mfma_f32_16x16x32_bf16 v[68:71], a[248:251], v[208:211], v[68:71]
    v_mfma_f32_16x16x32_bf16 v[72:75], a[248:251], v[212:215], v[72:75]
    v_mfma_f32_16x16x32_bf16 v[76:79], a[252:255], v[196:199], v[76:79]
    buffer_load_dwordx4 v235, s[8:11], s35 offen offset:2112 lds
    v_mfma_f32_16x16x32_bf16 v[80:83], a[252:255], v[200:203], v[80:83]
    v_mfma_f32_16x16x32_bf16 v[84:87], a[252:255], v[204:207], v[84:87]
    v_mfma_f32_16x16x32_bf16 v[88:91], a[252:255], v[208:211], v[88:91]
    buffer_load_dwordx4 v236, s[8:11], s35 offen offset:3168 lds
    v_mfma_f32_16x16x32_bf16 v[92:95], a[252:255], v[212:215], v[92:95]
    v_mfma_f32_16x16x32_bf16 v[16:19], a[224:227], v[176:179], v[16:19]
    s_waitcnt vmcnt(12)
    ds_read_b64_tr_b16 a[240:241], v237 offset:12672
    ds_read_b64_tr_b16 a[242:243], v237 offset:12928
    ds_read_b128 v[196:199], v217 offset:64
    v_mfma_f32_16x16x32_bf16 v[20:23], a[224:227], v[180:183], v[20:23]
    ds_read_b128 v[200:203], v217 offset:576
    ds_read_b128 v[204:207], v217 offset:4288
    ds_read_b128 v[208:211], v217 offset:4800
    v_mfma_f32_16x16x32_bf16 v[24:27], a[224:227], v[184:187], v[24:27]
    ds_read_b128 v[212:215], v219 offset:64
    ds_read_b64_tr_b16 a[244:245], v237 offset:12704
    ds_read_b64_tr_b16 a[246:247], v237 offset:12960
    v_mfma_f32_16x16x32_bf16 v[28:31], a[224:227], v[188:191], v[28:31]
    ds_read_b64_tr_b16 a[248:249], v237 offset:12736
    ds_read_b64_tr_b16 a[250:251], v237 offset:12992
    ds_read_b64_tr_b16 a[252:253], v237 offset:12768
    v_mfma_f32_16x16x32_bf16 v[32:35], a[224:227], v[192:195], v[32:35]
    ds_read_b64_tr_b16 a[254:255], v237 offset:13024
    v_mfma_f32_16x16x32_bf16 v[36:39], a[228:231], v[176:179], v[36:39]
    v_mfma_f32_16x16x32_bf16 v[40:43], a[228:231], v[180:183], v[40:43]
    v_mfma_f32_16x16x32_bf16 v[44:47], a[228:231], v[184:187], v[44:47]
    v_mfma_f32_16x16x32_bf16 v[48:51], a[228:231], v[188:191], v[48:51]
    v_mfma_f32_16x16x32_bf16 v[52:55], a[228:231], v[192:195], v[52:55]
    s_add_u32 m0, s29, 12672
    s_mov_b32 s36, 3407872
    s_waitcnt lgkmcnt(0)
    buffer_load_dwordx4 v233, s[8:11], s36 offen lds
    v_mfma_f32_16x16x32_bf16 v[56:59], a[232:235], v[176:179], v[56:59]
    v_mfma_f32_16x16x32_bf16 v[60:63], a[232:235], v[180:183], v[60:63]
    v_mfma_f32_16x16x32_bf16 v[64:67], a[232:235], v[184:187], v[64:67]
    buffer_load_dwordx4 v234, s[8:11], s36 offen offset:1056 lds
    v_mfma_f32_16x16x32_bf16 v[68:71], a[232:235], v[188:191], v[68:71]
    v_mfma_f32_16x16x32_bf16 v[72:75], a[232:235], v[192:195], v[72:75]
    v_mfma_f32_16x16x32_bf16 v[76:79], a[236:239], v[176:179], v[76:79]
    buffer_load_dwordx4 v235, s[8:11], s36 offen offset:2112 lds
    v_mfma_f32_16x16x32_bf16 v[80:83], a[236:239], v[180:183], v[80:83]
    v_mfma_f32_16x16x32_bf16 v[84:87], a[236:239], v[184:187], v[84:87]
    v_mfma_f32_16x16x32_bf16 v[88:91], a[236:239], v[188:191], v[88:91]
    buffer_load_dwordx4 v236, s[8:11], s36 offen offset:3168 lds
    v_mfma_f32_16x16x32_bf16 v[92:95], a[236:239], v[192:195], v[92:95]
    v_mfma_f32_16x16x32_bf16 v[16:19], a[240:243], v[196:199], v[16:19]
    s_waitcnt vmcnt(12)
    ds_read_b64_tr_b16 a[224:225], v237 offset:16896
    ds_read_b64_tr_b16 a[226:227], v237 offset:17152
    ds_read_b128 v[176:179], v217 offset:9600
    v_mfma_f32_16x16x32_bf16 v[20:23], a[240:243], v[200:203], v[20:23]
    ds_read_b128 v[180:183], v217 offset:10112
    ds_read_b128 v[184:187], v217 offset:13824
    ds_read_b128 v[188:191], v217 offset:14336
    v_mfma_f32_16x16x32_bf16 v[24:27], a[240:243], v[204:207], v[24:27]
    ds_read_b128 v[192:195], v219 offset:9600
    ds_read_b64_tr_b16 a[228:229], v237 offset:16928
    ds_read_b64_tr_b16 a[230:231], v237 offset:17184
    v_mfma_f32_16x16x32_bf16 v[28:31], a[240:243], v[208:211], v[28:31]
    ds_read_b64_tr_b16 a[232:233], v237 offset:16960
    ds_read_b64_tr_b16 a[234:235], v237 offset:17216
    ds_read_b64_tr_b16 a[236:237], v237 offset:16992
    v_mfma_f32_16x16x32_bf16 v[32:35], a[240:243], v[212:215], v[32:35]
    ds_read_b64_tr_b16 a[238:239], v237 offset:17248
    v_mfma_f32_16x16x32_bf16 v[36:39], a[244:247], v[196:199], v[36:39]
    v_mfma_f32_16x16x32_bf16 v[40:43], a[244:247], v[200:203], v[40:43]
    v_mfma_f32_16x16x32_bf16 v[44:47], a[244:247], v[204:207], v[44:47]
    v_mfma_f32_16x16x32_bf16 v[48:51], a[244:247], v[208:211], v[48:51]
    v_mfma_f32_16x16x32_bf16 v[52:55], a[244:247], v[212:215], v[52:55]
    s_add_u32 m0, s29, 16896
    s_add_u32 s37, s92, 0
    s_waitcnt lgkmcnt(0)
    buffer_load_dwordx4 v9, s[12:15], s37 offen nt lds
    v_mfma_f32_16x16x32_bf16 v[56:59], a[248:251], v[196:199], v[56:59]
    v_mfma_f32_16x16x32_bf16 v[60:63], a[248:251], v[200:203], v[60:63]
    v_mfma_f32_16x16x32_bf16 v[64:67], a[248:251], v[204:207], v[64:67]
    buffer_load_dwordx4 v10, s[12:15], s37 offen offset:1056 nt lds
    v_mfma_f32_16x16x32_bf16 v[68:71], a[248:251], v[208:211], v[68:71]
    v_mfma_f32_16x16x32_bf16 v[72:75], a[248:251], v[212:215], v[72:75]
    v_mfma_f32_16x16x32_bf16 v[76:79], a[252:255], v[196:199], v[76:79]
    buffer_load_dwordx4 v11, s[12:15], s37 offen offset:2112 nt lds
    v_mfma_f32_16x16x32_bf16 v[80:83], a[252:255], v[200:203], v[80:83]
    v_mfma_f32_16x16x32_bf16 v[84:87], a[252:255], v[204:207], v[84:87]
    v_mfma_f32_16x16x32_bf16 v[88:91], a[252:255], v[208:211], v[88:91]
    buffer_load_dwordx4 v12, s[12:15], s37 offen offset:3168 nt lds
    v_mfma_f32_16x16x32_bf16 v[92:95], a[252:255], v[212:215], v[92:95]
    v_mfma_f32_16x16x32_bf16 v[16:19], a[224:227], v[176:179], v[16:19]
    s_waitcnt vmcnt(12)
    ds_read_b64_tr_b16 a[240:241], v237 offset:21120
    ds_read_b64_tr_b16 a[242:243], v237 offset:21376
    ds_read_b128 v[196:199], v217 offset:9664
    v_mfma_f32_16x16x32_bf16 v[20:23], a[224:227], v[180:183], v[20:23]
    ds_read_b128 v[200:203], v217 offset:10176
    ds_read_b128 v[204:207], v217 offset:13888
    ds_read_b128 v[208:211], v217 offset:14400
    v_mfma_f32_16x16x32_bf16 v[24:27], a[224:227], v[184:187], v[24:27]
    ds_read_b128 v[212:215], v219 offset:9664
    ds_read_b64_tr_b16 a[244:245], v237 offset:21152
    ds_read_b64_tr_b16 a[246:247], v237 offset:21408
    v_mfma_f32_16x16x32_bf16 v[28:31], a[224:227], v[188:191], v[28:31]
    ds_read_b64_tr_b16 a[248:249], v237 offset:21184
    ds_read_b64_tr_b16 a[250:251], v237 offset:21440
    ds_read_b64_tr_b16 a[252:253], v237 offset:21216
    v_mfma_f32_16x16x32_bf16 v[32:35], a[224:227], v[192:195], v[32:35]
    ds_read_b64_tr_b16 a[254:255], v237 offset:21472
    v_mfma_f32_16x16x32_bf16 v[36:39], a[228:231], v[176:179], v[36:39]
    v_mfma_f32_16x16x32_bf16 v[40:43], a[228:231], v[180:183], v[40:43]
    v_mfma_f32_16x16x32_bf16 v[44:47], a[228:231], v[184:187], v[44:47]
    v_mfma_f32_16x16x32_bf16 v[48:51], a[228:231], v[188:191], v[48:51]
    v_mfma_f32_16x16x32_bf16 v[52:55], a[228:231], v[192:195], v[52:55]
    s_add_u32 m0, s29, 21120
    s_add_u32 s38, s93, 0
    s_waitcnt lgkmcnt(0)
    buffer_load_dwordx4 v9, s[12:15], s38 offen nt lds
    v_mfma_f32_16x16x32_bf16 v[56:59], a[232:235], v[176:179], v[56:59]
    v_mfma_f32_16x16x32_bf16 v[60:63], a[232:235], v[180:183], v[60:63]
    v_mfma_f32_16x16x32_bf16 v[64:67], a[232:235], v[184:187], v[64:67]
    buffer_load_dwordx4 v10, s[12:15], s38 offen offset:1056 nt lds
    v_mfma_f32_16x16x32_bf16 v[68:71], a[232:235], v[188:191], v[68:71]
    v_mfma_f32_16x16x32_bf16 v[72:75], a[232:235], v[192:195], v[72:75]
    v_mfma_f32_16x16x32_bf16 v[76:79], a[236:239], v[176:179], v[76:79]
    buffer_load_dwordx4 v11, s[12:15], s38 offen offset:2112 nt lds
    v_mfma_f32_16x16x32_bf16 v[80:83], a[236:239], v[180:183], v[80:83]
    v_mfma_f32_16x16x32_bf16 v[84:87], a[236:239], v[184:187], v[84:87]
    v_mfma_f32_16x16x32_bf16 v[88:91], a[236:239], v[188:191], v[88:91]
    buffer_load_dwordx4 v12, s[12:15], s38 offen offset:3168 nt lds
    v_mfma_f32_16x16x32_bf16 v[92:95], a[236:239], v[192:195], v[92:95]
    v_mfma_f32_16x16x32_bf16 v[16:19], a[240:243], v[196:199], v[16:19]
    s_waitcnt vmcnt(12)
    ds_read_b64_tr_b16 a[224:225], v237 offset:8448
    ds_read_b64_tr_b16 a[226:227], v237 offset:8704
    ds_read_b128 v[176:179], v217 offset:19200
    v_mfma_f32_16x16x32_bf16 v[20:23], a[240:243], v[200:203], v[20:23]
    ds_read_b128 v[180:183], v217 offset:19712
    ds_read_b128 v[184:187], v217 offset:23424
    ds_read_b128 v[188:191], v217 offset:23936
    v_mfma_f32_16x16x32_bf16 v[24:27], a[240:243], v[204:207], v[24:27]
    ds_read_b128 v[192:195], v219 offset:19200
    ds_read_b64_tr_b16 a[228:229], v237 offset:8480
    ds_read_b64_tr_b16 a[230:231], v237 offset:8736
    v_mfma_f32_16x16x32_bf16 v[28:31], a[240:243], v[208:211], v[28:31]
    ds_read_b64_tr_b16 a[232:233], v237 offset:8512
    ds_read_b64_tr_b16 a[234:235], v237 offset:8768
    ds_read_b64_tr_b16 a[236:237], v237 offset:8544
    v_mfma_f32_16x16x32_bf16 v[32:35], a[240:243], v[212:215], v[32:35]
    ds_read_b64_tr_b16 a[238:239], v237 offset:8800
    v_mfma_f32_16x16x32_bf16 v[36:39], a[244:247], v[196:199], v[36:39]
    v_mfma_f32_16x16x32_bf16 v[40:43], a[244:247], v[200:203], v[40:43]
    v_mfma_f32_16x16x32_bf16 v[44:47], a[244:247], v[204:207], v[44:47]
    v_mfma_f32_16x16x32_bf16 v[48:51], a[244:247], v[208:211], v[48:51]
    v_mfma_f32_16x16x32_bf16 v[52:55], a[244:247], v[212:215], v[52:55]
    s_add_u32 m0, s29, 8448
    s_add_u32 s39, s94, 0
    s_waitcnt lgkmcnt(0)
    buffer_load_dwordx4 v9, s[12:15], s39 offen nt lds
    v_mfma_f32_16x16x32_bf16 v[56:59], a[248:251], v[196:199], v[56:59]
    v_mfma_f32_16x16x32_bf16 v[60:63], a[248:251], v[200:203], v[60:63]
    v_mfma_f32_16x16x32_bf16 v[64:67], a[248:251], v[204:207], v[64:67]
    buffer_load_dwordx4 v10, s[12:15], s39 offen offset:1056 nt lds
    v_mfma_f32_16x16x32_bf16 v[68:71], a[248:251], v[208:211], v[68:71]
    v_mfma_f32_16x16x32_bf16 v[72:75], a[248:251], v[212:215], v[72:75]
    v_mfma_f32_16x16x32_bf16 v[76:79], a[252:255], v[196:199], v[76:79]
    buffer_load_dwordx4 v11, s[12:15], s39 offen offset:2112 nt lds
    v_mfma_f32_16x16x32_bf16 v[80:83], a[252:255], v[200:203], v[80:83]
    v_mfma_f32_16x16x32_bf16 v[84:87], a[252:255], v[204:207], v[84:87]
    v_mfma_f32_16x16x32_bf16 v[88:91], a[252:255], v[208:211], v[88:91]
    buffer_load_dwordx4 v12, s[12:15], s39 offen offset:3168 nt lds
    v_mfma_f32_16x16x32_bf16 v[92:95], a[252:255], v[212:215], v[92:95]
    v_mfma_f32_16x16x32_bf16 v[16:19], a[224:227], v[176:179], v[16:19]
    s_waitcnt vmcnt(12)
    ds_read_b64_tr_b16 a[240:241], v237 offset:12672
    ds_read_b64_tr_b16 a[242:243], v237 offset:12928
    ds_read_b128 v[196:199], v217 offset:19264
    v_mfma_f32_16x16x32_bf16 v[20:23], a[224:227], v[180:183], v[20:23]
    ds_read_b128 v[200:203], v217 offset:19776
    ds_read_b128 v[204:207], v217 offset:23488
    ds_read_b128 v[208:211], v217 offset:24000
    v_mfma_f32_16x16x32_bf16 v[24:27], a[224:227], v[184:187], v[24:27]
    ds_read_b128 v[212:215], v219 offset:19264
    ds_read_b64_tr_b16 a[244:245], v237 offset:12704
    ds_read_b64_tr_b16 a[246:247], v237 offset:12960
    v_mfma_f32_16x16x32_bf16 v[28:31], a[224:227], v[188:191], v[28:31]
    ds_read_b64_tr_b16 a[248:249], v237 offset:12736
    ds_read_b64_tr_b16 a[250:251], v237 offset:12992
    ds_read_b64_tr_b16 a[252:253], v237 offset:12768
    v_mfma_f32_16x16x32_bf16 v[32:35], a[224:227], v[192:195], v[32:35]
    ds_read_b64_tr_b16 a[254:255], v237 offset:13024
    v_mfma_f32_16x16x32_bf16 v[36:39], a[228:231], v[176:179], v[36:39]
    v_mfma_f32_16x16x32_bf16 v[40:43], a[228:231], v[180:183], v[40:43]
    v_mfma_f32_16x16x32_bf16 v[44:47], a[228:231], v[184:187], v[44:47]
    v_mfma_f32_16x16x32_bf16 v[48:51], a[228:231], v[188:191], v[48:51]
    v_mfma_f32_16x16x32_bf16 v[52:55], a[228:231], v[192:195], v[52:55]
    s_add_u32 m0, s29, 12672
    s_add_u32 s32, s95, 0
    s_waitcnt lgkmcnt(0)
    buffer_load_dwordx4 v9, s[12:15], s32 offen nt lds
    v_mfma_f32_16x16x32_bf16 v[56:59], a[232:235], v[176:179], v[56:59]
    v_mfma_f32_16x16x32_bf16 v[60:63], a[232:235], v[180:183], v[60:63]
    v_mfma_f32_16x16x32_bf16 v[64:67], a[232:235], v[184:187], v[64:67]
    buffer_load_dwordx4 v10, s[12:15], s32 offen offset:1056 nt lds
    v_mfma_f32_16x16x32_bf16 v[68:71], a[232:235], v[188:191], v[68:71]
    v_mfma_f32_16x16x32_bf16 v[72:75], a[232:235], v[192:195], v[72:75]
    v_mfma_f32_16x16x32_bf16 v[76:79], a[236:239], v[176:179], v[76:79]
    buffer_load_dwordx4 v11, s[12:15], s32 offen offset:2112 nt lds
    v_mfma_f32_16x16x32_bf16 v[80:83], a[236:239], v[180:183], v[80:83]
    v_mfma_f32_16x16x32_bf16 v[84:87], a[236:239], v[184:187], v[84:87]
    v_mfma_f32_16x16x32_bf16 v[88:91], a[236:239], v[188:191], v[88:91]
    buffer_load_dwordx4 v12, s[12:15], s32 offen offset:3168 nt lds
    v_mfma_f32_16x16x32_bf16 v[92:95], a[236:239], v[192:195], v[92:95]
    v_mfma_f32_16x16x32_bf16 v[16:19], a[240:243], v[196:199], v[16:19]
    v_mfma_f32_16x16x32_bf16 v[20:23], a[240:243], v[200:203], v[20:23]
    v_mfma_f32_16x16x32_bf16 v[24:27], a[240:243], v[204:207], v[24:27]
    v_mfma_f32_16x16x32_bf16 v[28:31], a[240:243], v[208:211], v[28:31]
    v_mfma_f32_16x16x32_bf16 v[32:35], a[240:243], v[212:215], v[32:35]
    v_mfma_f32_16x16x32_bf16 v[36:39], a[244:247], v[196:199], v[36:39]
    v_mfma_f32_16x16x32_bf16 v[40:43], a[244:247], v[200:203], v[40:43]
    v_mfma_f32_16x16x32_bf16 v[44:47], a[244:247], v[204:207], v[44:47]
    v_mfma_f32_16x16x32_bf16 v[48:51], a[244:247], v[208:211], v[48:51]
    v_mfma_f32_16x16x32_bf16 v[52:55], a[244:247], v[212:215], v[52:55]
    v_mfma_f32_16x16x32_bf16 v[56:59], a[248:251], v[196:199], v[56:59]
    v_mfma_f32_16x16x32_bf16 v[60:63], a[248:251], v[200:203], v[60:63]
    v_mfma_f32_16x16x32_bf16 v[64:67], a[248:251], v[204:207], v[64:67]
    v_mfma_f32_16x16x32_bf16 v[68:71], a[248:251], v[208:211], v[68:71]
    v_mfma_f32_16x16x32_bf16 v[72:75], a[248:251], v[212:215], v[72:75]
    v_mfma_f32_16x16x32_bf16 v[76:79], a[252:255], v[196:199], v[76:79]
    v_mfma_f32_16x16x32_bf16 v[80:83], a[252:255], v[200:203], v[80:83]
    v_mfma_f32_16x16x32_bf16 v[84:87], a[252:255], v[204:207], v[84:87]
    v_mfma_f32_16x16x32_bf16 v[88:91], a[252:255], v[208:211], v[88:91]
    v_mfma_f32_16x16x32_bf16 v[92:95], a[252:255], v[212:215], v[92:95]
    s_waitcnt lgkmcnt(0)
    s_barrier
    s_add_u32 m0, s29, 0
    s_add_u32 s33, s92, 65536
    buffer_load_dwordx4 v9, s[12:15], s33 offen nt lds
    buffer_load_dwordx4 v10, s[12:15], s33 offen offset:1056 nt lds
    buffer_load_dwordx4 v11, s[12:15], s33 offen offset:2112 nt lds
    buffer_load_dwordx4 v12, s[12:15], s33 offen offset:3168 nt lds
    s_add_u32 m0, s29, 4224
    s_add_u32 s34, s93, 65536
    buffer_load_dwordx4 v9, s[12:15], s34 offen nt lds
    buffer_load_dwordx4 v10, s[12:15], s34 offen offset:1056 nt lds
    buffer_load_dwordx4 v11, s[12:15], s34 offen offset:2112 nt lds
    buffer_load_dwordx4 v12, s[12:15], s34 offen offset:3168 nt lds
    v_lshlrev_b32 v1, 9, v3
    v_and_b32 v2, 1, v4
    v_lshl_add_u32 v2, v2, 3, v1
    s_lshl_b32 s74, s28, 3
    v_lshrrev_b32 v13, 1, v4
    v_add_u32 v13, s74, v13
    v_add_u32 v14, 0, v13
    v_xor_b32 v14, v14, v3
    v_lshl_add_u32 v176, v14, 4, v2
    v_add_u32 v14, 2, v13
    v_xor_b32 v14, v14, v3
    v_lshl_add_u32 v177, v14, 4, v2
    v_add_u32 v14, 4, v13
    v_xor_b32 v14, v14, v3
    v_lshl_add_u32 v178, v14, 4, v2
    v_add_u32 v14, 6, v13
    v_xor_b32 v14, v14, v3
    v_lshl_add_u32 v179, v14, 4, v2
    v_cvt_pk_bf16_f32 v216, v16, v17
    v_cvt_pk_bf16_f32 v217, v18, v19
    ds_write_b64 v176, v[216:217] offset:0
    v_cvt_pk_bf16_f32 v218, v20, v21
    v_cvt_pk_bf16_f32 v219, v22, v23
    ds_write_b64 v176, v[218:219] offset:8192
    v_cvt_pk_bf16_f32 v220, v24, v25
    v_cvt_pk_bf16_f32 v221, v26, v27
    ds_write_b64 v176, v[220:221] offset:16384
    v_cvt_pk_bf16_f32 v222, v28, v29
    v_cvt_pk_bf16_f32 v223, v30, v31
    ds_write_b64 v176, v[222:223] offset:24576
    v_cvt_pk_bf16_f32 v224, v32, v33
    v_cvt_pk_bf16_f32 v225, v34, v35
    ds_write_b64 v176, v[224:225] offset:32768
    v_cvt_pk_bf16_f32 v226, v36, v37
    v_cvt_pk_bf16_f32 v227, v38, v39
    ds_write_b64 v177, v[226:227] offset:0
    v_cvt_pk_bf16_f32 v228, v40, v41
    v_cvt_pk_bf16_f32 v229, v42, v43
    ds_write_b64 v177, v[228:229] offset:8192
    v_cvt_pk_bf16_f32 v230, v44, v45
    v_cvt_pk_bf16_f32 v231, v46, v47
    ds_write_b64 v177, v[230:231] offset:16384
    v_cvt_pk_bf16_f32 v216, v48, v49
    v_cvt_pk_bf16_f32 v217, v50, v51
    ds_write_b64 v177, v[216:217] offset:24576
    v_cvt_pk_bf16_f32 v218, v52, v53
    v_cvt_pk_bf16_f32 v219, v54, v55
    ds_write_b64 v177, v[218:219] offset:32768
    v_cvt_pk_bf16_f32 v220, v56, v57
    v_cvt_pk_bf16_f32 v221, v58, v59
    ds_write_b64 v178, v[220:221] offset:0
    v_cvt_pk_bf16_f32 v222, v60, v61
    v_cvt_pk_bf16_f32 v223, v62, v63
    ds_write_b64 v178, v[222:223] offset:8192
    v_cvt_pk_bf16_f32 v224, v64, v65
    v_cvt_pk_bf16_f32 v225, v66, v67
    ds_write_b64 v178, v[224:225] offset:16384
    v_cvt_pk_bf16_f32 v226, v68, v69
    v_cvt_pk_bf16_f32 v227, v70, v71
    ds_write_b64 v178, v[226:227] offset:24576
    v_cvt_pk_bf16_f32 v228, v72, v73
    v_cvt_pk_bf16_f32 v229, v74, v75
    ds_write_b64 v178, v[228:229] offset:32768
    v_cvt_pk_bf16_f32 v230, v76, v77
    v_cvt_pk_bf16_f32 v231, v78, v79
    ds_write_b64 v179, v[230:231] offset:0
    v_cvt_pk_bf16_f32 v216, v80, v81
    v_cvt_pk_bf16_f32 v217, v82, v83
    ds_write_b64 v179, v[216:217] offset:8192
    v_cvt_pk_bf16_f32 v218, v84, v85
    v_cvt_pk_bf16_f32 v219, v86, v87
    ds_write_b64 v179, v[218:219] offset:16384
    v_cvt_pk_bf16_f32 v220, v88, v89
    v_cvt_pk_bf16_f32 v221, v90, v91
    ds_write_b64 v179, v[220:221] offset:24576
    v_cvt_pk_bf16_f32 v222, v92, v93
    v_cvt_pk_bf16_f32 v223, v94, v95
    ds_write_b64 v179, v[222:223] offset:32768
    v_lshlrev_b32 v1, 9, v3
    s_mov_b32 s74, 0
    v_add_u32 v2, s74, v4
    v_xor_b32 v2, v2, v3
    v_lshl_add_u32 v216, v2, 4, v1
    s_mov_b32 s74, 4
    v_add_u32 v2, s74, v4
    v_xor_b32 v2, v2, v3
    v_lshl_add_u32 v217, v2, 4, v1
    s_mov_b32 s74, 8
    v_add_u32 v2, s74, v4
    v_xor_b32 v2, v2, v3
    v_lshl_add_u32 v218, v2, 4, v1
    s_mov_b32 s74, 12
    v_add_u32 v2, s74, v4
    v_xor_b32 v2, v2, v3
    v_lshl_add_u32 v219, v2, 4, v1
    s_mov_b32 s74, 16
    v_add_u32 v2, s74, v4
    v_xor_b32 v2, v2, v3
    v_lshl_add_u32 v220, v2, 4, v1
    s_mov_b32 s74, 20
    v_add_u32 v2, s74, v4
    v_xor_b32 v2, v2, v3
    v_lshl_add_u32 v221, v2, 4, v1
    s_mov_b32 s74, 24
    v_add_u32 v2, s74, v4
    v_xor_b32 v2, v2, v3
    v_lshl_add_u32 v222, v2, 4, v1
    s_mov_b32 s74, 28
    v_add_u32 v2, s74, v4
    v_xor_b32 v2, v2, v3
    v_lshl_add_u32 v223, v2, 4, v1
    s_waitcnt lgkmcnt(0)
    s_barrier
    ds_read_b128 a[0:3], v216 offset:0
    ds_read_b128 a[4:7], v216 offset:8192
    ds_read_b128 a[8:11], v216 offset:16384
    ds_read_b128 a[12:15], v216 offset:24576
    ds_read_b128 a[16:19], v216 offset:32768
    ds_read_b128 a[20:23], v217 offset:0
    ds_read_b128 a[24:27], v217 offset:8192
    ds_read_b128 a[28:31], v217 offset:16384
    ds_read_b128 a[32:35], v217 offset:24576
    ds_read_b128 a[36:39], v217 offset:32768
    ds_read_b128 a[40:43], v218 offset:0
    ds_read_b128 a[44:47], v218 offset:8192
    ds_read_b128 a[48:51], v218 offset:16384
    ds_read_b128 a[52:55], v218 offset:24576
    ds_read_b128 a[56:59], v218 offset:32768
    ds_read_b128 a[60:63], v219 offset:0
    ds_read_b128 a[64:67], v219 offset:8192
    ds_read_b128 a[68:71], v219 offset:16384
    ds_read_b128 a[72:75], v219 offset:24576
    ds_read_b128 a[76:79], v219 offset:32768
    ds_read_b128 a[80:83], v220 offset:0
    ds_read_b128 a[84:87], v220 offset:8192
    ds_read_b128 a[88:91], v220 offset:16384
    ds_read_b128 a[92:95], v220 offset:24576
    ds_read_b128 a[96:99], v220 offset:32768
    ds_read_b128 a[100:103], v221 offset:0
    ds_read_b128 a[104:107], v221 offset:8192
    ds_read_b128 a[108:111], v221 offset:16384
    ds_read_b128 a[112:115], v221 offset:24576
    ds_read_b128 a[116:119], v221 offset:32768
    ds_read_b128 a[120:123], v222 offset:0
    ds_read_b128 a[124:127], v222 offset:8192
    ds_read_b128 a[128:131], v222 offset:16384
    ds_read_b128 a[132:135], v222 offset:24576
    ds_read_b128 a[136:139], v222 offset:32768
    ds_read_b128 a[140:143], v223 offset:0
    ds_read_b128 a[144:147], v223 offset:8192
    ds_read_b128 a[148:151], v223 offset:16384
    ds_read_b128 a[152:155], v223 offset:24576
    ds_read_b128 a[156:159], v223 offset:32768
L_att:
    s_waitcnt vmcnt(20)
    ds_read_b128 a[160:163], v232 offset:16896
    ds_read_b128 a[164:167], v232 offset:17408
    ds_read_b128 a[168:171], v232 offset:16960
    ds_read_b128 a[172:175], v232 offset:17472
    s_waitcnt lgkmcnt(3)
    v_mfma_f32_16x16x32_bf16 v[16:19], a[160:163], a[0:3], 0
    s_waitcnt vmcnt(16)
    ds_read_b128 a[176:179], v232 offset:21120
    ds_read_b128 a[180:183], v232 offset:21632
    ds_read_b128 a[184:187], v232 offset:21184
    ds_read_b128 a[188:191], v232 offset:21696
    v_mfma_f32_16x16x32_bf16 v[20:23], a[160:163], a[4:7], 0
    v_mfma_f32_16x16x32_bf16 v[24:27], a[160:163], a[8:11], 0
    v_mfma_f32_16x16x32_bf16 v[28:31], a[160:163], a[12:15], 0
    v_mfma_f32_16x16x32_bf16 v[32:35], a[160:163], a[16:19], 0
    s_add_u32 m0, s29, 16896
    s_add_u32 s35, s94, 65536
    s_waitcnt lgkmcnt(4)
    buffer_load_dwordx4 v9, s[12:15], s35 offen nt lds
    v_mfma_f32_16x16x32_bf16 v[36:39], a[164:167], a[0:3], 0
    v_mfma_f32_16x16x32_bf16 v[40:43], a[164:167], a[4:7], 0
    v_mfma_f32_16x16x32_bf16 v[44:47], a[164:167], a[8:11], 0
    buffer_load_dwordx4 v10, s[12:15], s35 offen offset:1056 nt lds
    v_mfma_f32_16x16x32_bf16 v[48:51], a[164:167], a[12:15], 0
    v_mfma_f32_16x16x32_bf16 v[52:55], a[164:167], a[16:19], 0
    v_mfma_f32_16x16x32_bf16 v[16:19], a[168:171], a[20:23], v[16:19]
    buffer_load_dwordx4 v11, s[12:15], s35 offen offset:2112 nt lds
    v_mfma_f32_16x16x32_bf16 v[20:23], a[168:171], a[24:27], v[20:23]
    v_mfma_f32_16x16x32_bf16 v[24:27], a[168:171], a[28:31], v[24:27]
    v_mfma_f32_16x16x32_bf16 v[28:31], a[168:171], a[32:35], v[28:31]
    buffer_load_dwordx4 v12, s[12:15], s35 offen offset:3168 nt lds
    s_add_u32 m0, s29, 21120
    s_add_u32 s36, s95, 65536
    s_waitcnt lgkmcnt(0)
    buffer_load_dwordx4 v9, s[12:15], s36 offen nt lds
    v_mfma_f32_16x16x32_bf16 v[32:35], a[168:171], a[36:39], v[32:35]
    buffer_load_dwordx4 v10, s[12:15], s36 offen offset:1056 nt lds
    buffer_load_dwordx4 v11, s[12:15], s36 offen offset:2112 nt lds
    v_mfma_f32_16x16x32_bf16 v[36:39], a[172:175], a[20:23], v[36:39]
    v_mfma_f32_16x16x32_bf16 v[40:43], a[172:175], a[24:27], v[40:43]
    v_mfma_f32_16x16x32_bf16 v[44:47], a[172:175], a[28:31], v[44:47]
    buffer_load_dwordx4 v12, s[12:15], s36 offen offset:3168 nt lds
    v_mfma_f32_16x16x32_bf16 v[48:51], a[172:175], a[32:35], v[48:51]
    v_mfma_f32_16x16x32_bf16 v[52:55], a[172:175], a[36:39], v[52:55]
    v_mfma_f32_16x16x32_bf16 v[16:19], a[176:179], a[40:43], v[16:19]
    s_waitcnt vmcnt(20)
    ds_read_b128 a[160:163], v232 offset:8448
    ds_read_b128 a[164:167], v232 offset:8960
    ds_read_b128 a[168:171], v232 offset:8512
    ds_read_b128 a[172:175], v232 offset:9024
    v_mfma_f32_16x16x32_bf16 v[20:23], a[176:179], a[44:47], v[20:23]
    v_mfma_f32_16x16x32_bf16 v[24:27], a[176:179], a[48:51], v[24:27]
    v_mfma_f32_16x16x32_bf16 v[28:31], a[176:179], a[52:55], v[28:31]
    v_mfma_f32_16x16x32_bf16 v[32:35], a[176:179], a[56:59], v[32:35]
    v_mfma_f32_16x16x32_bf16 v[36:39], a[180:183], a[40:43], v[36:39]
    v_mfma_f32_16x16x32_bf16 v[40:43], a[180:183], a[44:47], v[40:43]
    v_mfma_f32_16x16x32_bf16 v[44:47], a[180:183], a[48:51], v[44:47]
    v_mfma_f32_16x16x32_bf16 v[48:51], a[180:183], a[52:55], v[48:51]
    s_add_u32 m0, s29, 8448
    s_add_u32 s37, s92, 131072
    s_waitcnt lgkmcnt(0)
    buffer_load_dwordx4 v9, s[12:15], s37 offen nt lds
    v_mfma_f32_16x16x32_bf16 v[52:55], a[180:183], a[56:59], v[52:55]
    v_mfma_f32_16x16x32_bf16 v[16:19], a[184:187], a[60:63], v[16:19]
    v_mfma_f32_16x16x32_bf16 v[20:23], a[184:187], a[64:67], v[20:23]
    buffer_load_dwordx4 v10, s[12:15], s37 offen offset:1056 nt lds
    v_mfma_f32_16x16x32_bf16 v[24:27], a[184:187], a[68:71], v[24:27]
    v_mfma_f32_16x16x32_bf16 v[28:31], a[184:187], a[72:75], v[28:31]
    v_mfma_f32_16x16x32_bf16 v[32:35], a[184:187], a[76:79], v[32:35]
    buffer_load_dwordx4 v11, s[12:15], s37 offen offset:2112 nt lds
    v_mfma_f32_16x16x32_bf16 v[36:39], a[188:191], a[60:63], v[36:39]
    v_mfma_f32_16x16x32_bf16 v[40:43], a[188:191], a[64:67], v[40:43]
    v_mfma_f32_16x16x32_bf16 v[44:47], a[188:191], a[68:71], v[44:47]
    buffer_load_dwordx4 v12, s[12:15], s37 offen offset:3168 nt lds
    v_mfma_f32_16x16x32_bf16 v[48:51], a[188:191], a[72:75], v[48:51]
    v_mfma_f32_16x16x32_bf16 v[52:55], a[188:191], a[76:79], v[52:55]
    v_mfma_f32_16x16x32_bf16 v[16:19], a[160:163], a[80:83], v[16:19]
    s_waitcnt vmcnt(20)
    ds_read_b128 a[176:179], v232 offset:12672
    ds_read_b128 a[180:183], v232 offset:13184
    ds_read_b128 a[184:187], v232 offset:12736
    ds_read_b128 a[188:191], v232 offset:13248
    v_mfma_f32_16x16x32_bf16 v[20:23], a[160:163], a[84:87], v[20:23]
    v_mfma_f32_16x16x32_bf16 v[24:27], a[160:163], a[88:91], v[24:27]
    v_mfma_f32_16x16x32_bf16 v[28:31], a[160:163], a[92:95], v[28:31]
    v_mfma_f32_16x16x32_bf16 v[32:35], a[160:163], a[96:99], v[32:35]
    v_mfma_f32_16x16x32_bf16 v[36:39], a[164:167], a[80:83], v[36:39]
    v_mfma_f32_16x16x32_bf16 v[40:43], a[164:167], a[84:87], v[40:43]
    v_mfma_f32_16x16x32_bf16 v[44:47], a[164:167], a[88:91], v[44:47]
    v_mfma_f32_16x16x32_bf16 v[48:51], a[164:167], a[92:95], v[48:51]
    s_mov_b32 s38, 512
    v_mad_u32_u24 v233, v5, s38, v7
    s_mul_i32 s39, s28, 128
    v_add_u32 v233, s39, v233
    v_mfma_f32_16x16x32_bf16 v[52:55], a[164:167], a[96:99], v[52:55]
    v_add_u32 v234, 96, v233
    v_add_u32 v235, 2112, v233
    v_add_u32 v236, 2080, v233
    v_add_u32 v233, 128, v233
    v_mfma_f32_16x16x32_bf16 v[16:19], a[168:171], a[100:103], v[16:19]
    s_add_u32 m0, s29, 12672
    s_add_u32 s32, s96, 0
    s_waitcnt lgkmcnt(0)
    buffer_load_dwordx4 v233, s[16:19], s32 offen nt lds
    v_mfma_f32_16x16x32_bf16 v[20:23], a[168:171], a[104:107], v[20:23]
    buffer_load_dwordx4 v234, s[16:19], s32 offen offset:1056 nt lds
    v_mfma_f32_16x16x32_bf16 v[24:27], a[168:171], a[108:111], v[24:27]
    v_mfma_f32_16x16x32_bf16 v[28:31], a[168:171], a[112:115], v[28:31]
    v_mfma_f32_16x16x32_bf16 v[32:35], a[168:171], a[116:119], v[32:35]
    buffer_load_dwordx4 v235, s[16:19], s32 offen offset:2112 nt lds
    v_mfma_f32_16x16x32_bf16 v[36:39], a[172:175], a[100:103], v[36:39]
    v_mfma_f32_16x16x32_bf16 v[40:43], a[172:175], a[104:107], v[40:43]
    v_mfma_f32_16x16x32_bf16 v[44:47], a[172:175], a[108:111], v[44:47]
    buffer_load_dwordx4 v236, s[16:19], s32 offen offset:3168 nt lds
    v_mfma_f32_16x16x32_bf16 v[48:51], a[172:175], a[112:115], v[48:51]
    v_mfma_f32_16x16x32_bf16 v[52:55], a[172:175], a[116:119], v[52:55]
    v_mfma_f32_16x16x32_bf16 v[16:19], a[176:179], a[120:123], v[16:19]
    s_waitcnt vmcnt(20)
    ds_read_b128 a[160:163], v232 offset:0
    ds_read_b128 a[164:167], v232 offset:512
    ds_read_b128 a[168:171], v232 offset:64
    ds_read_b128 a[172:175], v232 offset:576
    v_mfma_f32_16x16x32_bf16 v[20:23], a[176:179], a[124:127], v[20:23]
    v_mfma_f32_16x16x32_bf16 v[24:27], a[176:179], a[128:131], v[24:27]
    v_mfma_f32_16x16x32_bf16 v[28:31], a[176:179], a[132:135], v[28:31]
    v_mfma_f32_16x16x32_bf16 v[32:35], a[176:179], a[136:139], v[32:35]
    v_mfma_f32_16x16x32_bf16 v[36:39], a[180:183], a[120:123], v[36:39]
    v_mfma_f32_16x16x32_bf16 v[40:43], a[180:183], a[124:127], v[40:43]
    v_mfma_f32_16x16x32_bf16 v[44:47], a[180:183], a[128:131], v[44:47]
    v_mfma_f32_16x16x32_bf16 v[48:51], a[180:183], a[132:135], v[48:51]
    s_add_u32 m0, s29, 0
    s_add_u32 s33, s93, 131072
    s_waitcnt lgkmcnt(0)
    buffer_load_dwordx4 v9, s[12:15], s33 offen nt lds
    v_mfma_f32_16x16x32_bf16 v[52:55], a[180:183], a[136:139], v[52:55]
    v_mfma_f32_16x16x32_bf16 v[16:19], a[184:187], a[140:143], v[16:19]
    v_mfma_f32_16x16x32_bf16 v[20:23], a[184:187], a[144:147], v[20:23]
    buffer_load_dwordx4 v10, s[12:15], s33 offen offset:1056 nt lds
    v_mfma_f32_16x16x32_bf16 v[24:27], a[184:187], a[148:151], v[24:27]
    v_mfma_f32_16x16x32_bf16 v[28:31], a[184:187], a[152:155], v[28:31]
    v_mfma_f32_16x16x32_bf16 v[32:35], a[184:187], a[156:159], v[32:35]
    buffer_load_dwordx4 v11, s[12:15], s33 offen offset:2112 nt lds
    v_mfma_f32_16x16x32_bf16 v[36:39], a[188:191], a[140:143], v[36:39]
    v_mfma_f32_16x16x32_bf16 v[40:43], a[188:191], a[144:147], v[40:43]
    v_mfma_f32_16x16x32_bf16 v[44:47], a[188:191], a[148:151], v[44:47]
    buffer_load_dwordx4 v12, s[12:15], s33 offen offset:3168 nt lds
    v_mfma_f32_16x16x32_bf16 v[48:51], a[188:191], a[152:155], v[48:51]
    v_mfma_f32_16x16x32_bf16 v[52:55], a[188:191], a[156:159], v[52:55]
    v_mfma_f32_16x16x32_bf16 v[56:59], a[160:163], a[0:3], 0
    s_waitcnt vmcnt(20)
    ds_read_b128 a[176:179], v232 offset:4224
    ds_read_b128 a[180:183], v232 offset:4736
    ds_read_b128 a[184:187], v232 offset:4288
    ds_read_b128 a[188:191], v232 offset:4800
    v_mfma_f32_16x16x32_bf16 v[60:63], a[160:163], a[4:7], 0
    v_max3_f32 v244, v16, v17, v18
    v_max3_f32 v244, v244, v19, v36
    v_max3_f32 v244, v244, v37, v38
    v_max_f32 v244, v244, v39
    v_mfma_f32_16x16x32_bf16 v[64:67], a[160:163], a[8:11], 0
    v_max3_f32 v245, v20, v21, v22
    v_max3_f32 v245, v245, v23, v40
    v_max3_f32 v245, v245, v41, v42
    v_max_f32 v245, v245, v43
    v_mfma_f32_16x16x32_bf16 v[68:71], a[160:163], a[12:15], 0
    v_max3_f32 v246, v24, v25, v26
    v_max3_f32 v246, v246, v27, v44
    v_max3_f32 v246, v246, v45, v46
    v_max_f32 v246, v246, v47
    v_mfma_f32_16x16x32_bf16 v[72:75], a[160:163], a[16:19], 0
    v_max3_f32 v247, v28, v29, v30
    v_max3_f32 v247, v247, v31, v48
    v_max3_f32 v247, v247, v49, v50
    v_max_f32 v247, v247, v51
    v_mfma_f32_16x16x32_bf16 v[76:79], a[164:167], a[0:3], 0
    v_max3_f32 v248, v32, v33, v34
    v_max3_f32 v248, v248, v35, v52
    v_max3_f32 v248, v248, v53, v54
    v_max_f32 v248, v248, v55
    v_mfma_f32_16x16x32_bf16 v[80:83], a[164:167], a[4:7], 0
    v_mov_b32 v216, v244
    v_mov_b32 v217, v245
    v_mov_b32 v218, v246
    v_mov_b32 v219, v247
    v_mfma_f32_16x16x32_bf16 v[84:87], a[164:167], a[8:11], 0
    v_mov_b32 v220, v248
    v_permlane32_swap_b32 v216, v244
    v_permlane32_swap_b32 v217, v245
    v_permlane32_swap_b32 v218, v246
    v_mfma_f32_16x16x32_bf16 v[88:91], a[164:167], a[12:15], 0
    s_add_u32 m0, s29, 4224
    s_add_u32 s34, s97, 0
    s_waitcnt lgkmcnt(0)
    buffer_load_dwordx4 v233, s[16:19], s34 offen nt lds
    v_permlane32_swap_b32 v219, v247
    v_mfma_f32_16x16x32_bf16 v[92:95], a[164:167], a[16:19], 0
    v_permlane32_swap_b32 v220, v248
    v_max_f32 v244, v244, v216
    v_max_f32 v245, v245, v217
    v_max_f32 v246, v246, v218
    v_mfma_f32_16x16x32_bf16 v[56:59], a[168:171], a[20:23], v[56:59]
    v_max_f32 v247, v247, v219
    v_max_f32 v248, v248, v220
    v_mov_b32 v216, v244
    v_mov_b32 v217, v245
    v_mfma_f32_16x16x32_bf16 v[60:63], a[168:171], a[24:27], v[60:63]
    buffer_load_dwordx4 v234, s[16:19], s34 offen offset:1056 nt lds
    v_mov_b32 v218, v246
    v_mov_b32 v219, v247
    v_mov_b32 v220, v248
    v_mfma_f32_16x16x32_bf16 v[64:67], a[168:171], a[28:31], v[64:67]
    v_permlane16_swap_b32 v216, v244
    v_permlane16_swap_b32 v217, v245
    v_permlane16_swap_b32 v218, v246
    v_permlane16_swap_b32 v219, v247
    v_mfma_f32_16x16x32_bf16 v[68:71], a[168:171], a[32:35], v[68:71]
    v_permlane16_swap_b32 v220, v248
    v_max_f32 v244, v244, v216
    v_max_f32 v245, v245, v217
    v_max_f32 v246, v246, v218
    v_mfma_f32_16x16x32_bf16 v[72:75], a[168:171], a[36:39], v[72:75]
    buffer_load_dwordx4 v235, s[16:19], s34 offen offset:2112 nt lds
    v_max_f32 v247, v247, v219
    v_max_f32 v248, v248, v220
    s_lshl_b32 s74, s28, 2
    v_mfma_f32_16x16x32_bf16 v[76:79], a[172:175], a[20:23], v[76:79]
    v_lshlrev_b32 v15, 4, v3
    v_add_u32 v14, s74, v15
    ds_write_b32 v14, v244 offset:40960
    ds_write_b32 v14, v245 offset:41216
    v_mfma_f32_16x16x32_bf16 v[80:83], a[172:175], a[24:27], v[80:83]
    ds_write_b32 v14, v246 offset:41472
    ds_write_b32 v14, v247 offset:41728
    ds_write_b32 v14, v248 offset:41984
    s_waitcnt lgkmcnt(0)
    s_barrier
    v_mfma_f32_16x16x32_bf16 v[84:87], a[172:175], a[28:31], v[84:87]
    buffer_load_dwordx4 v236, s[16:19], s34 offen offset:3168 nt lds
    ds_read_b128 v[176:179], v15 offset:40960
    ds_read_b128 v[180:183], v15 offset:41216
    ds_read_b128 v[184:187], v15 offset:41472
    v_mfma_f32_16x16x32_bf16 v[88:91], a[172:175], a[32:35], v[88:91]
    ds_read_b128 v[188:191], v15 offset:41728
    ds_read_b128 v[192:195], v15 offset:41984
    s_waitcnt lgkmcnt(4)
    v_max3_f32 v176, v176, v177, v178
    v_max_f32 v244, v176, v179
    v_mfma_f32_16x16x32_bf16 v[92:95], a[172:175], a[36:39], v[92:95]
    s_waitcnt lgkmcnt(3)
    v_max3_f32 v180, v180, v181, v182
    v_max_f32 v245, v180, v183
    s_waitcnt lgkmcnt(2)
    v_max3_f32 v184, v184, v185, v186
    v_max_f32 v246, v184, v187
    v_mfma_f32_16x16x32_bf16 v[56:59], a[176:179], a[40:43], v[56:59]
    s_waitcnt vmcnt(20)
    ds_read_b128 a[160:163], v232 offset:16896
    ds_read_b128 a[164:167], v232 offset:17408
    ds_read_b128 a[168:171], v232 offset:16960
    ds_read_b128 a[172:175], v232 offset:17472
    v_mfma_f32_16x16x32_bf16 v[60:63], a[176:179], a[44:47], v[60:63]
    s_waitcnt lgkmcnt(5)
    v_max3_f32 v188, v188, v189, v190
    v_max_f32 v247, v188, v191
    s_waitcnt lgkmcnt(4)
    v_max3_f32 v192, v192, v193, v194
    v_max_f32 v248, v192, v195
    v_mfma_f32_16x16x32_bf16 v[64:67], a[176:179], a[48:51], v[64:67]
    v_accvgpr_read_b32 v216, a192
    v_max_f32 v244, v244, v216
    v_accvgpr_read_b32 v217, a193
    v_max_f32 v245, v245, v217
    v_mfma_f32_16x16x32_bf16 v[68:71], a[176:179], a[52:55], v[68:71]
    v_accvgpr_read_b32 v218, a194
    v_max_f32 v246, v246, v218
    v_accvgpr_read_b32 v219, a195
    v_max_f32 v247, v247, v219
    v_mfma_f32_16x16x32_bf16 v[72:75], a[176:179], a[56:59], v[72:75]
    v_accvgpr_read_b32 v220, a196
    v_max_f32 v248, v248, v220
    v_mul_f32 v244, s30, v244
    v_mov_b32 v249, 0
    v_mfma_f32_16x16x32_bf16 v[76:79], a[180:183], a[40:43], v[76:79]
    v_mul_f32 v245, s30, v245
    v_mov_b32 v250, 0
    v_mul_f32 v246, s30, v246
    v_mov_b32 v251, 0
    v_mfma_f32_16x16x32_bf16 v[80:83], a[180:183], a[44:47], v[80:83]
    v_mul_f32 v247, s30, v247
    v_mov_b32 v252, 0
    v_mul_f32 v248, s30, v248
    v_mov_b32 v253, 0
    v_mfma_f32_16x16x32_bf16 v[84:87], a[180:183], a[48:51], v[84:87]
    v_fma_f32 v16, v16, s30, -v244
    v_fma_f32 v17, v17, s30, -v244
    v_fma_f32 v18, v18, s30, -v244
    v_fma_f32 v19, v19, s30, -v244
    v_mfma_f32_16x16x32_bf16 v[88:91], a[180:183], a[52:55], v[88:91]
    s_add_u32 m0, s29, 16896
    s_add_u32 s35, s94, 131072
    s_waitcnt lgkmcnt(0)
    buffer_load_dwordx4 v9, s[12:15], s35 offen nt lds
    v_exp_f32 v16, v16
    v_mfma_f32_16x16x32_bf16 v[92:95], a[180:183], a[56:59], v[92:95]
    v_exp_f32 v17, v17
    v_exp_f32 v18, v18
    v_mfma_f32_16x16x32_bf16 v[56:59], a[184:187], a[60:63], v[56:59]
    v_exp_f32 v19, v19
    v_cvt_pk_bf16_f32 v216, v16, v17
    v_add_f32 v249, v249, v16
    v_mfma_f32_16x16x32_bf16 v[60:63], a[184:187], a[64:67], v[60:63]
    buffer_load_dwordx4 v10, s[12:15], s35 offen offset:1056 nt lds
    v_cvt_pk_bf16_f32 v217, v18, v19
    v_add_f32 v249, v249, v17
    ds_write_b64 v242, v[216:217] offset:0
    v_mfma_f32_16x16x32_bf16 v[64:67], a[184:187], a[68:71], v[64:67]
    v_add_f32 v249, v249, v18
    v_add_f32 v249, v249, v19
    v_fma_f32 v36, v36, s30, -v244
    v_fma_f32 v37, v37, s30, -v244
    v_mfma_f32_16x16x32_bf16 v[68:71], a[184:187], a[72:75], v[68:71]
    v_fma_f32 v38, v38, s30, -v244
    v_fma_f32 v39, v39, s30, -v244
    v_exp_f32 v36, v36
    v_mfma_f32_16x16x32_bf16 v[72:75], a[184:187], a[76:79], v[72:75]
    buffer_load_dwordx4 v11, s[12:15], s35 offen offset:2112 nt lds
    v_exp_f32 v37, v37
    v_exp_f32 v38, v38
    v_mfma_f32_16x16x32_bf16 v[76:79], a[188:191], a[60:63], v[76:79]
    v_exp_f32 v39, v39
    v_cvt_pk_bf16_f32 v218, v36, v37
    v_add_f32 v249, v249, v36
    v_mfma_f32_16x16x32_bf16 v[80:83], a[188:191], a[64:67], v[80:83]
    v_cvt_pk_bf16_f32 v219, v38, v39
    v_add_f32 v249, v249, v37
    ds_write_b64 v243, v[218:219] offset:0
    v_add_f32 v249, v249, v38
    v_mfma_f32_16x16x32_bf16 v[84:87], a[188:191], a[68:71], v[84:87]
    buffer_load_dwordx4 v12, s[12:15], s35 offen offset:3168 nt lds
    v_add_f32 v249, v249, v39
    v_fma_f32 v20, v20, s30, -v245
    v_fma_f32 v21, v21, s30, -v245
    v_mfma_f32_16x16x32_bf16 v[88:91], a[188:191], a[72:75], v[88:91]
    v_fma_f32 v22, v22, s30, -v245
    v_fma_f32 v23, v23, s30, -v245
    v_exp_f32 v20, v20
    v_mfma_f32_16x16x32_bf16 v[92:95], a[188:191], a[76:79], v[92:95]
    v_exp_f32 v21, v21
    v_exp_f32 v22, v22
    v_mfma_f32_16x16x32_bf16 v[56:59], a[160:163], a[80:83], v[56:59]
    s_waitcnt vmcnt(20)
    ds_read_b128 a[176:179], v232 offset:21120
    ds_read_b128 a[180:183], v232 offset:21632
    ds_read_b128 a[184:187], v232 offset:21184
    ds_read_b128 a[188:191], v232 offset:21696
    v_mfma_f32_16x16x32_bf16 v[60:63], a[160:163], a[84:87], v[60:63]
    v_exp_f32 v23, v23
    v_cvt_pk_bf16_f32 v220, v20, v21
    v_add_f32 v250, v250, v20
    v_mfma_f32_16x16x32_bf16 v[64:67], a[160:163], a[88:91], v[64:67]
    v_cvt_pk_bf16_f32 v221, v22, v23
    v_add_f32 v250, v250, v21
    ds_write_b64 v242, v[220:221] offset:4096
    v_add_f32 v250, v250, v22
    v_mfma_f32_16x16x32_bf16 v[68:71], a[160:163], a[92:95], v[68:71]
    v_add_f32 v250, v250, v23
    v_fma_f32 v40, v40, s30, -v245
    v_fma_f32 v41, v41, s30, -v245
    v_fma_f32 v42, v42, s30, -v245
    v_mfma_f32_16x16x32_bf16 v[72:75], a[160:163], a[96:99], v[72:75]
    v_fma_f32 v43, v43, s30, -v245
    v_exp_f32 v40, v40
    v_exp_f32 v41, v41
    v_mfma_f32_16x16x32_bf16 v[76:79], a[164:167], a[80:83], v[76:79]
    v_exp_f32 v42, v42
    v_exp_f32 v43, v43
    v_mfma_f32_16x16x32_bf16 v[80:83], a[164:167], a[84:87], v[80:83]
    v_cvt_pk_bf16_f32 v222, v40, v41
    v_add_f32 v250, v250, v40
    v_cvt_pk_bf16_f32 v223, v42, v43
    v_add_f32 v250, v250, v41
    v_mfma_f32_16x16x32_bf16 v[84:87], a[164:167], a[88:91], v[84:87]
    ds_write_b64 v243, v[222:223] offset:4096
    v_add_f32 v250, v250, v42
    v_add_f32 v250, v250, v43
    v_fma_f32 v24, v24, s30, -v246
    v_mfma_f32_16x16x32_bf16 v[88:91], a[164:167], a[92:95], v[88:91]
    s_add_u32 m0, s29, 21120
    s_add_u32 s36, s98, 0
    s_waitcnt lgkmcnt(2)
    buffer_load_dwordx4 v233, s[16:19], s36 offen nt lds
    v_fma_f32 v25, v25, s30, -v246
    v_mfma_f32_16x16x32_bf16 v[92:95], a[164:167], a[96:99], v[92:95]
    v_fma_f32 v26, v26, s30, -v246
    v_fma_f32 v27, v27, s30, -v246
    v_exp_f32 v24, v24
    v_mfma_f32_16x16x32_bf16 v[56:59], a[168:171], a[100:103], v[56:59]
    v_exp_f32 v25, v25
    v_exp_f32 v26, v26
    v_mfma_f32_16x16x32_bf16 v[60:63], a[168:171], a[104:107], v[60:63]
    buffer_load_dwordx4 v234, s[16:19], s36 offen offset:1056 nt lds
    v_exp_f32 v27, v27
    v_cvt_pk_bf16_f32 v224, v24, v25
    v_mfma_f32_16x16x32_bf16 v[64:67], a[168:171], a[108:111], v[64:67]
    v_add_f32 v251, v251, v24
    v_cvt_pk_bf16_f32 v225, v26, v27
    v_add_f32 v251, v251, v25
    ds_write_b64 v242, v[224:225] offset:8192
    v_mfma_f32_16x16x32_bf16 v[68:71], a[168:171], a[112:115], v[68:71]
    v_add_f32 v251, v251, v26
    v_add_f32 v251, v251, v27
    v_fma_f32 v44, v44, s30, -v246
    v_fma_f32 v45, v45, s30, -v246
    v_mfma_f32_16x16x32_bf16 v[72:75], a[168:171], a[116:119], v[72:75]
    buffer_load_dwordx4 v235, s[16:19], s36 offen offset:2112 nt lds
    v_fma_f32 v46, v46, s30, -v246
    v_fma_f32 v47, v47, s30, -v246
    v_exp_f32 v44, v44
    v_mfma_f32_16x16x32_bf16 v[76:79], a[172:175], a[100:103], v[76:79]
    v_exp_f32 v45, v45
    v_exp_f32 v46, v46
    v_mfma_f32_16x16x32_bf16 v[80:83], a[172:175], a[104:107], v[80:83]
    v_exp_f32 v47, v47
    v_cvt_pk_bf16_f32 v226, v44, v45
    v_add_f32 v251, v251, v44
    v_mfma_f32_16x16x32_bf16 v[84:87], a[172:175], a[108:111], v[84:87]
    buffer_load_dwordx4 v236, s[16:19], s36 offen offset:3168 nt lds
    v_cvt_pk_bf16_f32 v227, v46, v47
    v_add_f32 v251, v251, v45
    ds_write_b64 v243, v[226:227] offset:8192
    v_mfma_f32_16x16x32_bf16 v[88:91], a[172:175], a[112:115], v[88:91]
    v_add_f32 v251, v251, v46
    v_add_f32 v251, v251, v47
    v_fma_f32 v28, v28, s30, -v247
    v_fma_f32 v29, v29, s30, -v247
    v_mfma_f32_16x16x32_bf16 v[92:95], a[172:175], a[116:119], v[92:95]
    v_fma_f32 v30, v30, s30, -v247
    v_fma_f32 v31, v31, s30, -v247
    v_exp_f32 v28, v28
    v_mfma_f32_16x16x32_bf16 v[56:59], a[176:179], a[120:123], v[56:59]
    v_exp_f32 v29, v29
    v_exp_f32 v30, v30
    v_mfma_f32_16x16x32_bf16 v[60:63], a[176:179], a[124:127], v[60:63]
    v_exp_f32 v31, v31
    v_cvt_pk_bf16_f32 v228, v28, v29
    v_add_f32 v252, v252, v28
    v_mfma_f32_16x16x32_bf16 v[64:67], a[176:179], a[128:131], v[64:67]
    v_cvt_pk_bf16_f32 v229, v30, v31
    v_add_f32 v252, v252, v29
    ds_write_b64 v242, v[228:229] offset:12288
    v_add_f32 v252, v252, v30
    v_mfma_f32_16x16x32_bf16 v[68:71], a[176:179], a[132:135], v[68:71]
    v_add_f32 v252, v252, v31
    v_fma_f32 v48, v48, s30, -v247
    v_fma_f32 v49, v49, s30, -v247
    v_fma_f32 v50, v50, s30, -v247
    v_mfma_f32_16x16x32_bf16 v[72:75], a[176:179], a[136:139], v[72:75]
    v_fma_f32 v51, v51, s30, -v247
    v_exp_f32 v48, v48
    v_exp_f32 v49, v49
    v_mfma_f32_16x16x32_bf16 v[76:79], a[180:183], a[120:123], v[76:79]
    v_exp_f32 v50, v50
    v_exp_f32 v51, v51
    v_mfma_f32_16x16x32_bf16 v[80:83], a[180:183], a[124:127], v[80:83]
    v_cvt_pk_bf16_f32 v230, v48, v49
    v_add_f32 v252, v252, v48
    v_cvt_pk_bf16_f32 v231, v50, v51
    v_add_f32 v252, v252, v49
    v_mfma_f32_16x16x32_bf16 v[84:87], a[180:183], a[128:131], v[84:87]
    ds_write_b64 v243, v[230:231] offset:12288
    v_add_f32 v252, v252, v50
    v_add_f32 v252, v252, v51
    v_fma_f32 v32, v32, s30, -v248
    v_mfma_f32_16x16x32_bf16 v[88:91], a[180:183], a[132:135], v[88:91]
    v_fma_f32 v33, v33, s30, -v248
    v_fma_f32 v34, v34, s30, -v248
    v_fma_f32 v35, v35, s30, -v248
    v_exp_f32 v32, v32
    v_mfma_f32_16x16x32_bf16 v[92:95], a[180:183], a[136:139], v[92:95]
    v_exp_f32 v33, v33
    v_exp_f32 v34, v34
    v_mfma_f32_16x16x32_bf16 v[56:59], a[184:187], a[140:143], v[56:59]
    v_exp_f32 v35, v35
    v_cvt_pk_bf16_f32 v216, v32, v33
    v_add_f32 v253, v253, v32
    v_mfma_f32_16x16x32_bf16 v[60:63], a[184:187], a[144:147], v[60:63]
    v_cvt_pk_bf16_f32 v217, v34, v35
    v_add_f32 v253, v253, v33
    ds_write_b64 v242, v[216:217] offset:16384
    v_add_f32 v253, v253, v34
    v_mfma_f32_16x16x32_bf16 v[64:67], a[184:187], a[148:151], v[64:67]
    v_add_f32 v253, v253, v35
    v_fma_f32 v52, v52, s30, -v248
    v_fma_f32 v53, v53, s30, -v248
    v_fma_f32 v54, v54, s30, -v248
    v_mfma_f32_16x16x32_bf16 v[68:71], a[184:187], a[152:155], v[68:71]
    v_fma_f32 v55, v55, s30, -v248
    v_exp_f32 v52, v52
    v_exp_f32 v53, v53
    v_mfma_f32_16x16x32_bf16 v[72:75], a[184:187], a[156:159], v[72:75]
    v_exp_f32 v54, v54
    v_exp_f32 v55, v55
    v_mfma_f32_16x16x32_bf16 v[76:79], a[188:191], a[140:143], v[76:79]
    v_cvt_pk_bf16_f32 v218, v52, v53
    v_add_f32 v253, v253, v52
    v_cvt_pk_bf16_f32 v219, v54, v55
    v_add_f32 v253, v253, v53
    v_mfma_f32_16x16x32_bf16 v[80:83], a[188:191], a[144:147], v[80:83]
    ds_write_b64 v243, v[218:219] offset:16384
    v_add_f32 v253, v253, v54
    v_add_f32 v253, v253, v55
    v_mfma_f32_16x16x32_bf16 v[84:87], a[188:191], a[148:151], v[84:87]
    v_mfma_f32_16x16x32_bf16 v[88:91], a[188:191], a[152:155], v[88:91]
    v_mfma_f32_16x16x32_bf16 v[92:95], a[188:191], a[156:159], v[92:95]
    s_waitcnt vmcnt(20)
    ds_read_b128 a[160:163], v232 offset:8448
    ds_read_b128 a[164:167], v232 offset:8960
    ds_read_b128 a[168:171], v232 offset:8512
    ds_read_b128 a[172:175], v232 offset:9024
    s_waitcnt vmcnt(16)
    ds_read_b64_tr_b16 a[224:225], v237 offset:12672
    ds_read_b64_tr_b16 a[226:227], v237 offset:12928
    ds_read_b64_tr_b16 a[228:229], v237 offset:12704
    ds_read_b64_tr_b16 a[230:231], v237 offset:12960
    ds_read_b64_tr_b16 a[232:233], v237 offset:12736
    ds_read_b64_tr_b16 a[234:235], v237 offset:12992
    ds_read_b64_tr_b16 a[236:237], v237 offset:12768
    ds_read_b64_tr_b16 a[238:239], v237 offset:13024
    s_waitcnt lgkmcnt(12)
    s_barrier
    s_add_u32 m0, s29, 8448
    s_add_u32 s37, s95, 131072
    s_waitcnt lgkmcnt(8)
    buffer_load_dwordx4 v9, s[12:15], s37 offen nt lds
    buffer_load_dwordx4 v10, s[12:15], s37 offen offset:1056 nt lds
    buffer_load_dwordx4 v11, s[12:15], s37 offen offset:2112 nt lds
    buffer_load_dwordx4 v12, s[12:15], s37 offen offset:3168 nt lds
    s_add_u32 m0, s29, 12672
    s_add_u32 s38, s99, 0
    s_waitcnt lgkmcnt(0)
    buffer_load_dwordx4 v233, s[16:19], s38 offen nt lds
    buffer_load_dwordx4 v234, s[16:19], s38 offen offset:1056 nt lds
    buffer_load_dwordx4 v235, s[16:19], s38 offen offset:2112 nt lds
    buffer_load_dwordx4 v236, s[16:19], s38 offen offset:3168 nt lds
    v_mfma_f32_16x16x32_bf16 v[16:19], a[160:163], a[0:3], 0
    s_waitcnt vmcnt(20)
    ds_read_b128 a[176:179], v232 offset:0
    ds_read_b128 a[180:183], v232 offset:512
    ds_read_b128 a[184:187], v232 offset:64
    ds_read_b128 a[188:191], v232 offset:576
    ds_read_b128 v[176:179], v238 offset:0
    v_mfma_f32_16x16x32_bf16 v[20:23], a[160:163], a[4:7], 0
    ds_read_b128 v[180:183], v238 offset:4096
    ds_read_b128 v[184:187], v238 offset:8192
    ds_read_b128 v[188:191], v238 offset:12288
    ds_read_b128 v[192:195], v238 offset:16384
    s_waitcnt vmcnt(16)
    ds_read_b64_tr_b16 a[240:241], v237 offset:4224
    v_mfma_f32_16x16x32_bf16 v[24:27], a[160:163], a[8:11], 0
    ds_read_b64_tr_b16 a[242:243], v237 offset:4480
    ds_read_b64_tr_b16 a[244:245], v237 offset:4256
    ds_read_b64_tr_b16 a[246:247], v237 offset:4512
    ds_read_b64_tr_b16 a[248:249], v237 offset:4288
    ds_read_b64_tr_b16 a[250:251], v237 offset:4544
    v_mfma_f32_16x16x32_bf16 v[28:31], a[160:163], a[12:15], 0
    ds_read_b64_tr_b16 a[252:253], v237 offset:4320
    ds_read_b64_tr_b16 a[254:255], v237 offset:4576
    v_fma_f32 v56, v56, s30, -v244
    v_fma_f32 v57, v57, s30, -v244
    v_fma_f32 v58, v58, s30, -v244
    v_mfma_f32_16x16x32_bf16 v[32:35], a[160:163], a[16:19], 0
    v_fma_f32 v59, v59, s30, -v244
    v_exp_f32 v56, v56
    v_exp_f32 v57, v57
    v_mfma_f32_16x16x32_bf16 v[36:39], a[164:167], a[0:3], 0
    v_exp_f32 v58, v58
    v_exp_f32 v59, v59
    v_cvt_pk_bf16_f32 v220, v56, v57
    v_mfma_f32_16x16x32_bf16 v[40:43], a[164:167], a[4:7], 0
    v_add_f32 v249, v249, v56
    v_cvt_pk_bf16_f32 v221, v58, v59
    v_add_f32 v249, v249, v57
    ds_write_b64 v242, v[220:221] offset:20480
    v_add_f32 v249, v249, v58
    v_mfma_f32_16x16x32_bf16 v[44:47], a[164:167], a[8:11], 0
    v_add_f32 v249, v249, v59
    ds_read_b128 v[196:199], v239 offset:0
    ds_read_b128 v[200:203], v239 offset:4096
    ds_read_b128 v[204:207], v239 offset:8192
    ds_read_b128 v[208:211], v239 offset:12288
    v_mfma_f32_16x16x32_bf16 v[48:51], a[164:167], a[12:15], 0
    ds_read_b128 v[212:215], v239 offset:16384
    s_add_u32 m0, s29, 0
    s_add_u32 s39, s92, 196608
    s_waitcnt lgkmcnt(15)
    buffer_load_dwordx4 v9, s[12:15], s39 offen nt lds
    v_mfma_f32_16x16x32_bf16 v[52:55], a[164:167], a[16:19], 0
    v_mfma_f32_16x16x32_bf16 v[96:99], a[224:227], v[176:179], 0
    v_mfma_f32_16x16x32_bf16 v[100:103], a[224:227], v[180:183], 0
    buffer_load_dwordx4 v10, s[12:15], s39 offen offset:1056 nt lds
    v_mfma_f32_16x16x32_bf16 v[104:107], a[224:227], v[184:187], 0
    v_mfma_f32_16x16x32_bf16 v[108:111], a[224:227], v[188:191], 0
    s_waitcnt lgkmcnt(14)
    v_mfma_f32_16x16x32_bf16 v[112:115], a[224:227], v[192:195], 0
    v_fma_f32 v76, v76, s30, -v244
    v_fma_f32 v77, v77, s30, -v244
    v_fma_f32 v78, v78, s30, -v244
    v_fma_f32 v79, v79, s30, -v244
    v_exp_f32 v76, v76
    v_mfma_f32_16x16x32_bf16 v[116:119], a[228:231], v[176:179], 0
    v_exp_f32 v77, v77
    v_exp_f32 v78, v78
    v_exp_f32 v79, v79
    v_mfma_f32_16x16x32_bf16 v[120:123], a[228:231], v[180:183], 0
    v_cvt_pk_bf16_f32 v222, v76, v77
    v_add_f32 v249, v249, v76
    v_cvt_pk_bf16_f32 v223, v78, v79
    v_add_f32 v249, v249, v77
    ds_write_b64 v243, v[222:223] offset:20480
    v_mfma_f32_16x16x32_bf16 v[124:127], a[228:231], v[184:187], 0
    v_add_f32 v249, v249, v78
    v_add_f32 v249, v249, v79
    buffer_load_dwordx4 v11, s[12:15], s39 offen offset:2112 nt lds
    buffer_load_dwordx4 v12, s[12:15], s39 offen offset:3168 nt lds
    v_mfma_f32_16x16x32_bf16 v[128:131], a[228:231], v[188:191], 0
    v_mfma_f32_16x16x32_bf16 v[132:135], a[228:231], v[192:195], 0
    v_mfma_f32_16x16x32_bf16 v[16:19], a[168:171], a[20:23], v[16:19]
    v_mfma_f32_16x16x32_bf16 v[20:23], a[168:171], a[24:27], v[20:23]
    v_mfma_f32_16x16x32_bf16 v[24:27], a[168:171], a[28:31], v[24:27]
    v_mfma_f32_16x16x32_bf16 v[28:31], a[168:171], a[32:35], v[28:31]
    v_mfma_f32_16x16x32_bf16 v[32:35], a[168:171], a[36:39], v[32:35]
    s_add_u32 m0, s29, 4224
    s_add_u32 s32, s96, 65536
    s_waitcnt lgkmcnt(7)
    buffer_load_dwordx4 v233, s[16:19], s32 offen nt lds
    v_mfma_f32_16x16x32_bf16 v[36:39], a[172:175], a[20:23], v[36:39]
    v_mfma_f32_16x16x32_bf16 v[40:43], a[172:175], a[24:27], v[40:43]
    v_mfma_f32_16x16x32_bf16 v[44:47], a[172:175], a[28:31], v[44:47]
    buffer_load_dwordx4 v234, s[16:19], s32 offen offset:1056 nt lds
    v_mfma_f32_16x16x32_bf16 v[48:51], a[172:175], a[32:35], v[48:51]
    v_mfma_f32_16x16x32_bf16 v[52:55], a[172:175], a[36:39], v[52:55]
    v_fma_f32 v60, v60, s30, -v245
    v_fma_f32 v61, v61, s30, -v245
    v_fma_f32 v62, v62, s30, -v245
    v_fma_f32 v63, v63, s30, -v245
    v_exp_f32 v60, v60
    v_mfma_f32_16x16x32_bf16 v[136:139], a[232:235], v[176:179], 0
    v_exp_f32 v61, v61
    v_exp_f32 v62, v62
    v_exp_f32 v63, v63
    v_mfma_f32_16x16x32_bf16 v[140:143], a[232:235], v[180:183], 0
    v_cvt_pk_bf16_f32 v224, v60, v61
    v_add_f32 v250, v250, v60
    v_cvt_pk_bf16_f32 v225, v62, v63
    v_add_f32 v250, v250, v61
    ds_write_b64 v242, v[224:225] offset:24576
    v_mfma_f32_16x16x32_bf16 v[144:147], a[232:235], v[184:187], 0
    v_add_f32 v250, v250, v62
    v_add_f32 v250, v250, v63
    buffer_load_dwordx4 v235, s[16:19], s32 offen offset:2112 nt lds
    v_mfma_f32_16x16x32_bf16 v[148:151], a[232:235], v[188:191], 0
    buffer_load_dwordx4 v236, s[16:19], s32 offen offset:3168 nt lds
    v_mfma_f32_16x16x32_bf16 v[152:155], a[232:235], v[192:195], 0
    v_mfma_f32_16x16x32_bf16 v[156:159], a[236:239], v[176:179], 0
    v_mfma_f32_16x16x32_bf16 v[160:163], a[236:239], v[180:183], 0
    v_mfma_f32_16x16x32_bf16 v[164:167], a[236:239], v[184:187], 0
    v_mfma_f32_16x16x32_bf16 v[168:171], a[236:239], v[188:191], 0
    v_mfma_f32_16x16x32_bf16 v[172:175], a[236:239], v[192:195], 0
    ds_read_b128 v[176:179], v240 offset:0
    ds_read_b128 v[180:183], v240 offset:4096
    ds_read_b128 v[184:187], v240 offset:8192
    ds_read_b128 v[188:191], v240 offset:12288
    ds_read_b128 v[192:195], v240 offset:16384
    v_mfma_f32_16x16x32_bf16 v[16:19], a[176:179], a[40:43], v[16:19]
    s_waitcnt vmcnt(20)
    ds_read_b128 a[160:163], v232 offset:16896
    ds_read_b128 a[164:167], v232 offset:17408
    ds_read_b128 a[168:171], v232 offset:16960
    ds_read_b128 a[172:175], v232 offset:17472
    v_mfma_f32_16x16x32_bf16 v[20:23], a[176:179], a[44:47], v[20:23]
    s_waitcnt vmcnt(16)
    ds_read_b64_tr_b16 a[224:225], v237 offset:21120
    ds_read_b64_tr_b16 a[226:227], v237 offset:21376
    ds_read_b64_tr_b16 a[228:229], v237 offset:21152
    ds_read_b64_tr_b16 a[230:231], v237 offset:21408
    ds_read_b64_tr_b16 a[232:233], v237 offset:21184
    v_mfma_f32_16x16x32_bf16 v[24:27], a[176:179], a[48:51], v[24:27]
    ds_read_b64_tr_b16 a[234:235], v237 offset:21440
    ds_read_b64_tr_b16 a[236:237], v237 offset:21216
    ds_read_b64_tr_b16 a[238:239], v237 offset:21472
    v_mfma_f32_16x16x32_bf16 v[28:31], a[176:179], a[52:55], v[28:31]
    v_fma_f32 v80, v80, s30, -v245
    v_fma_f32 v81, v81, s30, -v245
    v_fma_f32 v82, v82, s30, -v245
    v_fma_f32 v83, v83, s30, -v245
    v_exp_f32 v80, v80
    v_mfma_f32_16x16x32_bf16 v[32:35], a[176:179], a[56:59], v[32:35]
    v_exp_f32 v81, v81
    v_exp_f32 v82, v82
    v_exp_f32 v83, v83
    v_mfma_f32_16x16x32_bf16 v[36:39], a[180:183], a[40:43], v[36:39]
    v_cvt_pk_bf16_f32 v226, v80, v81
    v_add_f32 v250, v250, v80
    v_cvt_pk_bf16_f32 v227, v82, v83
    v_add_f32 v250, v250, v81
    ds_write_b64 v243, v[226:227] offset:24576
    v_mfma_f32_16x16x32_bf16 v[40:43], a[180:183], a[44:47], v[40:43]
    v_add_f32 v250, v250, v82
    v_add_f32 v250, v250, v83
    v_mfma_f32_16x16x32_bf16 v[44:47], a[180:183], a[48:51], v[44:47]
    v_mfma_f32_16x16x32_bf16 v[48:51], a[180:183], a[52:55], v[48:51]
    s_add_u32 m0, s29, 16896
    s_add_u32 s33, s93, 196608
    s_waitcnt lgkmcnt(9)
    buffer_load_dwordx4 v9, s[12:15], s33 offen nt lds
    v_mfma_f32_16x16x32_bf16 v[52:55], a[180:183], a[56:59], v[52:55]
    v_mfma_f32_16x16x32_bf16 v[96:99], a[240:243], v[196:199], v[96:99]
    v_mfma_f32_16x16x32_bf16 v[100:103], a[240:243], v[200:203], v[100:103]
    buffer_load_dwordx4 v10, s[12:15], s33 offen offset:1056 nt lds
    v_mfma_f32_16x16x32_bf16 v[104:107], a[240:243], v[204:207], v[104:107]
    v_mfma_f32_16x16x32_bf16 v[108:111], a[240:243], v[208:211], v[108:111]
    v_mfma_f32_16x16x32_bf16 v[112:115], a[240:243], v[212:215], v[112:115]
    buffer_load_dwordx4 v11, s[12:15], s33 offen offset:2112 nt lds
    v_mfma_f32_16x16x32_bf16 v[116:119], a[244:247], v[196:199], v[116:119]
    v_mfma_f32_16x16x32_bf16 v[120:123], a[244:247], v[200:203], v[120:123]
    v_mfma_f32_16x16x32_bf16 v[124:127], a[244:247], v[204:207], v[124:127]
    buffer_load_dwordx4 v12, s[12:15], s33 offen offset:3168 nt lds
    v_mfma_f32_16x16x32_bf16 v[128:131], a[244:247], v[208:211], v[128:131]
    v_fma_f32 v64, v64, s30, -v246
    v_fma_f32 v65, v65, s30, -v246
    v_fma_f32 v66, v66, s30, -v246
    v_fma_f32 v67, v67, s30, -v246
    v_exp_f32 v64, v64
    v_mfma_f32_16x16x32_bf16 v[132:135], a[244:247], v[212:215], v[132:135]
    v_exp_f32 v65, v65
    v_exp_f32 v66, v66
    v_exp_f32 v67, v67
    v_mfma_f32_16x16x32_bf16 v[16:19], a[184:187], a[60:63], v[16:19]
    v_cvt_pk_bf16_f32 v228, v64, v65
    v_add_f32 v251, v251, v64
    v_cvt_pk_bf16_f32 v229, v66, v67
    v_add_f32 v251, v251, v65
    ds_write_b64 v242, v[228:229] offset:28672
    v_mfma_f32_16x16x32_bf16 v[20:23], a[184:187], a[64:67], v[20:23]
    v_add_f32 v251, v251, v66
    v_add_f32 v251, v251, v67
    v_mfma_f32_16x16x32_bf16 v[24:27], a[184:187], a[68:71], v[24:27]
    v_mfma_f32_16x16x32_bf16 v[28:31], a[184:187], a[72:75], v[28:31]
    v_mfma_f32_16x16x32_bf16 v[32:35], a[184:187], a[76:79], v[32:35]
    s_add_u32 m0, s29, 21120
    s_add_u32 s34, s97, 65536
    s_waitcnt lgkmcnt(2)
    buffer_load_dwordx4 v233, s[16:19], s34 offen nt lds
    v_mfma_f32_16x16x32_bf16 v[36:39], a[188:191], a[60:63], v[36:39]
    v_mfma_f32_16x16x32_bf16 v[40:43], a[188:191], a[64:67], v[40:43]
    v_mfma_f32_16x16x32_bf16 v[44:47], a[188:191], a[68:71], v[44:47]
    buffer_load_dwordx4 v234, s[16:19], s34 offen offset:1056 nt lds
    v_mfma_f32_16x16x32_bf16 v[48:51], a[188:191], a[72:75], v[48:51]
    v_mfma_f32_16x16x32_bf16 v[52:55], a[188:191], a[76:79], v[52:55]
    v_mfma_f32_16x16x32_bf16 v[136:139], a[248:251], v[196:199], v[136:139]
    buffer_load_dwordx4 v235, s[16:19], s34 offen offset:2112 nt lds
    v_mfma_f32_16x16x32_bf16 v[140:143], a[248:251], v[200:203], v[140:143]
    v_mfma_f32_16x16x32_bf16 v[144:147], a[248:251], v[204:207], v[144:147]
    v_fma_f32 v84, v84, s30, -v246
    v_fma_f32 v85, v85, s30, -v246
    v_fma_f32 v86, v86, s30, -v246
    v_fma_f32 v87, v87, s30, -v246
    v_exp_f32 v84, v84
    v_mfma_f32_16x16x32_bf16 v[148:151], a[248:251], v[208:211], v[148:151]
    v_exp_f32 v85, v85
    v_exp_f32 v86, v86
    v_exp_f32 v87, v87
    v_mfma_f32_16x16x32_bf16 v[152:155], a[248:251], v[212:215], v[152:155]
    v_cvt_pk_bf16_f32 v230, v84, v85
    v_add_f32 v251, v251, v84
    v_cvt_pk_bf16_f32 v231, v86, v87
    v_add_f32 v251, v251, v85
    ds_write_b64 v243, v[230:231] offset:28672
    v_mfma_f32_16x16x32_bf16 v[156:159], a[252:255], v[196:199], v[156:159]
    v_add_f32 v251, v251, v86
    v_add_f32 v251, v251, v87
    buffer_load_dwordx4 v236, s[16:19], s34 offen offset:3168 nt lds
    v_mfma_f32_16x16x32_bf16 v[160:163], a[252:255], v[200:203], v[160:163]
    v_mfma_f32_16x16x32_bf16 v[164:167], a[252:255], v[204:207], v[164:167]
    v_mfma_f32_16x16x32_bf16 v[168:171], a[252:255], v[208:211], v[168:171]
    v_mfma_f32_16x16x32_bf16 v[172:175], a[252:255], v[212:215], v[172:175]
    ds_read_b128 v[196:199], v241 offset:0
    ds_read_b128 v[200:203], v241 offset:4096
    ds_read_b128 v[204:207], v241 offset:8192
    ds_read_b128 v[208:211], v241 offset:12288
    ds_read_b128 v[212:215], v241 offset:16384
    v_mfma_f32_16x16x32_bf16 v[16:19], a[160:163], a[80:83], v[16:19]
    s_waitcnt vmcnt(20)
    ds_read_b128 a[176:179], v232 offset:8448
    ds_read_b128 a[180:183], v232 offset:8960
    ds_read_b128 a[184:187], v232 offset:8512
    ds_read_b128 a[188:191], v232 offset:9024
    v_mfma_f32_16x16x32_bf16 v[20:23], a[160:163], a[84:87], v[20:23]
    s_waitcnt vmcnt(16)
    ds_read_b64_tr_b16 a[240:241], v237 offset:12672
    ds_read_b64_tr_b16 a[242:243], v237 offset:12928
    ds_read_b64_tr_b16 a[244:245], v237 offset:12704
    ds_read_b64_tr_b16 a[246:247], v237 offset:12960
    ds_read_b64_tr_b16 a[248:249], v237 offset:12736
    v_mfma_f32_16x16x32_bf16 v[24:27], a[160:163], a[88:91], v[24:27]
    ds_read_b64_tr_b16 a[250:251], v237 offset:12992
    ds_read_b64_tr_b16 a[252:253], v237 offset:12768
    ds_read_b64_tr_b16 a[254:255], v237 offset:13024
    v_mfma_f32_16x16x32_bf16 v[28:31], a[160:163], a[92:95], v[28:31]
    v_mfma_f32_16x16x32_bf16 v[32:35], a[160:163], a[96:99], v[32:35]
    v_mfma_f32_16x16x32_bf16 v[36:39], a[164:167], a[80:83], v[36:39]
    v_mfma_f32_16x16x32_bf16 v[40:43], a[164:167], a[84:87], v[40:43]
    v_mfma_f32_16x16x32_bf16 v[44:47], a[164:167], a[88:91], v[44:47]
    v_fma_f32 v68, v68, s30, -v247
    v_fma_f32 v69, v69, s30, -v247
    v_fma_f32 v70, v70, s30, -v247
    v_fma_f32 v71, v71, s30, -v247
    v_exp_f32 v68, v68
    v_mfma_f32_16x16x32_bf16 v[48:51], a[164:167], a[92:95], v[48:51]
    v_exp_f32 v69, v69
    v_exp_f32 v70, v70
    v_exp_f32 v71, v71
    v_mfma_f32_16x16x32_bf16 v[52:55], a[164:167], a[96:99], v[52:55]
    v_cvt_pk_bf16_f32 v216, v68, v69
    v_add_f32 v252, v252, v68
    v_cvt_pk_bf16_f32 v217, v70, v71
    v_add_f32 v252, v252, v69
    ds_write_b64 v242, v[216:217] offset:32768
    v_mfma_f32_16x16x32_bf16 v[96:99], a[224:227], v[176:179], v[96:99]
    v_add_f32 v252, v252, v70
    v_add_f32 v252, v252, v71
    s_add_u32 m0, s29, 8448
    s_add_u32 s35, s94, 196608
    s_waitcnt lgkmcnt(9)
    buffer_load_dwordx4 v9, s[12:15], s35 offen nt lds
    v_mfma_f32_16x16x32_bf16 v[100:103], a[224:227], v[180:183], v[100:103]
    buffer_load_dwordx4 v10, s[12:15], s35 offen offset:1056 nt lds
    v_mfma_f32_16x16x32_bf16 v[104:107], a[224:227], v[184:187], v[104:107]
    v_mfma_f32_16x16x32_bf16 v[108:111], a[224:227], v[188:191], v[108:111]
    v_mfma_f32_16x16x32_bf16 v[112:115], a[224:227], v[192:195], v[112:115]
    buffer_load_dwordx4 v11, s[12:15], s35 offen offset:2112 nt lds
    v_mfma_f32_16x16x32_bf16 v[116:119], a[228:231], v[176:179], v[116:119]
    v_mfma_f32_16x16x32_bf16 v[120:123], a[228:231], v[180:183], v[120:123]
    v_mfma_f32_16x16x32_bf16 v[124:127], a[228:231], v[184:187], v[124:127]
    buffer_load_dwordx4 v12, s[12:15], s35 offen offset:3168 nt lds
    v_mfma_f32_16x16x32_bf16 v[128:131], a[228:231], v[188:191], v[128:131]
    v_mfma_f32_16x16x32_bf16 v[132:135], a[228:231], v[192:195], v[132:135]
    v_mfma_f32_16x16x32_bf16 v[16:19], a[168:171], a[100:103], v[16:19]
    v_mfma_f32_16x16x32_bf16 v[20:23], a[168:171], a[104:107], v[20:23]
    v_fma_f32 v88, v88, s30, -v247
    v_fma_f32 v89, v89, s30, -v247
    v_fma_f32 v90, v90, s30, -v247
    v_fma_f32 v91, v91, s30, -v247
    v_exp_f32 v88, v88
    v_mfma_f32_16x16x32_bf16 v[24:27], a[168:171], a[108:111], v[24:27]
    v_exp_f32 v89, v89
    v_exp_f32 v90, v90
    v_exp_f32 v91, v91
    v_mfma_f32_16x16x32_bf16 v[28:31], a[168:171], a[112:115], v[28:31]
    v_cvt_pk_bf16_f32 v218, v88, v89
    v_add_f32 v252, v252, v88
    v_cvt_pk_bf16_f32 v219, v90, v91
    v_add_f32 v252, v252, v89
    ds_write_b64 v243, v[218:219] offset:32768
    v_mfma_f32_16x16x32_bf16 v[32:35], a[168:171], a[116:119], v[32:35]
    v_add_f32 v252, v252, v90
    v_add_f32 v252, v252, v91
    s_add_u32 m0, s29, 12672
    s_add_u32 s36, s98, 65536
    s_waitcnt lgkmcnt(2)
    buffer_load_dwordx4 v233, s[16:19], s36 offen nt lds
    v_mfma_f32_16x16x32_bf16 v[36:39], a[172:175], a[100:103], v[36:39]
    v_mfma_f32_16x16x32_bf16 v[40:43], a[172:175], a[104:107], v[40:43]
    v_mfma_f32_16x16x32_bf16 v[44:47], a[172:175], a[108:111], v[44:47]
    buffer_load_dwordx4 v234, s[16:19], s36 offen offset:1056 nt lds
    v_mfma_f32_16x16x32_bf16 v[48:51], a[172:175], a[112:115], v[48:51]
    v_mfma_f32_16x16x32_bf16 v[52:55], a[172:175], a[116:119], v[52:55]
    v_mfma_f32_16x16x32_bf16 v[136:139], a[232:235], v[176:179], v[136:139]
    buffer_load_dwordx4 v235, s[16:19], s36 offen offset:2112 nt lds
    v_mfma_f32_16x16x32_bf16 v[140:143], a[232:235], v[180:183], v[140:143]
    v_mfma_f32_16x16x32_bf16 v[144:147], a[232:235], v[184:187], v[144:147]
    v_mfma_f32_16x16x32_bf16 v[148:151], a[232:235], v[188:191], v[148:151]
    buffer_load_dwordx4 v236, s[16:19], s36 offen offset:3168 nt lds
    v_mfma_f32_16x16x32_bf16 v[152:155], a[232:235], v[192:195], v[152:155]
    v_mfma_f32_16x16x32_bf16 v[156:159], a[236:239], v[176:179], v[156:159]
    v_mfma_f32_16x16x32_bf16 v[160:163], a[236:239], v[180:183], v[160:163]
    v_fma_f32 v72, v72, s30, -v248
    v_fma_f32 v73, v73, s30, -v248
    v_fma_f32 v74, v74, s30, -v248
    v_fma_f32 v75, v75, s30, -v248
    v_exp_f32 v72, v72
    v_mfma_f32_16x16x32_bf16 v[164:167], a[236:239], v[184:187], v[164:167]
    v_exp_f32 v73, v73
    v_exp_f32 v74, v74
    v_exp_f32 v75, v75
    v_mfma_f32_16x16x32_bf16 v[168:171], a[236:239], v[188:191], v[168:171]
    v_cvt_pk_bf16_f32 v220, v72, v73
    v_add_f32 v253, v253, v72
    v_cvt_pk_bf16_f32 v221, v74, v75
    v_add_f32 v253, v253, v73
    ds_write_b64 v242, v[220:221] offset:36864
    v_mfma_f32_16x16x32_bf16 v[172:175], a[236:239], v[192:195], v[172:175]
    v_add_f32 v253, v253, v74
    v_add_f32 v253, v253, v75
    v_mfma_f32_16x16x32_bf16 v[16:19], a[176:179], a[120:123], v[16:19]
    s_waitcnt vmcnt(20)
    ds_read_b128 a[160:163], v232 offset:0
    ds_read_b128 a[164:167], v232 offset:512
    ds_read_b128 a[168:171], v232 offset:64
    ds_read_b128 a[172:175], v232 offset:576
    v_mfma_f32_16x16x32_bf16 v[20:23], a[176:179], a[124:127], v[20:23]
    s_waitcnt vmcnt(16)
    ds_read_b64_tr_b16 a[224:225], v237 offset:4224
    ds_read_b64_tr_b16 a[226:227], v237 offset:4480
    ds_read_b64_tr_b16 a[228:229], v237 offset:4256
    ds_read_b64_tr_b16 a[230:231], v237 offset:4512
    ds_read_b64_tr_b16 a[232:233], v237 offset:4288
    v_mfma_f32_16x16x32_bf16 v[24:27], a[176:179], a[128:131], v[24:27]
    ds_read_b64_tr_b16 a[234:235], v237 offset:4544
    ds_read_b64_tr_b16 a[236:237], v237 offset:4320
    ds_read_b64_tr_b16 a[238:239], v237 offset:4576
    v_mfma_f32_16x16x32_bf16 v[28:31], a[176:179], a[132:135], v[28:31]
    v_mfma_f32_16x16x32_bf16 v[32:35], a[176:179], a[136:139], v[32:35]
    v_mfma_f32_16x16x32_bf16 v[36:39], a[180:183], a[120:123], v[36:39]
    v_mfma_f32_16x16x32_bf16 v[40:43], a[180:183], a[124:127], v[40:43]
    v_mfma_f32_16x16x32_bf16 v[44:47], a[180:183], a[128:131], v[44:47]
    v_mfma_f32_16x16x32_bf16 v[48:51], a[180:183], a[132:135], v[48:51]
    s_add_u32 m0, s29, 0
    s_add_u32 s37, s95, 196608
    s_waitcnt lgkmcnt(8)
    buffer_load_dwordx4 v9, s[12:15], s37 offen nt lds
    v_mfma_f32_16x16x32_bf16 v[52:55], a[180:183], a[136:139], v[52:55]
    v_mfma_f32_16x16x32_bf16 v[96:99], a[240:243], v[196:199], v[96:99]
    v_fma_f32 v92, v92, s30, -v248
    v_fma_f32 v93, v93, s30, -v248
    v_fma_f32 v94, v94, s30, -v248
    v_fma_f32 v95, v95, s30, -v248
    v_exp_f32 v92, v92
    v_mfma_f32_16x16x32_bf16 v[100:103], a[240:243], v[200:203], v[100:103]
    buffer_load_dwordx4 v10, s[12:15], s37 offen offset:1056 nt lds
    v_exp_f32 v93, v93
    v_exp_f32 v94, v94
    v_mfma_f32_16x16x32_bf16 v[104:107], a[240:243], v[204:207], v[104:107]
    v_exp_f32 v95, v95
    v_cvt_pk_bf16_f32 v222, v92, v93
    v_add_f32 v253, v253, v92
    v_cvt_pk_bf16_f32 v223, v94, v95
    v_mfma_f32_16x16x32_bf16 v[108:111], a[240:243], v[208:211], v[108:111]
    v_add_f32 v253, v253, v93
    ds_write_b64 v243, v[222:223] offset:36864
    v_add_f32 v253, v253, v94
    v_add_f32 v253, v253, v95
    v_mfma_f32_16x16x32_bf16 v[112:115], a[240:243], v[212:215], v[112:115]
    buffer_load_dwordx4 v11, s[12:15], s37 offen offset:2112 nt lds
    v_mfma_f32_16x16x32_bf16 v[116:119], a[244:247], v[196:199], v[116:119]
    v_mfma_f32_16x16x32_bf16 v[120:123], a[244:247], v[200:203], v[120:123]
    v_mfma_f32_16x16x32_bf16 v[124:127], a[244:247], v[204:207], v[124:127]
    buffer_load_dwordx4 v12, s[12:15], s37 offen offset:3168 nt lds
    v_mfma_f32_16x16x32_bf16 v[128:131], a[244:247], v[208:211], v[128:131]
    v_mfma_f32_16x16x32_bf16 v[132:135], a[244:247], v[212:215], v[132:135]
    v_mfma_f32_16x16x32_bf16 v[16:19], a[184:187], a[140:143], v[16:19]
    v_mfma_f32_16x16x32_bf16 v[20:23], a[184:187], a[144:147], v[20:23]
    v_mfma_f32_16x16x32_bf16 v[24:27], a[184:187], a[148:151], v[24:27]
    v_mfma_f32_16x16x32_bf16 v[28:31], a[184:187], a[152:155], v[28:31]
    v_mfma_f32_16x16x32_bf16 v[32:35], a[184:187], a[156:159], v[32:35]
    s_add_u32 m0, s29, 4224
    s_add_u32 s38, s99, 65536
    s_waitcnt lgkmcnt(1)
    buffer_load_dwordx4 v233, s[16:19], s38 offen nt lds
    v_mfma_f32_16x16x32_bf16 v[36:39], a[188:191], a[140:143], v[36:39]
    v_mfma_f32_16x16x32_bf16 v[40:43], a[188:191], a[144:147], v[40:43]
    v_mfma_f32_16x16x32_bf16 v[44:47], a[188:191], a[148:151], v[44:47]
    buffer_load_dwordx4 v234, s[16:19], s38 offen offset:1056 nt lds
    v_mfma_f32_16x16x32_bf16 v[48:51], a[188:191], a[152:155], v[48:51]
    v_mfma_f32_16x16x32_bf16 v[52:55], a[188:191], a[156:159], v[52:55]
    v_mfma_f32_16x16x32_bf16 v[136:139], a[248:251], v[196:199], v[136:139]
    buffer_load_dwordx4 v235, s[16:19], s38 offen offset:2112 nt lds
    v_mfma_f32_16x16x32_bf16 v[140:143], a[248:251], v[200:203], v[140:143]
    v_mfma_f32_16x16x32_bf16 v[144:147], a[248:251], v[204:207], v[144:147]
    v_mfma_f32_16x16x32_bf16 v[148:151], a[248:251], v[208:211], v[148:151]
    buffer_load_dwordx4 v236, s[16:19], s38 offen offset:3168 nt lds
    v_mfma_f32_16x16x32_bf16 v[152:155], a[248:251], v[212:215], v[152:155]
    v_mfma_f32_16x16x32_bf16 v[156:159], a[252:255], v[196:199], v[156:159]
    v_mfma_f32_16x16x32_bf16 v[160:163], a[252:255], v[200:203], v[160:163]
    v_mfma_f32_16x16x32_bf16 v[164:167], a[252:255], v[204:207], v[164:167]
    v_mfma_f32_16x16x32_bf16 v[168:171], a[252:255], v[208:211], v[168:171]
    v_mfma_f32_16x16x32_bf16 v[172:175], a[252:255], v[212:215], v[172:175]
    s_waitcnt lgkmcnt(0)
    s_barrier
    v_mfma_f32_16x16x32_bf16 v[56:59], a[160:163], a[0:3], 0
    s_waitcnt vmcnt(20)
    ds_read_b128 a[176:179], v232 offset:16896
    ds_read_b128 a[180:183], v232 offset:17408
    ds_read_b128 a[184:187], v232 offset:16960
    ds_read_b128 a[188:191], v232 offset:17472
    ds_read_b128 v[176:179], v238 offset:20480
    v_mfma_f32_16x16x32_bf16 v[60:63], a[160:163], a[4:7], 0
    ds_read_b128 v[180:183], v238 offset:24576
    ds_read_b128 v[184:187], v238 offset:28672
    ds_read_b128 v[188:191], v238 offset:32768
    ds_read_b128 v[192:195], v238 offset:36864
    s_waitcnt vmcnt(16)
    ds_read_b64_tr_b16 a[240:241], v237 offset:21120
    v_mfma_f32_16x16x32_bf16 v[64:67], a[160:163], a[8:11], 0
    ds_read_b64_tr_b16 a[242:243], v237 offset:21376
    ds_read_b64_tr_b16 a[244:245], v237 offset:21152
    ds_read_b64_tr_b16 a[246:247], v237 offset:21408
    ds_read_b64_tr_b16 a[248:249], v237 offset:21184
    ds_read_b64_tr_b16 a[250:251], v237 offset:21440
    v_mfma_f32_16x16x32_bf16 v[68:71], a[160:163], a[12:15], 0
    ds_read_b64_tr_b16 a[252:253], v237 offset:21216
    ds_read_b64_tr_b16 a[254:255], v237 offset:21472
    v_fma_f32 v16, v16, s30, -v244
    v_fma_f32 v17, v17, s30, -v244
    v_fma_f32 v18, v18, s30, -v244
    v_mfma_f32_16x16x32_bf16 v[72:75], a[160:163], a[16:19], 0
    v_fma_f32 v19, v19, s30, -v244
    v_exp_f32 v16, v16
    v_exp_f32 v17, v17
    v_mfma_f32_16x16x32_bf16 v[76:79], a[164:167], a[0:3], 0
    v_exp_f32 v18, v18
    v_exp_f32 v19, v19
    v_cvt_pk_bf16_f32 v224, v16, v17
    v_mfma_f32_16x16x32_bf16 v[80:83], a[164:167], a[4:7], 0
    v_add_f32 v249, v249, v16
    v_cvt_pk_bf16_f32 v225, v18, v19
    v_add_f32 v249, v249, v17
    ds_write_b64 v242, v[224:225] offset:0
    v_add_f32 v249, v249, v18
    v_mfma_f32_16x16x32_bf16 v[84:87], a[164:167], a[8:11], 0
    v_add_f32 v249, v249, v19
    ds_read_b128 v[196:199], v239 offset:20480
    ds_read_b128 v[200:203], v239 offset:24576
    ds_read_b128 v[204:207], v239 offset:28672
    ds_read_b128 v[208:211], v239 offset:32768
    v_mfma_f32_16x16x32_bf16 v[88:91], a[164:167], a[12:15], 0
    ds_read_b128 v[212:215], v239 offset:36864
    s_add_u32 m0, s29, 16896
    s_add_u32 s39, s92, 262144
    s_waitcnt lgkmcnt(15)
    buffer_load_dwordx4 v9, s[12:15], s39 offen nt lds
    v_mfma_f32_16x16x32_bf16 v[92:95], a[164:167], a[16:19], 0
    v_mfma_f32_16x16x32_bf16 v[96:99], a[224:227], v[176:179], v[96:99]
    v_mfma_f32_16x16x32_bf16 v[100:103], a[224:227], v[180:183], v[100:103]
    buffer_load_dwordx4 v10, s[12:15], s39 offen offset:1056 nt lds
    v_mfma_f32_16x16x32_bf16 v[104:107], a[224:227], v[184:187], v[104:107]
    v_mfma_f32_16x16x32_bf16 v[108:111], a[224:227], v[188:191], v[108:111]
    s_waitcnt lgkmcnt(14)
    v_mfma_f32_16x16x32_bf16 v[112:115], a[224:227], v[192:195], v[112:115]
    v_fma_f32 v36, v36, s30, -v244
    v_fma_f32 v37, v37, s30, -v244
    v_fma_f32 v38, v38, s30, -v244
    v_fma_f32 v39, v39, s30, -v244
    v_exp_f32 v36, v36
    v_mfma_f32_16x16x32_bf16 v[116:119], a[228:231], v[176:179], v[116:119]
    v_exp_f32 v37, v37
    v_exp_f32 v38, v38
    v_exp_f32 v39, v39
    v_mfma_f32_16x16x32_bf16 v[120:123], a[228:231], v[180:183], v[120:123]
    v_cvt_pk_bf16_f32 v226, v36, v37
    v_add_f32 v249, v249, v36
    v_cvt_pk_bf16_f32 v227, v38, v39
    v_add_f32 v249, v249, v37
    ds_write_b64 v243, v[226:227] offset:0
    v_mfma_f32_16x16x32_bf16 v[124:127], a[228:231], v[184:187], v[124:127]
    v_add_f32 v249, v249, v38
    v_add_f32 v249, v249, v39
    buffer_load_dwordx4 v11, s[12:15], s39 offen offset:2112 nt lds
    buffer_load_dwordx4 v12, s[12:15], s39 offen offset:3168 nt lds
    v_mfma_f32_16x16x32_bf16 v[128:131], a[228:231], v[188:191], v[128:131]
    v_mfma_f32_16x16x32_bf16 v[132:135], a[228:231], v[192:195], v[132:135]
    v_mfma_f32_16x16x32_bf16 v[56:59], a[168:171], a[20:23], v[56:59]
    v_mfma_f32_16x16x32_bf16 v[60:63], a[168:171], a[24:27], v[60:63]
    v_mfma_f32_16x16x32_bf16 v[64:67], a[168:171], a[28:31], v[64:67]
    v_mfma_f32_16x16x32_bf16 v[68:71], a[168:171], a[32:35], v[68:71]
    v_mfma_f32_16x16x32_bf16 v[72:75], a[168:171], a[36:39], v[72:75]
    s_add_u32 m0, s29, 21120
    s_add_u32 s32, s96, 131072
    s_waitcnt lgkmcnt(7)
    buffer_load_dwordx4 v233, s[16:19], s32 offen nt lds
    v_mfma_f32_16x16x32_bf16 v[76:79], a[172:175], a[20:23], v[76:79]
    v_mfma_f32_16x16x32_bf16 v[80:83], a[172:175], a[24:27], v[80:83]
    v_mfma_f32_16x16x32_bf16 v[84:87], a[172:175], a[28:31], v[84:87]
    buffer_load_dwordx4 v234, s[16:19], s32 offen offset:1056 nt lds
    v_mfma_f32_16x16x32_bf16 v[88:91], a[172:175], a[32:35], v[88:91]
    v_mfma_f32_16x16x32_bf16 v[92:95], a[172:175], a[36:39], v[92:95]
    v_fma_f32 v20, v20, s30, -v245
    v_fma_f32 v21, v21, s30, -v245
    v_fma_f32 v22, v22, s30, -v245
    v_fma_f32 v23, v23, s30, -v245
    v_exp_f32 v20, v20
    v_mfma_f32_16x16x32_bf16 v[136:139], a[232:235], v[176:179], v[136:139]
    v_exp_f32 v21, v21
    v_exp_f32 v22, v22
    v_exp_f32 v23, v23
    v_mfma_f32_16x16x32_bf16 v[140:143], a[232:235], v[180:183], v[140:143]
    v_cvt_pk_bf16_f32 v228, v20, v21
    v_add_f32 v250, v250, v20
    v_cvt_pk_bf16_f32 v229, v22, v23
    v_add_f32 v250, v250, v21
    ds_write_b64 v242, v[228:229] offset:4096
    v_mfma_f32_16x16x32_bf16 v[144:147], a[232:235], v[184:187], v[144:147]
    v_add_f32 v250, v250, v22
    v_add_f32 v250, v250, v23
    buffer_load_dwordx4 v235, s[16:19], s32 offen offset:2112 nt lds
    v_mfma_f32_16x16x32_bf16 v[148:151], a[232:235], v[188:191], v[148:151]
    buffer_load_dwordx4 v236, s[16:19], s32 offen offset:3168 nt lds
    v_mfma_f32_16x16x32_bf16 v[152:155], a[232:235], v[192:195], v[152:155]
    v_mfma_f32_16x16x32_bf16 v[156:159], a[236:239], v[176:179], v[156:159]
    v_mfma_f32_16x16x32_bf16 v[160:163], a[236:239], v[180:183], v[160:163]
    v_mfma_f32_16x16x32_bf16 v[164:167], a[236:239], v[184:187], v[164:167]
    v_mfma_f32_16x16x32_bf16 v[168:171], a[236:239], v[188:191], v[168:171]
    v_mfma_f32_16x16x32_bf16 v[172:175], a[236:239], v[192:195], v[172:175]
    ds_read_b128 v[176:179], v240 offset:20480
    ds_read_b128 v[180:183], v240 offset:24576
    ds_read_b128 v[184:187], v240 offset:28672
    ds_read_b128 v[188:191], v240 offset:32768
    ds_read_b128 v[192:195], v240 offset:36864
    v_mfma_f32_16x16x32_bf16 v[56:59], a[176:179], a[40:43], v[56:59]
    s_waitcnt vmcnt(20)
    ds_read_b128 a[160:163], v232 offset:8448
    ds_read_b128 a[164:167], v232 offset:8960
    ds_read_b128 a[168:171], v232 offset:8512
    ds_read_b128 a[172:175], v232 offset:9024
    v_mfma_f32_16x16x32_bf16 v[60:63], a[176:179], a[44:47], v[60:63]
    s_waitcnt vmcnt(16)
    ds_read_b64_tr_b16 a[224:225], v237 offset:12672
    ds_read_b64_tr_b16 a[226:227], v237 offset:12928
    ds_read_b64_tr_b16 a[228:229], v237 offset:12704
    ds_read_b64_tr_b16 a[230:231], v237 offset:12960
    ds_read_b64_tr_b16 a[232:233], v237 offset:12736
    v_mfma_f32_16x16x32_bf16 v[64:67], a[176:179], a[48:51], v[64:67]
    ds_read_b64_tr_b16 a[234:235], v237 offset:12992
    ds_read_b64_tr_b16 a[236:237], v237 offset:12768
    ds_read_b64_tr_b16 a[238:239], v237 offset:13024
    v_mfma_f32_16x16x32_bf16 v[68:71], a[176:179], a[52:55], v[68:71]
    v_fma_f32 v40, v40, s30, -v245
    v_fma_f32 v41, v41, s30, -v245
    v_fma_f32 v42, v42, s30, -v245
    v_fma_f32 v43, v43, s30, -v245
    v_exp_f32 v40, v40
    v_mfma_f32_16x16x32_bf16 v[72:75], a[176:179], a[56:59], v[72:75]
    v_exp_f32 v41, v41
    v_exp_f32 v42, v42
    v_exp_f32 v43, v43
    v_mfma_f32_16x16x32_bf16 v[76:79], a[180:183], a[40:43], v[76:79]
    v_cvt_pk_bf16_f32 v230, v40, v41
    v_add_f32 v250, v250, v40
    v_cvt_pk_bf16_f32 v231, v42, v43
    v_add_f32 v250, v250, v41
    ds_write_b64 v243, v[230:231] offset:4096
    v_mfma_f32_16x16x32_bf16 v[80:83], a[180:183], a[44:47], v[80:83]
    v_add_f32 v250, v250, v42
    v_add_f32 v250, v250, v43
    v_mfma_f32_16x16x32_bf16 v[84:87], a[180:183], a[48:51], v[84:87]
    v_mfma_f32_16x16x32_bf16 v[88:91], a[180:183], a[52:55], v[88:91]
    s_add_u32 m0, s29, 8448
    s_add_u32 s33, s93, 262144
    s_waitcnt lgkmcnt(9)
    buffer_load_dwordx4 v9, s[12:15], s33 offen nt lds
    v_mfma_f32_16x16x32_bf16 v[92:95], a[180:183], a[56:59], v[92:95]
    v_mfma_f32_16x16x32_bf16 v[96:99], a[240:243], v[196:199], v[96:99]
    v_mfma_f32_16x16x32_bf16 v[100:103], a[240:243], v[200:203], v[100:103]
    buffer_load_dwordx4 v10, s[12:15], s33 offen offset:1056 nt lds
    v_mfma_f32_16x16x32_bf16 v[104:107], a[240:243], v[204:207], v[104:107]
    v_mfma_f32_16x16x32_bf16 v[108:111], a[240:243], v[208:211], v[108:111]
    v_mfma_f32_16x16x32_bf16 v[112:115], a[240:243], v[212:215], v[112:115]
    buffer_load_dwordx4 v11, s[12:15], s33 offen offset:2112 nt lds
    v_mfma_f32_16x16x32_bf16 v[116:119], a[244:247], v[196:199], v[116:119]
    v_mfma_f32_16x16x32_bf16 v[120:123], a[244:247], v[200:203], v[120:123]
    v_mfma_f32_16x16x32_bf16 v[124:127], a[244:247], v[204:207], v[124:127]
    buffer_load_dwordx4 v12, s[12:15], s33 offen offset:3168 nt lds
    v_mfma_f32_16x16x32_bf16 v[128:131], a[244:247], v[208:211], v[128:131]
    v_fma_f32 v24, v24, s30, -v246
    v_fma_f32 v25, v25, s30, -v246
    v_fma_f32 v26, v26, s30, -v246
    v_fma_f32 v27, v27, s30, -v246
    v_exp_f32 v24, v24
    v_mfma_f32_16x16x32_bf16 v[132:135], a[244:247], v[212:215], v[132:135]
    v_exp_f32 v25, v25
    v_exp_f32 v26, v26
    v_exp_f32 v27, v27
    v_mfma_f32_16x16x32_bf16 v[56:59], a[184:187], a[60:63], v[56:59]
    v_cvt_pk_bf16_f32 v216, v24, v25
    v_add_f32 v251, v251, v24
    v_cvt_pk_bf16_f32 v217, v26, v27
    v_add_f32 v251, v251, v25
    ds_write_b64 v242, v[216:217] offset:8192
    v_mfma_f32_16x16x32_bf16 v[60:63], a[184:187], a[64:67], v[60:63]
    v_add_f32 v251, v251, v26
    v_add_f32 v251, v251, v27
    v_mfma_f32_16x16x32_bf16 v[64:67], a[184:187], a[68:71], v[64:67]
    v_mfma_f32_16x16x32_bf16 v[68:71], a[184:187], a[72:75], v[68:71]
    v_mfma_f32_16x16x32_bf16 v[72:75], a[184:187], a[76:79], v[72:75]
    s_add_u32 m0, s29, 12672
    s_add_u32 s34, s97, 131072
    s_waitcnt lgkmcnt(2)
    buffer_load_dwordx4 v233, s[16:19], s34 offen nt lds
    v_mfma_f32_16x16x32_bf16 v[76:79], a[188:191], a[60:63], v[76:79]
    v_mfma_f32_16x16x32_bf16 v[80:83], a[188:191], a[64:67], v[80:83]
    v_mfma_f32_16x16x32_bf16 v[84:87], a[188:191], a[68:71], v[84:87]
    buffer_load_dwordx4 v234, s[16:19], s34 offen offset:1056 nt lds
    v_mfma_f32_16x16x32_bf16 v[88:91], a[188:191], a[72:75], v[88:91]
    v_mfma_f32_16x16x32_bf16 v[92:95], a[188:191], a[76:79], v[92:95]
    v_mfma_f32_16x16x32_bf16 v[136:139], a[248:251], v[196:199], v[136:139]
    buffer_load_dwordx4 v235, s[16:19], s34 offen offset:2112 nt lds
    v_mfma_f32_16x16x32_bf16 v[140:143], a[248:251], v[200:203], v[140:143]
    v_mfma_f32_16x16x32_bf16 v[144:147], a[248:251], v[204:207], v[144:147]
    v_fma_f32 v44, v44, s30, -v246
    v_fma_f32 v45, v45, s30, -v246
    v_fma_f32 v46, v46, s30, -v246
    v_fma_f32 v47, v47, s30, -v246
    v_exp_f32 v44, v44
    v_mfma_f32_16x16x32_bf16 v[148:151], a[248:251], v[208:211], v[148:151]
    v_exp_f32 v45, v45
    v_exp_f32 v46, v46
    v_exp_f32 v47, v47
    v_mfma_f32_16x16x32_bf16 v[152:155], a[248:251], v[212:215], v[152:155]
    v_cvt_pk_bf16_f32 v218, v44, v45
    v_add_f32 v251, v251, v44
    v_cvt_pk_bf16_f32 v219, v46, v47
    v_add_f32 v251, v251, v45
    ds_write_b64 v243, v[218:219] offset:8192
    v_mfma_f32_16x16x32_bf16 v[156:159], a[252:255], v[196:199], v[156:159]
    v_add_f32 v251, v251, v46
    v_add_f32 v251, v251, v47
    buffer_load_dwordx4 v236, s[16:19], s34 offen offset:3168 nt lds
    v_mfma_f32_16x16x32_bf16 v[160:163], a[252:255], v[200:203], v[160:163]
    v_mfma_f32_16x16x32_bf16 v[164:167], a[252:255], v[204:207], v[164:167]
    v_mfma_f32_16x16x32_bf16 v[168:171], a[252:255], v[208:211], v[168:171]
    v_mfma_f32_16x16x32_bf16 v[172:175], a[252:255], v[212:215], v[172:175]
    ds_read_b128 v[196:199], v241 offset:20480
    ds_read_b128 v[200:203], v241 offset:24576
    ds_read_b128 v[204:207], v241 offset:28672
    ds_read_b128 v[208:211], v241 offset:32768
    ds_read_b128 v[212:215], v241 offset:36864
    v_mfma_f32_16x16x32_bf16 v[56:59], a[160:163], a[80:83], v[56:59]
    s_waitcnt vmcnt(20)
    ds_read_b128 a[176:179], v232 offset:0
    ds_read_b128 a[180:183], v232 offset:512
    ds_read_b128 a[184:187], v232 offset:64
    ds_read_b128 a[188:191], v232 offset:576
    v_mfma_f32_16x16x32_bf16 v[60:63], a[160:163], a[84:87], v[60:63]
    s_waitcnt vmcnt(16)
    ds_read_b64_tr_b16 a[240:241], v237 offset:4224
    ds_read_b64_tr_b16 a[242:243], v237 offset:4480
    ds_read_b64_tr_b16 a[244:245], v237 offset:4256
    ds_read_b64_tr_b16 a[246:247], v237 offset:4512
    ds_read_b64_tr_b16 a[248:249], v237 offset:4288
    v_mfma_f32_16x16x32_bf16 v[64:67], a[160:163], a[88:91], v[64:67]
    ds_read_b64_tr_b16 a[250:251], v237 offset:4544
    ds_read_b64_tr_b16 a[252:253], v237 offset:4320
    ds_read_b64_tr_b16 a[254:255], v237 offset:4576
    v_mfma_f32_16x16x32_bf16 v[68:71], a[160:163], a[92:95], v[68:71]
    v_mfma_f32_16x16x32_bf16 v[72:75], a[160:163], a[96:99], v[72:75]
    v_mfma_f32_16x16x32_bf16 v[76:79], a[164:167], a[80:83], v[76:79]
    v_mfma_f32_16x16x32_bf16 v[80:83], a[164:167], a[84:87], v[80:83]
    v_mfma_f32_16x16x32_bf16 v[84:87], a[164:167], a[88:91], v[84:87]
    v_fma_f32 v28, v28, s30, -v247
    v_fma_f32 v29, v29, s30, -v247
    v_fma_f32 v30, v30, s30, -v247
    v_fma_f32 v31, v31, s30, -v247
    v_exp_f32 v28, v28
    v_mfma_f32_16x16x32_bf16 v[88:91], a[164:167], a[92:95], v[88:91]
    v_exp_f32 v29, v29
    v_exp_f32 v30, v30
    v_exp_f32 v31, v31
    v_mfma_f32_16x16x32_bf16 v[92:95], a[164:167], a[96:99], v[92:95]
    v_cvt_pk_bf16_f32 v220, v28, v29
    v_add_f32 v252, v252, v28
    v_cvt_pk_bf16_f32 v221, v30, v31
    v_add_f32 v252, v252, v29
    ds_write_b64 v242, v[220:221] offset:12288
    v_mfma_f32_16x16x32_bf16 v[96:99], a[224:227], v[176:179], v[96:99]
    v_add_f32 v252, v252, v30
    v_add_f32 v252, v252, v31
    s_add_u32 m0, s29, 0
    s_add_u32 s35, s94, 262144
    s_waitcnt lgkmcnt(9)
    buffer_load_dwordx4 v9, s[12:15], s35 offen nt lds
    v_mfma_f32_16x16x32_bf16 v[100:103], a[224:227], v[180:183], v[100:103]
    buffer_load_dwordx4 v10, s[12:15], s35 offen offset:1056 nt lds
    v_mfma_f32_16x16x32_bf16 v[104:107], a[224:227], v[184:187], v[104:107]
    v_mfma_f32_16x16x32_bf16 v[108:111], a[224:227], v[188:191], v[108:111]
    v_mfma_f32_16x16x32_bf16 v[112:115], a[224:227], v[192:195], v[112:115]
    buffer_load_dwordx4 v11, s[12:15], s35 offen offset:2112 nt lds
    v_mfma_f32_16x16x32_bf16 v[116:119], a[228:231], v[176:179], v[116:119]
    v_mfma_f32_16x16x32_bf16 v[120:123], a[228:231], v[180:183], v[120:123]
    v_mfma_f32_16x16x32_bf16 v[124:127], a[228:231], v[184:187], v[124:127]
    buffer_load_dwordx4 v12, s[12:15], s35 offen offset:3168 nt lds
    v_mfma_f32_16x16x32_bf16 v[128:131], a[228:231], v[188:191], v[128:131]
    v_mfma_f32_16x16x32_bf16 v[132:135], a[228:231], v[192:195], v[132:135]
    v_mfma_f32_16x16x32_bf16 v[56:59], a[168:171], a[100:103], v[56:59]
    v_mfma_f32_16x16x32_bf16 v[60:63], a[168:171], a[104:107], v[60:63]
    v_fma_f32 v48, v48, s30, -v247
    v_fma_f32 v49, v49, s30, -v247
    v_fma_f32 v50, v50, s30, -v247
    v_fma_f32 v51, v51, s30, -v247
    v_exp_f32 v48, v48
    v_mfma_f32_16x16x32_bf16 v[64:67], a[168:171], a[108:111], v[64:67]
    v_exp_f32 v49, v49
    v_exp_f32 v50, v50
    v_exp_f32 v51, v51
    v_mfma_f32_16x16x32_bf16 v[68:71], a[168:171], a[112:115], v[68:71]
    v_cvt_pk_bf16_f32 v222, v48, v49
    v_add_f32 v252, v252, v48
    v_cvt_pk_bf16_f32 v223, v50, v51
    v_add_f32 v252, v252, v49
    ds_write_b64 v243, v[222:223] offset:12288
    v_mfma_f32_16x16x32_bf16 v[72:75], a[168:171], a[116:119], v[72:75]
    v_add_f32 v252, v252, v50
    v_add_f32 v252, v252, v51
    s_add_u32 m0, s29, 4224
    s_add_u32 s36, s98, 131072
    s_waitcnt lgkmcnt(2)
    buffer_load_dwordx4 v233, s[16:19], s36 offen nt lds
    v_mfma_f32_16x16x32_bf16 v[76:79], a[172:175], a[100:103], v[76:79]
    v_mfma_f32_16x16x32_bf16 v[80:83], a[172:175], a[104:107], v[80:83]
    v_mfma_f32_16x16x32_bf16 v[84:87], a[172:175], a[108:111], v[84:87]
    buffer_load_dwordx4 v234, s[16:19], s36 offen offset:1056 nt lds
    v_mfma_f32_16x16x32_bf16 v[88:91], a[172:175], a[112:115], v[88:91]
    v_mfma_f32_16x16x32_bf16 v[92:95], a[172:175], a[116:119], v[92:95]
    v_mfma_f32_16x16x32_bf16 v[136:139], a[232:235], v[176:179], v[136:139]
    buffer_load_dwordx4 v235, s[16:19], s36 offen offset:2112 nt lds
    v_mfma_f32_16x16x32_bf16 v[140:143], a[232:235], v[180:183], v[140:143]
    v_mfma_f32_16x16x32_bf16 v[144:147], a[232:235], v[184:187], v[144:147]
    v_mfma_f32_16x16x32_bf16 v[148:151], a[232:235], v[188:191], v[148:151]
    buffer_load_dwordx4 v236, s[16:19], s36 offen offset:3168 nt lds
    v_mfma_f32_16x16x32_bf16 v[152:155], a[232:235], v[192:195], v[152:155]
    v_mfma_f32_16x16x32_bf16 v[156:159], a[236:239], v[176:179], v[156:159]
    v_mfma_f32_16x16x32_bf16 v[160:163], a[236:239], v[180:183], v[160:163]
    v_fma_f32 v32, v32, s30, -v248
    v_fma_f32 v33, v33, s30, -v248
    v_fma_f32 v34, v34, s30, -v248
    v_fma_f32 v35, v35, s30, -v248
    v_exp_f32 v32, v32
    v_mfma_f32_16x16x32_bf16 v[164:167], a[236:239], v[184:187], v[164:167]
    v_exp_f32 v33, v33
    v_exp_f32 v34, v34
    v_exp_f32 v35, v35
    v_mfma_f32_16x16x32_bf16 v[168:171], a[236:239], v[188:191], v[168:171]
    v_cvt_pk_bf16_f32 v224, v32, v33
    v_add_f32 v253, v253, v32
    v_cvt_pk_bf16_f32 v225, v34, v35
    v_add_f32 v253, v253, v33
    ds_write_b64 v242, v[224:225] offset:16384
    v_mfma_f32_16x16x32_bf16 v[172:175], a[236:239], v[192:195], v[172:175]
    v_add_f32 v253, v253, v34
    v_add_f32 v253, v253, v35
    v_mfma_f32_16x16x32_bf16 v[56:59], a[176:179], a[120:123], v[56:59]
    s_waitcnt vmcnt(20)
    ds_read_b128 a[160:163], v232 offset:16896
    ds_read_b128 a[164:167], v232 offset:17408
    ds_read_b128 a[168:171], v232 offset:16960
    ds_read_b128 a[172:175], v232 offset:17472
    v_mfma_f32_16x16x32_bf16 v[60:63], a[176:179], a[124:127], v[60:63]
    s_waitcnt vmcnt(16)
    ds_read_b64_tr_b16 a[224:225], v237 offset:21120
    ds_read_b64_tr_b16 a[226:227], v237 offset:21376
    ds_read_b64_tr_b16 a[228:229], v237 offset:21152
    ds_read_b64_tr_b16 a[230:231], v237 offset:21408
    ds_read_b64_tr_b16 a[232:233], v237 offset:21184
    v_mfma_f32_16x16x32_bf16 v[64:67], a[176:179], a[128:131], v[64:67]
    ds_read_b64_tr_b16 a[234:235], v237 offset:21440
    ds_read_b64_tr_b16 a[236:237], v237 offset:21216
    ds_read_b64_tr_b16 a[238:239], v237 offset:21472
    v_mfma_f32_16x16x32_bf16 v[68:71], a[176:179], a[132:135], v[68:71]
    v_mfma_f32_16x16x32_bf16 v[72:75], a[176:179], a[136:139], v[72:75]
    v_mfma_f32_16x16x32_bf16 v[76:79], a[180:183], a[120:123], v[76:79]
    v_mfma_f32_16x16x32_bf16 v[80:83], a[180:183], a[124:127], v[80:83]
    v_mfma_f32_16x16x32_bf16 v[84:87], a[180:183], a[128:131], v[84:87]
    v_mfma_f32_16x16x32_bf16 v[88:91], a[180:183], a[132:135], v[88:91]
    s_add_u32 m0, s29, 16896
    s_add_u32 s37, s95, 262144
    s_waitcnt lgkmcnt(8)
    buffer_load_dwordx4 v9, s[12:15], s37 offen nt lds
    v_mfma_f32_16x16x32_bf16 v[92:95], a[180:183], a[136:139], v[92:95]
    v_mfma_f32_16x16x32_bf16 v[96:99], a[240:243], v[196:199], v[96:99]
    v_fma_f32 v52, v52, s30, -v248
    v_fma_f32 v53, v53, s30, -v248
    v_fma_f32 v54, v54, s30, -v248
    v_fma_f32 v55, v55, s30, -v248
    v_exp_f32 v52, v52
    v_mfma_f32_16x16x32_bf16 v[100:103], a[240:243], v[200:203], v[100:103]
    buffer_load_dwordx4 v10, s[12:15], s37 offen offset:1056 nt lds
    v_exp_f32 v53, v53
    v_exp_f32 v54, v54
    v_mfma_f32_16x16x32_bf16 v[104:107], a[240:243], v[204:207], v[104:107]
    v_exp_f32 v55, v55
    v_cvt_pk_bf16_f32 v226, v52, v53
    v_add_f32 v253, v253, v52
    v_cvt_pk_bf16_f32 v227, v54, v55
    v_mfma_f32_16x16x32_bf16 v[108:111], a[240:243], v[208:211], v[108:111]
    v_add_f32 v253, v253, v53
    ds_write_b64 v243, v[226:227] offset:16384
    v_add_f32 v253, v253, v54
    v_add_f32 v253, v253, v55
    v_mfma_f32_16x16x32_bf16 v[112:115], a[240:243], v[212:215], v[112:115]
    buffer_load_dwordx4 v11, s[12:15], s37 offen offset:2112 nt lds
    v_mfma_f32_16x16x32_bf16 v[116:119], a[244:247], v[196:199], v[116:119]
    v_mfma_f32_16x16x32_bf16 v[120:123], a[244:247], v[200:203], v[120:123]
    v_mfma_f32_16x16x32_bf16 v[124:127], a[244:247], v[204:207], v[124:127]
    buffer_load_dwordx4 v12, s[12:15], s37 offen offset:3168 nt lds
    v_mfma_f32_16x16x32_bf16 v[128:131], a[244:247], v[208:211], v[128:131]
    v_mfma_f32_16x16x32_bf16 v[132:135], a[244:247], v[212:215], v[132:135]
    v_mfma_f32_16x16x32_bf16 v[56:59], a[184:187], a[140:143], v[56:59]
    v_mfma_f32_16x16x32_bf16 v[60:63], a[184:187], a[144:147], v[60:63]
    v_mfma_f32_16x16x32_bf16 v[64:67], a[184:187], a[148:151], v[64:67]
    v_mfma_f32_16x16x32_bf16 v[68:71], a[184:187], a[152:155], v[68:71]
    v_mfma_f32_16x16x32_bf16 v[72:75], a[184:187], a[156:159], v[72:75]
    s_add_u32 m0, s29, 21120
    s_add_u32 s38, s99, 131072
    s_waitcnt lgkmcnt(1)
    buffer_load_dwordx4 v233, s[16:19], s38 offen nt lds
    v_mfma_f32_16x16x32_bf16 v[76:79], a[188:191], a[140:143], v[76:79]
    v_mfma_f32_16x16x32_bf16 v[80:83], a[188:191], a[144:147], v[80:83]
    v_mfma_f32_16x16x32_bf16 v[84:87], a[188:191], a[148:151], v[84:87]
    buffer_load_dwordx4 v234, s[16:19], s38 offen offset:1056 nt lds
    v_mfma_f32_16x16x32_bf16 v[88:91], a[188:191], a[152:155], v[88:91]
    v_mfma_f32_16x16x32_bf16 v[92:95], a[188:191], a[156:159], v[92:95]
    v_mfma_f32_16x16x32_bf16 v[136:139], a[248:251], v[196:199], v[136:139]
    buffer_load_dwordx4 v235, s[16:19], s38 offen offset:2112 nt lds
    v_mfma_f32_16x16x32_bf16 v[140:143], a[248:251], v[200:203], v[140:143]
    v_mfma_f32_16x16x32_bf16 v[144:147], a[248:251], v[204:207], v[144:147]
    v_mfma_f32_16x16x32_bf16 v[148:151], a[248:251], v[208:211], v[148:151]
    buffer_load_dwordx4 v236, s[16:19], s38 offen offset:3168 nt lds
    v_mfma_f32_16x16x32_bf16 v[152:155], a[248:251], v[212:215], v[152:155]
    v_mfma_f32_16x16x32_bf16 v[156:159], a[252:255], v[196:199], v[156:159]
    v_mfma_f32_16x16x32_bf16 v[160:163], a[252:255], v[200:203], v[160:163]
    v_mfma_f32_16x16x32_bf16 v[164:167], a[252:255], v[204:207], v[164:167]
    v_mfma_f32_16x16x32_bf16 v[168:171], a[252:255], v[208:211], v[168:171]
    v_mfma_f32_16x16x32_bf16 v[172:175], a[252:255], v[212:215], v[172:175]
    s_waitcnt lgkmcnt(0)
    s_barrier
    v_mfma_f32_16x16x32_bf16 v[16:19], a[160:163], a[0:3], 0
    s_waitcnt vmcnt(20)
    ds_read_b128 a[176:179], v232 offset:8448
    ds_read_b128 a[180:183], v232 offset:8960
    ds_read_b128 a[184:187], v232 offset:8512
    ds_read_b128 a[188:191], v232 offset:9024
    ds_read_b128 v[176:179], v238 offset:0
    v_mfma_f32_16x16x32_bf16 v[20:23], a[160:163], a[4:7], 0
    ds_read_b128 v[180:183], v238 offset:4096
    ds_read_b128 v[184:187], v238 offset:8192
    ds_read_b128 v[188:191], v238 offset:12288
    ds_read_b128 v[192:195], v238 offset:16384
    s_waitcnt vmcnt(16)
    ds_read_b64_tr_b16 a[240:241], v237 offset:12672
    v_mfma_f32_16x16x32_bf16 v[24:27], a[160:163], a[8:11], 0
    ds_read_b64_tr_b16 a[242:243], v237 offset:12928
    ds_read_b64_tr_b16 a[244:245], v237 offset:12704
    ds_read_b64_tr_b16 a[246:247], v237 offset:12960
    ds_read_b64_tr_b16 a[248:249], v237 offset:12736
    ds_read_b64_tr_b16 a[250:251], v237 offset:12992
    v_mfma_f32_16x16x32_bf16 v[28:31], a[160:163], a[12:15], 0
    ds_read_b64_tr_b16 a[252:253], v237 offset:12768
    ds_read_b64_tr_b16 a[254:255], v237 offset:13024
    v_fma_f32 v56, v56, s30, -v244
    v_fma_f32 v57, v57, s30, -v244
    v_fma_f32 v58, v58, s30, -v244
    v_mfma_f32_16x16x32_bf16 v[32:35], a[160:163], a[16:19], 0
    v_fma_f32 v59, v59, s30, -v244
    v_exp_f32 v56, v56
    v_exp_f32 v57, v57
    v_mfma_f32_16x16x32_bf16 v[36:39], a[164:167], a[0:3], 0
    v_exp_f32 v58, v58
    v_exp_f32 v59, v59
    v_cvt_pk_bf16_f32 v228, v56, v57
    v_mfma_f32_16x16x32_bf16 v[40:43], a[164:167], a[4:7], 0
    v_add_f32 v249, v249, v56
    v_cvt_pk_bf16_f32 v229, v58, v59
    v_add_f32 v249, v249, v57
    ds_write_b64 v242, v[228:229] offset:20480
    v_add_f32 v249, v249, v58
    v_mfma_f32_16x16x32_bf16 v[44:47], a[164:167], a[8:11], 0
    v_add_f32 v249, v249, v59
    ds_read_b128 v[196:199], v239 offset:0
    ds_read_b128 v[200:203], v239 offset:4096
    ds_read_b128 v[204:207], v239 offset:8192
    ds_read_b128 v[208:211], v239 offset:12288
    v_mfma_f32_16x16x32_bf16 v[48:51], a[164:167], a[12:15], 0
    ds_read_b128 v[212:215], v239 offset:16384
    s_add_u32 m0, s29, 8448
    s_add_u32 s39, s92, 327680
    s_waitcnt lgkmcnt(15)
    buffer_load_dwordx4 v9, s[12:15], s39 offen nt lds
    v_mfma_f32_16x16x32_bf16 v[52:55], a[164:167], a[16:19], 0
    v_mfma_f32_16x16x32_bf16 v[96:99], a[224:227], v[176:179], v[96:99]
    v_mfma_f32_16x16x32_bf16 v[100:103], a[224:227], v[180:183], v[100:103]
    buffer_load_dwordx4 v10, s[12:15], s39 offen offset:1056 nt lds
    v_mfma_f32_16x16x32_bf16 v[104:107], a[224:227], v[184:187], v[104:107]
    v_mfma_f32_16x16x32_bf16 v[108:111], a[224:227], v[188:191], v[108:111]
    s_waitcnt lgkmcnt(14)
    v_mfma_f32_16x16x32_bf16 v[112:115], a[224:227], v[192:195], v[112:115]
    v_fma_f32 v76, v76, s30, -v244
    v_fma_f32 v77, v77, s30, -v244
    v_fma_f32 v78, v78, s30, -v244
    v_fma_f32 v79, v79, s30, -v244
    v_exp_f32 v76, v76
    v_mfma_f32_16x16x32_bf16 v[116:119], a[228:231], v[176:179], v[116:119]
    v_exp_f32 v77, v77
    v_exp_f32 v78, v78
    v_exp_f32 v79, v79
    v_mfma_f32_16x16x32_bf16 v[120:123], a[228:231], v[180:183], v[120:123]
    v_cvt_pk_bf16_f32 v230, v76, v77
    v_add_f32 v249, v249, v76
    v_cvt_pk_bf16_f32 v231, v78, v79
    v_add_f32 v249, v249, v77
    ds_write_b64 v243, v[230:231] offset:20480
    v_mfma_f32_16x16x32_bf16 v[124:127], a[228:231], v[184:187], v[124:127]
    v_add_f32 v249, v249, v78
    v_add_f32 v249, v249, v79
    buffer_load_dwordx4 v11, s[12:15], s39 offen offset:2112 nt lds
    buffer_load_dwordx4 v12, s[12:15], s39 offen offset:3168 nt lds
    v_mfma_f32_16x16x32_bf16 v[128:131], a[228:231], v[188:191], v[128:131]
    v_mfma_f32_16x16x32_bf16 v[132:135], a[228:231], v[192:195], v[132:135]
    v_mfma_f32_16x16x32_bf16 v[16:19], a[168:171], a[20:23], v[16:19]
    v_mfma_f32_16x16x32_bf16 v[20:23], a[168:171], a[24:27], v[20:23]
    v_mfma_f32_16x16x32_bf16 v[24:27], a[168:171], a[28:31], v[24:27]
    v_mfma_f32_16x16x32_bf16 v[28:31], a[168:171], a[32:35], v[28:31]
    v_mfma_f32_16x16x32_bf16 v[32:35], a[168:171], a[36:39], v[32:35]
    s_add_u32 m0, s29, 12672
    s_add_u32 s32, s96, 196608
    s_waitcnt lgkmcnt(7)
    buffer_load_dwordx4 v233, s[16:19], s32 offen nt lds
    v_mfma_f32_16x16x32_bf16 v[36:39], a[172:175], a[20:23], v[36:39]
    v_mfma_f32_16x16x32_bf16 v[40:43], a[172:175], a[24:27], v[40:43]
    v_mfma_f32_16x16x32_bf16 v[44:47], a[172:175], a[28:31], v[44:47]
    buffer_load_dwordx4 v234, s[16:19], s32 offen offset:1056 nt lds
    v_mfma_f32_16x16x32_bf16 v[48:51], a[172:175], a[32:35], v[48:51]
    v_mfma_f32_16x16x32_bf16 v[52:55], a[172:175], a[36:39], v[52:55]
    v_fma_f32 v60, v60, s30, -v245
    v_fma_f32 v61, v61, s30, -v245
    v_fma_f32 v62, v62, s30, -v245
    v_fma_f32 v63, v63, s30, -v245
    v_exp_f32 v60, v60
    v_mfma_f32_16x16x32_bf16 v[136:139], a[232:235], v[176:179], v[136:139]
    v_exp_f32 v61, v61
    v_exp_f32 v62, v62
    v_exp_f32 v63, v63
    v_mfma_f32_16x16x32_bf16 v[140:143], a[232:235], v[180:183], v[140:143]
    v_cvt_pk_bf16_f32 v216, v60, v61
    v_add_f32 v250, v250, v60
    v_cvt_pk_bf16_f32 v217, v62, v63
    v_add_f32 v250, v250, v61
    ds_write_b64 v242, v[216:217] offset:24576
    v_mfma_f32_16x16x32_bf16 v[144:147], a[232:235], v[184:187], v[144:147]
    v_add_f32 v250, v250, v62
    v_add_f32 v250, v250, v63
    buffer_load_dwordx4 v235, s[16:19], s32 offen offset:2112 nt lds
    v_mfma_f32_16x16x32_bf16 v[148:151], a[232:235], v[188:191], v[148:151]
    buffer_load_dwordx4 v236, s[16:19], s32 offen offset:3168 nt lds
    v_mfma_f32_16x16x32_bf16 v[152:155], a[232:235], v[192:195], v[152:155]
    v_mfma_f32_16x16x32_bf16 v[156:159], a[236:239], v[176:179], v[156:159]
    v_mfma_f32_16x16x32_bf16 v[160:163], a[236:239], v[180:183], v[160:163]
    v_mfma_f32_16x16x32_bf16 v[164:167], a[236:239], v[184:187], v[164:167]
    v_mfma_f32_16x16x32_bf16 v[168:171], a[236:239], v[188:191], v[168:171]
    v_mfma_f32_16x16x32_bf16 v[172:175], a[236:239], v[192:195], v[172:175]
    ds_read_b128 v[176:179], v240 offset:0
    ds_read_b128 v[180:183], v240 offset:4096
    ds_read_b128 v[184:187], v240 offset:8192
    ds_read_b128 v[188:191], v240 offset:12288
    ds_read_b128 v[192:195], v240 offset:16384
    v_mfma_f32_16x16x32_bf16 v[16:19], a[176:179], a[40:43], v[16:19]
    s_waitcnt vmcnt(20)
    ds_read_b128 a[160:163], v232 offset:0
    ds_read_b128 a[164:167], v232 offset:512
    ds_read_b128 a[168:171], v232 offset:64
    ds_read_b128 a[172:175], v232 offset:576
    v_mfma_f32_16x16x32_bf16 v[20:23], a[176:179], a[44:47], v[20:23]
    s_waitcnt vmcnt(16)
    ds_read_b64_tr_b16 a[224:225], v237 offset:4224
    ds_read_b64_tr_b16 a[226:227], v237 offset:4480
    ds_read_b64_tr_b16 a[228:229], v237 offset:4256
    ds_read_b64_tr_b16 a[230:231], v237 offset:4512
    ds_read_b64_tr_b16 a[232:233], v237 offset:4288
    v_mfma_f32_16x16x32_bf16 v[24:27], a[176:179], a[48:51], v[24:27]
    ds_read_b64_tr_b16 a[234:235], v237 offset:4544
    ds_read_b64_tr_b16 a[236:237], v237 offset:4320
    ds_read_b64_tr_b16 a[238:239], v237 offset:4576
    v_mfma_f32_16x16x32_bf16 v[28:31], a[176:179], a[52:55], v[28:31]
    v_fma_f32 v80, v80, s30, -v245
    v_fma_f32 v81, v81, s30, -v245
    v_fma_f32 v82, v82, s30, -v245
    v_fma_f32 v83, v83, s30, -v245
    v_exp_f32 v80, v80
    v_mfma_f32_16x16x32_bf16 v[32:35], a[176:179], a[56:59], v[32:35]
    v_exp_f32 v81, v81
    v_exp_f32 v82, v82
    v_exp_f32 v83, v83
    v_mfma_f32_16x16x32_bf16 v[36:39], a[180:183], a[40:43], v[36:39]
    v_cvt_pk_bf16_f32 v218, v80, v81
    v_add_f32 v250, v250, v80
    v_cvt_pk_bf16_f32 v219, v82, v83
    v_add_f32 v250, v250, v81
    ds_write_b64 v243, v[218:219] offset:24576
    v_mfma_f32_16x16x32_bf16 v[40:43], a[180:183], a[44:47], v[40:43]
    v_add_f32 v250, v250, v82
    v_add_f32 v250, v250, v83
    v_mfma_f32_16x16x32_bf16 v[44:47], a[180:183], a[48:51], v[44:47]
    v_mfma_f32_16x16x32_bf16 v[48:51], a[180:183], a[52:55], v[48:51]
    s_add_u32 m0, s29, 0
    s_add_u32 s33, s93, 327680
    s_waitcnt lgkmcnt(9)
    buffer_load_dwordx4 v9, s[12:15], s33 offen nt lds
    v_mfma_f32_16x16x32_bf16 v[52:55], a[180:183], a[56:59], v[52:55]
    v_mfma_f32_16x16x32_bf16 v[96:99], a[240:243], v[196:199], v[96:99]
    v_mfma_f32_16x16x32_bf16 v[100:103], a[240:243], v[200:203], v[100:103]
    buffer_load_dwordx4 v10, s[12:15], s33 offen offset:1056 nt lds
    v_mfma_f32_16x16x32_bf16 v[104:107], a[240:243], v[204:207], v[104:107]
    v_mfma_f32_16x16x32_bf16 v[108:111], a[240:243], v[208:211], v[108:111]
    v_mfma_f32_16x16x32_bf16 v[112:115], a[240:243], v[212:215], v[112:115]
    buffer_load_dwordx4 v11, s[12:15], s33 offen offset:2112 nt lds
    v_mfma_f32_16x16x32_bf16 v[116:119], a[244:247], v[196:199], v[116:119]
    v_mfma_f32_16x16x32_bf16 v[120:123], a[244:247], v[200:203], v[120:123]
    v_mfma_f32_16x16x32_bf16 v[124:127], a[244:247], v[204:207], v[124:127]
    buffer_load_dwordx4 v12, s[12:15], s33 offen offset:3168 nt lds
    v_mfma_f32_16x16x32_bf16 v[128:131], a[244:247], v[208:211], v[128:131]
    v_fma_f32 v64, v64, s30, -v246
    v_fma_f32 v65, v65, s30, -v246
    v_fma_f32 v66, v66, s30, -v246
    v_fma_f32 v67, v67, s30, -v246
    v_exp_f32 v64, v64
    v_mfma_f32_16x16x32_bf16 v[132:135], a[244:247], v[212:215], v[132:135]
    v_exp_f32 v65, v65
    v_exp_f32 v66, v66
    v_exp_f32 v67, v67
    v_mfma_f32_16x16x32_bf16 v[16:19], a[184:187], a[60:63], v[16:19]
    v_cvt_pk_bf16_f32 v220, v64, v65
    v_add_f32 v251, v251, v64
    v_cvt_pk_bf16_f32 v221, v66, v67
    v_add_f32 v251, v251, v65
    ds_write_b64 v242, v[220:221] offset:28672
    v_mfma_f32_16x16x32_bf16 v[20:23], a[184:187], a[64:67], v[20:23]
    v_add_f32 v251, v251, v66
    v_add_f32 v251, v251, v67
    v_mfma_f32_16x16x32_bf16 v[24:27], a[184:187], a[68:71], v[24:27]
    v_mfma_f32_16x16x32_bf16 v[28:31], a[184:187], a[72:75], v[28:31]
    v_mfma_f32_16x16x32_bf16 v[32:35], a[184:187], a[76:79], v[32:35]
    s_add_u32 m0, s29, 4224
    s_add_u32 s34, s97, 196608
    s_waitcnt lgkmcnt(2)
    buffer_load_dwordx4 v233, s[16:19], s34 offen nt lds
    v_mfma_f32_16x16x32_bf16 v[36:39], a[188:191], a[60:63], v[36:39]
    v_mfma_f32_16x16x32_bf16 v[40:43], a[188:191], a[64:67], v[40:43]
    v_mfma_f32_16x16x32_bf16 v[44:47], a[188:191], a[68:71], v[44:47]
    buffer_load_dwordx4 v234, s[16:19], s34 offen offset:1056 nt lds
    v_mfma_f32_16x16x32_bf16 v[48:51], a[188:191], a[72:75], v[48:51]
    v_mfma_f32_16x16x32_bf16 v[52:55], a[188:191], a[76:79], v[52:55]
    v_mfma_f32_16x16x32_bf16 v[136:139], a[248:251], v[196:199], v[136:139]
    buffer_load_dwordx4 v235, s[16:19], s34 offen offset:2112 nt lds
    v_mfma_f32_16x16x32_bf16 v[140:143], a[248:251], v[200:203], v[140:143]
    v_mfma_f32_16x16x32_bf16 v[144:147], a[248:251], v[204:207], v[144:147]
    v_fma_f32 v84, v84, s30, -v246
    v_fma_f32 v85, v85, s30, -v246
    v_fma_f32 v86, v86, s30, -v246
    v_fma_f32 v87, v87, s30, -v246
    v_exp_f32 v84, v84
    v_mfma_f32_16x16x32_bf16 v[148:151], a[248:251], v[208:211], v[148:151]
    v_exp_f32 v85, v85
    v_exp_f32 v86, v86
    v_exp_f32 v87, v87
    v_mfma_f32_16x16x32_bf16 v[152:155], a[248:251], v[212:215], v[152:155]
    v_cvt_pk_bf16_f32 v222, v84, v85
    v_add_f32 v251, v251, v84
    v_cvt_pk_bf16_f32 v223, v86, v87
    v_add_f32 v251, v251, v85
    ds_write_b64 v243, v[222:223] offset:28672
    v_mfma_f32_16x16x32_bf16 v[156:159], a[252:255], v[196:199], v[156:159]
    v_add_f32 v251, v251, v86
    v_add_f32 v251, v251, v87
    buffer_load_dwordx4 v236, s[16:19], s34 offen offset:3168 nt lds
    v_mfma_f32_16x16x32_bf16 v[160:163], a[252:255], v[200:203], v[160:163]
    v_mfma_f32_16x16x32_bf16 v[164:167], a[252:255], v[204:207], v[164:167]
    v_mfma_f32_16x16x32_bf16 v[168:171], a[252:255], v[208:211], v[168:171]
    v_mfma_f32_16x16x32_bf16 v[172:175], a[252:255], v[212:215], v[172:175]
    ds_read_b128 v[196:199], v241 offset:0
    ds_read_b128 v[200:203], v241 offset:4096
    ds_read_b128 v[204:207], v241 offset:8192
    ds_read_b128 v[208:211], v241 offset:12288
    ds_read_b128 v[212:215], v241 offset:16384
    v_mfma_f32_16x16x32_bf16 v[16:19], a[160:163], a[80:83], v[16:19]
    s_waitcnt vmcnt(20)
    ds_read_b128 a[176:179], v232 offset:16896
    ds_read_b128 a[180:183], v232 offset:17408
    ds_read_b128 a[184:187], v232 offset:16960
    ds_read_b128 a[188:191], v232 offset:17472
    v_mfma_f32_16x16x32_bf16 v[20:23], a[160:163], a[84:87], v[20:23]
    s_waitcnt vmcnt(16)
    ds_read_b64_tr_b16 a[240:241], v237 offset:21120
    ds_read_b64_tr_b16 a[242:243], v237 offset:21376
    ds_read_b64_tr_b16 a[244:245], v237 offset:21152
    ds_read_b64_tr_b16 a[246:247], v237 offset:21408
    ds_read_b64_tr_b16 a[248:249], v237 offset:21184
    v_mfma_f32_16x16x32_bf16 v[24:27], a[160:163], a[88:91], v[24:27]
    ds_read_b64_tr_b16 a[250:251], v237 offset:21440
    ds_read_b64_tr_b16 a[252:253], v237 offset:21216
    ds_read_b64_tr_b16 a[254:255], v237 offset:21472
    v_mfma_f32_16x16x32_bf16 v[28:31], a[160:163], a[92:95], v[28:31]
    v_mfma_f32_16x16x32_bf16 v[32:35], a[160:163], a[96:99], v[32:35]
    v_mfma_f32_16x16x32_bf16 v[36:39], a[164:167], a[80:83], v[36:39]
    v_mfma_f32_16x16x32_bf16 v[40:43], a[164:167], a[84:87], v[40:43]
    v_mfma_f32_16x16x32_bf16 v[44:47], a[164:167], a[88:91], v[44:47]
    v_fma_f32 v68, v68, s30, -v247
    v_fma_f32 v69, v69, s30, -v247
    v_fma_f32 v70, v70, s30, -v247
    v_fma_f32 v71, v71, s30, -v247
    v_exp_f32 v68, v68
    v_mfma_f32_16x16x32_bf16 v[48:51], a[164:167], a[92:95], v[48:51]
    v_exp_f32 v69, v69
    v_exp_f32 v70, v70
    v_exp_f32 v71, v71
    v_mfma_f32_16x16x32_bf16 v[52:55], a[164:167], a[96:99], v[52:55]
    v_cvt_pk_bf16_f32 v224, v68, v69
    v_add_f32 v252, v252, v68
    v_cvt_pk_bf16_f32 v225, v70, v71
    v_add_f32 v252, v252, v69
    ds_write_b64 v242, v[224:225] offset:32768
    v_mfma_f32_16x16x32_bf16 v[96:99], a[224:227], v[176:179], v[96:99]
    v_add_f32 v252, v252, v70
    v_add_f32 v252, v252, v71
    s_add_u32 m0, s29, 16896
    s_add_u32 s35, s94, 327680
    s_waitcnt lgkmcnt(9)
    buffer_load_dwordx4 v9, s[12:15], s35 offen nt lds
    v_mfma_f32_16x16x32_bf16 v[100:103], a[224:227], v[180:183], v[100:103]
    buffer_load_dwordx4 v10, s[12:15], s35 offen offset:1056 nt lds
    v_mfma_f32_16x16x32_bf16 v[104:107], a[224:227], v[184:187], v[104:107]
    v_mfma_f32_16x16x32_bf16 v[108:111], a[224:227], v[188:191], v[108:111]
    v_mfma_f32_16x16x32_bf16 v[112:115], a[224:227], v[192:195], v[112:115]
    buffer_load_dwordx4 v11, s[12:15], s35 offen offset:2112 nt lds
    v_mfma_f32_16x16x32_bf16 v[116:119], a[228:231], v[176:179], v[116:119]
    v_mfma_f32_16x16x32_bf16 v[120:123], a[228:231], v[180:183], v[120:123]
    v_mfma_f32_16x16x32_bf16 v[124:127], a[228:231], v[184:187], v[124:127]
    buffer_load_dwordx4 v12, s[12:15], s35 offen offset:3168 nt lds
    v_mfma_f32_16x16x32_bf16 v[128:131], a[228:231], v[188:191], v[128:131]
    v_mfma_f32_16x16x32_bf16 v[132:135], a[228:231], v[192:195], v[132:135]
    v_mfma_f32_16x16x32_bf16 v[16:19], a[168:171], a[100:103], v[16:19]
    v_mfma_f32_16x16x32_bf16 v[20:23], a[168:171], a[104:107], v[20:23]
    v_fma_f32 v88, v88, s30, -v247
    v_fma_f32 v89, v89, s30, -v247
    v_fma_f32 v90, v90, s30, -v247
    v_fma_f32 v91, v91, s30, -v247
    v_exp_f32 v88, v88
    v_mfma_f32_16x16x32_bf16 v[24:27], a[168:171], a[108:111], v[24:27]
    v_exp_f32 v89, v89
    v_exp_f32 v90, v90
    v_exp_f32 v91, v91
    v_mfma_f32_16x16x32_bf16 v[28:31], a[168:171], a[112:115], v[28:31]
    v_cvt_pk_bf16_f32 v226, v88, v89
    v_add_f32 v252, v252, v88
    v_cvt_pk_bf16_f32 v227, v90, v91
    v_add_f32 v252, v252, v89
    ds_write_b64 v243, v[226:227] offset:32768
    v_mfma_f32_16x16x32_bf16 v[32:35], a[168:171], a[116:119], v[32:35]
    v_add_f32 v252, v252, v90
    v_add_f32 v252, v252, v91
    s_add_u32 m0, s29, 21120
    s_add_u32 s36, s98, 196608
    s_waitcnt lgkmcnt(2)
    buffer_load_dwordx4 v233, s[16:19], s36 offen nt lds
    v_mfma_f32_16x16x32_bf16 v[36:39], a[172:175], a[100:103], v[36:39]
    v_mfma_f32_16x16x32_bf16 v[40:43], a[172:175], a[104:107], v[40:43]
    v_mfma_f32_16x16x32_bf16 v[44:47], a[172:175], a[108:111], v[44:47]
    buffer_load_dwordx4 v234, s[16:19], s36 offen offset:1056 nt lds
    v_mfma_f32_16x16x32_bf16 v[48:51], a[172:175], a[112:115], v[48:51]
    v_mfma_f32_16x16x32_bf16 v[52:55], a[172:175], a[116:119], v[52:55]
    v_mfma_f32_16x16x32_bf16 v[136:139], a[232:235], v[176:179], v[136:139]
    buffer_load_dwordx4 v235, s[16:19], s36 offen offset:2112 nt lds
    v_mfma_f32_16x16x32_bf16 v[140:143], a[232:235], v[180:183], v[140:143]
    v_mfma_f32_16x16x32_bf16 v[144:147], a[232:235], v[184:187], v[144:147]
    v_mfma_f32_16x16x32_bf16 v[148:151], a[232:235], v[188:191], v[148:151]
    buffer_load_dwordx4 v236, s[16:19], s36 offen offset:3168 nt lds
    v_mfma_f32_16x16x32_bf16 v[152:155], a[232:235], v[192:195], v[152:155]
    v_mfma_f32_16x16x32_bf16 v[156:159], a[236:239], v[176:179], v[156:159]
    v_mfma_f32_16x16x32_bf16 v[160:163], a[236:239], v[180:183], v[160:163]
    v_fma_f32 v72, v72, s30, -v248
    v_fma_f32 v73, v73, s30, -v248
    v_fma_f32 v74, v74, s30, -v248
    v_fma_f32 v75, v75, s30, -v248
    v_exp_f32 v72, v72
    v_mfma_f32_16x16x32_bf16 v[164:167], a[236:239], v[184:187], v[164:167]
    v_exp_f32 v73, v73
    v_exp_f32 v74, v74
    v_exp_f32 v75, v75
    v_mfma_f32_16x16x32_bf16 v[168:171], a[236:239], v[188:191], v[168:171]
    v_cvt_pk_bf16_f32 v228, v72, v73
    v_add_f32 v253, v253, v72
    v_cvt_pk_bf16_f32 v229, v74, v75
    v_add_f32 v253, v253, v73
    ds_write_b64 v242, v[228:229] offset:36864
    v_mfma_f32_16x16x32_bf16 v[172:175], a[236:239], v[192:195], v[172:175]
    v_add_f32 v253, v253, v74
    v_add_f32 v253, v253, v75
    v_mfma_f32_16x16x32_bf16 v[16:19], a[176:179], a[120:123], v[16:19]
    s_waitcnt vmcnt(20)
    ds_read_b128 a[160:163], v232 offset:8448
    ds_read_b128 a[164:167], v232 offset:8960
    ds_read_b128 a[168:171], v232 offset:8512
    ds_read_b128 a[172:175], v232 offset:9024
    v_mfma_f32_16x16x32_bf16 v[20:23], a[176:179], a[124:127], v[20:23]
    s_waitcnt vmcnt(16)
    ds_read_b64_tr_b16 a[224:225], v237 offset:12672
    ds_read_b64_tr_b16 a[226:227], v237 offset:12928
    ds_read_b64_tr_b16 a[228:229], v237 offset:12704
    ds_read_b64_tr_b16 a[230:231], v237 offset:12960
    ds_read_b64_tr_b16 a[232:233], v237 offset:12736
    v_mfma_f32_16x16x32_bf16 v[24:27], a[176:179], a[128:131], v[24:27]
    ds_read_b64_tr_b16 a[234:235], v237 offset:12992
    ds_read_b64_tr_b16 a[236:237], v237 offset:12768
    ds_read_b64_tr_b16 a[238:239], v237 offset:13024
    v_mfma_f32_16x16x32_bf16 v[28:31], a[176:179], a[132:135], v[28:31]
    v_mfma_f32_16x16x32_bf16 v[32:35], a[176:179], a[136:139], v[32:35]
    v_mfma_f32_16x16x32_bf16 v[36:39], a[180:183], a[120:123], v[36:39]
    v_mfma_f32_16x16x32_bf16 v[40:43], a[180:183], a[124:127], v[40:43]
    v_mfma_f32_16x16x32_bf16 v[44:47], a[180:183], a[128:131], v[44:47]
    v_mfma_f32_16x16x32_bf16 v[48:51], a[180:183], a[132:135], v[48:51]
    s_add_u32 m0, s29, 8448
    s_add_u32 s37, s95, 327680
    s_waitcnt lgkmcnt(8)
    buffer_load_dwordx4 v9, s[12:15], s37 offen nt lds
    v_mfma_f32_16x16x32_bf16 v[52:55], a[180:183], a[136:139], v[52:55]
    v_mfma_f32_16x16x32_bf16 v[96:99], a[240:243], v[196:199], v[96:99]
    v_fma_f32 v92, v92, s30, -v248
    v_fma_f32 v93, v93, s30, -v248
    v_fma_f32 v94, v94, s30, -v248
    v_fma_f32 v95, v95, s30, -v248
    v_exp_f32 v92, v92
    v_mfma_f32_16x16x32_bf16 v[100:103], a[240:243], v[200:203], v[100:103]
    buffer_load_dwordx4 v10, s[12:15], s37 offen offset:1056 nt lds
    v_exp_f32 v93, v93
    v_exp_f32 v94, v94
    v_mfma_f32_16x16x32_bf16 v[104:107], a[240:243], v[204:207], v[104:107]
    v_exp_f32 v95, v95
    v_cvt_pk_bf16_f32 v230, v92, v93
    v_add_f32 v253, v253, v92
    v_cvt_pk_bf16_f32 v231, v94, v95
    v_mfma_f32_16x16x32_bf16 v[108:111], a[240:243], v[208:211], v[108:111]
    v_add_f32 v253, v253, v93
    ds_write_b64 v243, v[230:231] offset:36864
    v_add_f32 v253, v253, v94
    v_add_f32 v253, v253, v95
    v_mfma_f32_16x16x32_bf16 v[112:115], a[240:243], v[212:215], v[112:115]
    buffer_load_dwordx4 v11, s[12:15], s37 offen offset:2112 nt lds
    v_mfma_f32_16x16x32_bf16 v[116:119], a[244:247], v[196:199], v[116:119]
    v_mfma_f32_16x16x32_bf16 v[120:123], a[244:247], v[200:203], v[120:123]
    v_mfma_f32_16x16x32_bf16 v[124:127], a[244:247], v[204:207], v[124:127]
    buffer_load_dwordx4 v12, s[12:15], s37 offen offset:3168 nt lds
    v_mfma_f32_16x16x32_bf16 v[128:131], a[244:247], v[208:211], v[128:131]
    v_mfma_f32_16x16x32_bf16 v[132:135], a[244:247], v[212:215], v[132:135]
    v_mfma_f32_16x16x32_bf16 v[16:19], a[184:187], a[140:143], v[16:19]
    v_mfma_f32_16x16x32_bf16 v[20:23], a[184:187], a[144:147], v[20:23]
    v_mfma_f32_16x16x32_bf16 v[24:27], a[184:187], a[148:151], v[24:27]
    v_mfma_f32_16x16x32_bf16 v[28:31], a[184:187], a[152:155], v[28:31]
    v_mfma_f32_16x16x32_bf16 v[32:35], a[184:187], a[156:159], v[32:35]
    s_add_u32 m0, s29, 12672
    s_add_u32 s38, s99, 196608
    s_waitcnt lgkmcnt(1)
    buffer_load_dwordx4 v233, s[16:19], s38 offen nt lds
    v_mfma_f32_16x16x32_bf16 v[36:39], a[188:191], a[140:143], v[36:39]
    v_mfma_f32_16x16x32_bf16 v[40:43], a[188:191], a[144:147], v[40:43]
    v_mfma_f32_16x16x32_bf16 v[44:47], a[188:191], a[148:151], v[44:47]
    buffer_load_dwordx4 v234, s[16:19], s38 offen offset:1056 nt lds
    v_mfma_f32_16x16x32_bf16 v[48:51], a[188:191], a[152:155], v[48:51]
    v_mfma_f32_16x16x32_bf16 v[52:55], a[188:191], a[156:159], v[52:55]
    v_mfma_f32_16x16x32_bf16 v[136:139], a[248:251], v[196:199], v[136:139]
    buffer_load_dwordx4 v235, s[16:19], s38 offen offset:2112 nt lds
    v_mfma_f32_16x16x32_bf16 v[140:143], a[248:251], v[200:203], v[140:143]
    v_mfma_f32_16x16x32_bf16 v[144:147], a[248:251], v[204:207], v[144:147]
    v_mfma_f32_16x16x32_bf16 v[148:151], a[248:251], v[208:211], v[148:151]
    buffer_load_dwordx4 v236, s[16:19], s38 offen offset:3168 nt lds
    v_mfma_f32_16x16x32_bf16 v[152:155], a[248:251], v[212:215], v[152:155]
    v_mfma_f32_16x16x32_bf16 v[156:159], a[252:255], v[196:199], v[156:159]
    v_mfma_f32_16x16x32_bf16 v[160:163], a[252:255], v[200:203], v[160:163]
    v_mfma_f32_16x16x32_bf16 v[164:167], a[252:255], v[204:207], v[164:167]
    v_mfma_f32_16x16x32_bf16 v[168:171], a[252:255], v[208:211], v[168:171]
    v_mfma_f32_16x16x32_bf16 v[172:175], a[252:255], v[212:215], v[172:175]
    s_waitcnt lgkmcnt(0)
    s_barrier
    v_mfma_f32_16x16x32_bf16 v[56:59], a[160:163], a[0:3], 0
    s_waitcnt vmcnt(20)
    ds_read_b128 a[176:179], v232 offset:0
    ds_read_b128 a[180:183], v232 offset:512
    ds_read_b128 a[184:187], v232 offset:64
    ds_read_b128 a[188:191], v232 offset:576
    ds_read_b128 v[176:179], v238 offset:20480
    v_mfma_f32_16x16x32_bf16 v[60:63], a[160:163], a[4:7], 0
    ds_read_b128 v[180:183], v238 offset:24576
    ds_read_b128 v[184:187], v238 offset:28672
    ds_read_b128 v[188:191], v238 offset:32768
    ds_read_b128 v[192:195], v238 offset:36864
    s_waitcnt vmcnt(16)
    ds_read_b64_tr_b16 a[240:241], v237 offset:4224
    v_mfma_f32_16x16x32_bf16 v[64:67], a[160:163], a[8:11], 0
    ds_read_b64_tr_b16 a[242:243], v237 offset:4480
    ds_read_b64_tr_b16 a[244:245], v237 offset:4256
    ds_read_b64_tr_b16 a[246:247], v237 offset:4512
    ds_read_b64_tr_b16 a[248:249], v237 offset:4288
    ds_read_b64_tr_b16 a[250:251], v237 offset:4544
    v_mfma_f32_16x16x32_bf16 v[68:71], a[160:163], a[12:15], 0
    ds_read_b64_tr_b16 a[252:253], v237 offset:4320
    ds_read_b64_tr_b16 a[254:255], v237 offset:4576
    v_fma_f32 v16, v16, s30, -v244
    v_fma_f32 v17, v17, s30, -v244
    v_fma_f32 v18, v18, s30, -v244
    v_mfma_f32_16x16x32_bf16 v[72:75], a[160:163], a[16:19], 0
    v_fma_f32 v19, v19, s30, -v244
    v_exp_f32 v16, v16
    v_exp_f32 v17, v17
    v_mfma_f32_16x16x32_bf16 v[76:79], a[164:167], a[0:3], 0
    v_exp_f32 v18, v18
    v_exp_f32 v19, v19
    v_cvt_pk_bf16_f32 v216, v16, v17
    v_mfma_f32_16x16x32_bf16 v[80:83], a[164:167], a[4:7], 0
    v_add_f32 v249, v249, v16
    v_cvt_pk_bf16_f32 v217, v18, v19
    v_add_f32 v249, v249, v17
    ds_write_b64 v242, v[216:217] offset:0
    v_add_f32 v249, v249, v18
    v_mfma_f32_16x16x32_bf16 v[84:87], a[164:167], a[8:11], 0
    v_add_f32 v249, v249, v19
    ds_read_b128 v[196:199], v239 offset:20480
    ds_read_b128 v[200:203], v239 offset:24576
    ds_read_b128 v[204:207], v239 offset:28672
    ds_read_b128 v[208:211], v239 offset:32768
    v_mfma_f32_16x16x32_bf16 v[88:91], a[164:167], a[12:15], 0
    ds_read_b128 v[212:215], v239 offset:36864
    s_add_u32 m0, s29, 0
    s_add_u32 s39, s92, 393216
    s_waitcnt lgkmcnt(15)
    buffer_load_dwordx4 v9, s[12:15], s39 offen nt lds
    v_mfma_f32_16x16x32_bf16 v[92:95], a[164:167], a[16:19], 0
    v_mfma_f32_16x16x32_bf16 v[96:99], a[224:227], v[176:179], v[96:99]
    v_mfma_f32_16x16x32_bf16 v[100:103], a[224:227], v[180:183], v[100:103]
    buffer_load_dwordx4 v10, s[12:15], s39 offen offset:1056 nt lds
    v_mfma_f32_16x16x32_bf16 v[104:107], a[224:227], v[184:187], v[104:107]
    v_mfma_f32_16x16x32_bf16 v[108:111], a[224:227], v[188:191], v[108:111]
    s_waitcnt lgkmcnt(14)
    v_mfma_f32_16x16x32_bf16 v[112:115], a[224:227], v[192:195], v[112:115]
    v_fma_f32 v36, v36, s30, -v244
    v_fma_f32 v37, v37, s30, -v244
    v_fma_f32 v38, v38, s30, -v244
    v_fma_f32 v39, v39, s30, -v244
    v_exp_f32 v36, v36
    v_mfma_f32_16x16x32_bf16 v[116:119], a[228:231], v[176:179], v[116:119]
    v_exp_f32 v37, v37
    v_exp_f32 v38, v38
    v_exp_f32 v39, v39
    v_mfma_f32_16x16x32_bf16 v[120:123], a[228:231], v[180:183], v[120:123]
    v_cvt_pk_bf16_f32 v218, v36, v37
    v_add_f32 v249, v249, v36
    v_cvt_pk_bf16_f32 v219, v38, v39
    v_add_f32 v249, v249, v37
    ds_write_b64 v243, v[218:219] offset:0
    v_mfma_f32_16x16x32_bf16 v[124:127], a[228:231], v[184:187], v[124:127]
    v_add_f32 v249, v249, v38
    v_add_f32 v249, v249, v39
    buffer_load_dwordx4 v11, s[12:15], s39 offen offset:2112 nt lds
    buffer_load_dwordx4 v12, s[12:15], s39 offen offset:3168 nt lds
    v_mfma_f32_16x16x32_bf16 v[128:131], a[228:231], v[188:191], v[128:131]
    v_mfma_f32_16x16x32_bf16 v[132:135], a[228:231], v[192:195], v[132:135]
    v_mfma_f32_16x16x32_bf16 v[56:59], a[168:171], a[20:23], v[56:59]
    v_mfma_f32_16x16x32_bf16 v[60:63], a[168:171], a[24:27], v[60:63]
    v_mfma_f32_16x16x32_bf16 v[64:67], a[168:171], a[28:31], v[64:67]
    v_mfma_f32_16x16x32_bf16 v[68:71], a[168:171], a[32:35], v[68:71]
    v_mfma_f32_16x16x32_bf16 v[72:75], a[168:171], a[36:39], v[72:75]
    s_add_u32 m0, s29, 4224
    s_add_u32 s32, s96, 262144
    s_waitcnt lgkmcnt(7)
    buffer_load_dwordx4 v233, s[16:19], s32 offen nt lds
    v_mfma_f32_16x16x32_bf16 v[76:79], a[172:175], a[20:23], v[76:79]
    v_mfma_f32_16x16x32_bf16 v[80:83], a[172:175], a[24:27], v[80:83]
    v_mfma_f32_16x16x32_bf16 v[84:87], a[172:175], a[28:31], v[84:87]
    buffer_load_dwordx4 v234, s[16:19], s32 offen offset:1056 nt lds
    v_mfma_f32_16x16x32_bf16 v[88:91], a[172:175], a[32:35], v[88:91]
    v_mfma_f32_16x16x32_bf16 v[92:95], a[172:175], a[36:39], v[92:95]
    v_fma_f32 v20, v20, s30, -v245
    v_fma_f32 v21, v21, s30, -v245
    v_fma_f32 v22, v22, s30, -v245
    v_fma_f32 v23, v23, s30, -v245
    v_exp_f32 v20, v20
    v_mfma_f32_16x16x32_bf16 v[136:139], a[232:235], v[176:179], v[136:139]
    v_exp_f32 v21, v21
    v_exp_f32 v22, v22
    v_exp_f32 v23, v23
    v_mfma_f32_16x16x32_bf16 v[140:143], a[232:235], v[180:183], v[140:143]
    v_cvt_pk_bf16_f32 v220, v20, v21
    v_add_f32 v250, v250, v20
    v_cvt_pk_bf16_f32 v221, v22, v23
    v_add_f32 v250, v250, v21
    ds_write_b64 v242, v[220:221] offset:4096
    v_mfma_f32_16x16x32_bf16 v[144:147], a[232:235], v[184:187], v[144:147]
    v_add_f32 v250, v250, v22
    v_add_f32 v250, v250, v23
    buffer_load_dwordx4 v235, s[16:19], s32 offen offset:2112 nt lds
    v_mfma_f32_16x16x32_bf16 v[148:151], a[232:235], v[188:191], v[148:151]
    buffer_load_dwordx4 v236, s[16:19], s32 offen offset:3168 nt lds
    v_mfma_f32_16x16x32_bf16 v[152:155], a[232:235], v[192:195], v[152:155]
    v_mfma_f32_16x16x32_bf16 v[156:159], a[236:239], v[176:179], v[156:159]
    v_mfma_f32_16x16x32_bf16 v[160:163], a[236:239], v[180:183], v[160:163]
    v_mfma_f32_16x16x32_bf16 v[164:167], a[236:239], v[184:187], v[164:167]
    v_mfma_f32_16x16x32_bf16 v[168:171], a[236:239], v[188:191], v[168:171]
    v_mfma_f32_16x16x32_bf16 v[172:175], a[236:239], v[192:195], v[172:175]
    ds_read_b128 v[176:179], v240 offset:20480
    ds_read_b128 v[180:183], v240 offset:24576
    ds_read_b128 v[184:187], v240 offset:28672
    ds_read_b128 v[188:191], v240 offset:32768
    ds_read_b128 v[192:195], v240 offset:36864
    v_mfma_f32_16x16x32_bf16 v[56:59], a[176:179], a[40:43], v[56:59]
    s_waitcnt vmcnt(20)
    ds_read_b128 a[160:163], v232 offset:16896
    ds_read_b128 a[164:167], v232 offset:17408
    ds_read_b128 a[168:171], v232 offset:16960
    ds_read_b128 a[172:175], v232 offset:17472
    v_mfma_f32_16x16x32_bf16 v[60:63], a[176:179], a[44:47], v[60:63]
    s_waitcnt vmcnt(16)
    ds_read_b64_tr_b16 a[224:225], v237 offset:21120
    ds_read_b64_tr_b16 a[226:227], v237 offset:21376
    ds_read_b64_tr_b16 a[228:229], v237 offset:21152
    ds_read_b64_tr_b16 a[230:231], v237 offset:21408
    ds_read_b64_tr_b16 a[232:233], v237 offset:21184
    v_mfma_f32_16x16x32_bf16 v[64:67], a[176:179], a[48:51], v[64:67]
    ds_read_b64_tr_b16 a[234:235], v237 offset:21440
    ds_read_b64_tr_b16 a[236:237], v237 offset:21216
    ds_read_b64_tr_b16 a[238:239], v237 offset:21472
    v_mfma_f32_16x16x32_bf16 v[68:71], a[176:179], a[52:55], v[68:71]
    v_fma_f32 v40, v40, s30, -v245
    v_fma_f32 v41, v41, s30, -v245
    v_fma_f32 v42, v42, s30, -v245
    v_fma_f32 v43, v43, s30, -v245
    v_exp_f32 v40, v40
    v_mfma_f32_16x16x32_bf16 v[72:75], a[176:179], a[56:59], v[72:75]
    v_exp_f32 v41, v41
    v_exp_f32 v42, v42
    v_exp_f32 v43, v43
    v_mfma_f32_16x16x32_bf16 v[76:79], a[180:183], a[40:43], v[76:79]
    v_cvt_pk_bf16_f32 v222, v40, v41
    v_add_f32 v250, v250, v40
    v_cvt_pk_bf16_f32 v223, v42, v43
    v_add_f32 v250, v250, v41
    ds_write_b64 v243, v[222:223] offset:4096
    v_mfma_f32_16x16x32_bf16 v[80:83], a[180:183], a[44:47], v[80:83]
    v_add_f32 v250, v250, v42
    v_add_f32 v250, v250, v43
    v_mfma_f32_16x16x32_bf16 v[84:87], a[180:183], a[48:51], v[84:87]
    v_mfma_f32_16x16x32_bf16 v[88:91], a[180:183], a[52:55], v[88:91]
    s_add_u32 m0, s29, 16896
    s_add_u32 s33, s93, 393216
    s_waitcnt lgkmcnt(9)
    buffer_load_dwordx4 v9, s[12:15], s33 offen nt lds
    v_mfma_f32_16x16x32_bf16 v[92:95], a[180:183], a[56:59], v[92:95]
    v_mfma_f32_16x16x32_bf16 v[96:99], a[240:243], v[196:199], v[96:99]
    v_mfma_f32_16x16x32_bf16 v[100:103], a[240:243], v[200:203], v[100:103]
    buffer_load_dwordx4 v10, s[12:15], s33 offen offset:1056 nt lds
    v_mfma_f32_16x16x32_bf16 v[104:107], a[240:243], v[204:207], v[104:107]
    v_mfma_f32_16x16x32_bf16 v[108:111], a[240:243], v[208:211], v[108:111]
    v_mfma_f32_16x16x32_bf16 v[112:115], a[240:243], v[212:215], v[112:115]
    buffer_load_dwordx4 v11, s[12:15], s33 offen offset:2112 nt lds
    v_mfma_f32_16x16x32_bf16 v[116:119], a[244:247], v[196:199], v[116:119]
    v_mfma_f32_16x16x32_bf16 v[120:123], a[244:247], v[200:203], v[120:123]
    v_mfma_f32_16x16x32_bf16 v[124:127], a[244:247], v[204:207], v[124:127]
    buffer_load_dwordx4 v12, s[12:15], s33 offen offset:3168 nt lds
    v_mfma_f32_16x16x32_bf16 v[128:131], a[244:247], v[208:211], v[128:131]
    v_fma_f32 v24, v24, s30, -v246
    v_fma_f32 v25, v25, s30, -v246
    v_fma_f32 v26, v26, s30, -v246
    v_fma_f32 v27, v27, s30, -v246
    v_exp_f32 v24, v24
    v_mfma_f32_16x16x32_bf16 v[132:135], a[244:247], v[212:215], v[132:135]
    v_exp_f32 v25, v25
    v_exp_f32 v26, v26
    v_exp_f32 v27, v27
    v_mfma_f32_16x16x32_bf16 v[56:59], a[184:187], a[60:63], v[56:59]
    v_cvt_pk_bf16_f32 v224, v24, v25
    v_add_f32 v251, v251, v24
    v_cvt_pk_bf16_f32 v225, v26, v27
    v_add_f32 v251, v251, v25
    ds_write_b64 v242, v[224:225] offset:8192
    v_mfma_f32_16x16x32_bf16 v[60:63], a[184:187], a[64:67], v[60:63]
    v_add_f32 v251, v251, v26
    v_add_f32 v251, v251, v27
    v_mfma_f32_16x16x32_bf16 v[64:67], a[184:187], a[68:71], v[64:67]
    v_mfma_f32_16x16x32_bf16 v[68:71], a[184:187], a[72:75], v[68:71]
    v_mfma_f32_16x16x32_bf16 v[72:75], a[184:187], a[76:79], v[72:75]
    s_add_u32 m0, s29, 21120
    s_add_u32 s34, s97, 262144
    s_waitcnt lgkmcnt(2)
    buffer_load_dwordx4 v233, s[16:19], s34 offen nt lds
    v_mfma_f32_16x16x32_bf16 v[76:79], a[188:191], a[60:63], v[76:79]
    v_mfma_f32_16x16x32_bf16 v[80:83], a[188:191], a[64:67], v[80:83]
    v_mfma_f32_16x16x32_bf16 v[84:87], a[188:191], a[68:71], v[84:87]
    buffer_load_dwordx4 v234, s[16:19], s34 offen offset:1056 nt lds
    v_mfma_f32_16x16x32_bf16 v[88:91], a[188:191], a[72:75], v[88:91]
    v_mfma_f32_16x16x32_bf16 v[92:95], a[188:191], a[76:79], v[92:95]
    v_mfma_f32_16x16x32_bf16 v[136:139], a[248:251], v[196:199], v[136:139]
    buffer_load_dwordx4 v235, s[16:19], s34 offen offset:2112 nt lds
    v_mfma_f32_16x16x32_bf16 v[140:143], a[248:251], v[200:203], v[140:143]
    v_mfma_f32_16x16x32_bf16 v[144:147], a[248:251], v[204:207], v[144:147]
    v_fma_f32 v44, v44, s30, -v246
    v_fma_f32 v45, v45, s30, -v246
    v_fma_f32 v46, v46, s30, -v246
    v_fma_f32 v47, v47, s30, -v246
    v_exp_f32 v44, v44
    v_mfma_f32_16x16x32_bf16 v[148:151], a[248:251], v[208:211], v[148:151]
    v_exp_f32 v45, v45
    v_exp_f32 v46, v46
    v_exp_f32 v47, v47
    v_mfma_f32_16x16x32_bf16 v[152:155], a[248:251], v[212:215], v[152:155]
    v_cvt_pk_bf16_f32 v226, v44, v45
    v_add_f32 v251, v251, v44
    v_cvt_pk_bf16_f32 v227, v46, v47
    v_add_f32 v251, v251, v45
    ds_write_b64 v243, v[226:227] offset:8192
    v_mfma_f32_16x16x32_bf16 v[156:159], a[252:255], v[196:199], v[156:159]
    v_add_f32 v251, v251, v46
    v_add_f32 v251, v251, v47
    buffer_load_dwordx4 v236, s[16:19], s34 offen offset:3168 nt lds
    v_mfma_f32_16x16x32_bf16 v[160:163], a[252:255], v[200:203], v[160:163]
    v_mfma_f32_16x16x32_bf16 v[164:167], a[252:255], v[204:207], v[164:167]
    v_mfma_f32_16x16x32_bf16 v[168:171], a[252:255], v[208:211], v[168:171]
    v_mfma_f32_16x16x32_bf16 v[172:175], a[252:255], v[212:215], v[172:175]
    ds_read_b128 v[196:199], v241 offset:20480
    ds_read_b128 v[200:203], v241 offset:24576
    ds_read_b128 v[204:207], v241 offset:28672
    ds_read_b128 v[208:211], v241 offset:32768
    ds_read_b128 v[212:215], v241 offset:36864
    v_mfma_f32_16x16x32_bf16 v[56:59], a[160:163], a[80:83], v[56:59]
    s_waitcnt vmcnt(20)
    ds_read_b128 a[176:179], v232 offset:8448
    ds_read_b128 a[180:183], v232 offset:8960
    ds_read_b128 a[184:187], v232 offset:8512
    ds_read_b128 a[188:191], v232 offset:9024
    v_mfma_f32_16x16x32_bf16 v[60:63], a[160:163], a[84:87], v[60:63]
    s_waitcnt vmcnt(16)
    ds_read_b64_tr_b16 a[240:241], v237 offset:12672
    ds_read_b64_tr_b16 a[242:243], v237 offset:12928
    ds_read_b64_tr_b16 a[244:245], v237 offset:12704
    ds_read_b64_tr_b16 a[246:247], v237 offset:12960
    ds_read_b64_tr_b16 a[248:249], v237 offset:12736
    v_mfma_f32_16x16x32_bf16 v[64:67], a[160:163], a[88:91], v[64:67]
    ds_read_b64_tr_b16 a[250:251], v237 offset:12992
    ds_read_b64_tr_b16 a[252:253], v237 offset:12768
    ds_read_b64_tr_b16 a[254:255], v237 offset:13024
    v_mfma_f32_16x16x32_bf16 v[68:71], a[160:163], a[92:95], v[68:71]
    v_mfma_f32_16x16x32_bf16 v[72:75], a[160:163], a[96:99], v[72:75]
    v_mfma_f32_16x16x32_bf16 v[76:79], a[164:167], a[80:83], v[76:79]
    v_mfma_f32_16x16x32_bf16 v[80:83], a[164:167], a[84:87], v[80:83]
    v_mfma_f32_16x16x32_bf16 v[84:87], a[164:167], a[88:91], v[84:87]
    v_fma_f32 v28, v28, s30, -v247
    v_fma_f32 v29, v29, s30, -v247
    v_fma_f32 v30, v30, s30, -v247
    v_fma_f32 v31, v31, s30, -v247
    v_exp_f32 v28, v28
    v_mfma_f32_16x16x32_bf16 v[88:91], a[164:167], a[92:95], v[88:91]
    v_exp_f32 v29, v29
    v_exp_f32 v30, v30
    v_exp_f32 v31, v31
    v_mfma_f32_16x16x32_bf16 v[92:95], a[164:167], a[96:99], v[92:95]
    v_cvt_pk_bf16_f32 v228, v28, v29
    v_add_f32 v252, v252, v28
    v_cvt_pk_bf16_f32 v229, v30, v31
    v_add_f32 v252, v252, v29
    ds_write_b64 v242, v[228:229] offset:12288
    v_mfma_f32_16x16x32_bf16 v[96:99], a[224:227], v[176:179], v[96:99]
    v_add_f32 v252, v252, v30
    v_add_f32 v252, v252, v31
    s_add_u32 m0, s29, 8448
    s_add_u32 s35, s94, 393216
    s_waitcnt lgkmcnt(9)
    buffer_load_dwordx4 v9, s[12:15], s35 offen nt lds
    v_mfma_f32_16x16x32_bf16 v[100:103], a[224:227], v[180:183], v[100:103]
    buffer_load_dwordx4 v10, s[12:15], s35 offen offset:1056 nt lds
    v_mfma_f32_16x16x32_bf16 v[104:107], a[224:227], v[184:187], v[104:107]
    v_mfma_f32_16x16x32_bf16 v[108:111], a[224:227], v[188:191], v[108:111]
    v_mfma_f32_16x16x32_bf16 v[112:115], a[224:227], v[192:195], v[112:115]
    buffer_load_dwordx4 v11, s[12:15], s35 offen offset:2112 nt lds
    v_mfma_f32_16x16x32_bf16 v[116:119], a[228:231], v[176:179], v[116:119]
    v_mfma_f32_16x16x32_bf16 v[120:123], a[228:231], v[180:183], v[120:123]
    v_mfma_f32_16x16x32_bf16 v[124:127], a[228:231], v[184:187], v[124:127]
    buffer_load_dwordx4 v12, s[12:15], s35 offen offset:3168 nt lds
    v_mfma_f32_16x16x32_bf16 v[128:131], a[228:231], v[188:191], v[128:131]
    v_mfma_f32_16x16x32_bf16 v[132:135], a[228:231], v[192:195], v[132:135]
    v_mfma_f32_16x16x32_bf16 v[56:59], a[168:171], a[100:103], v[56:59]
    v_mfma_f32_16x16x32_bf16 v[60:63], a[168:171], a[104:107], v[60:63]
    v_fma_f32 v48, v48, s30, -v247
    v_fma_f32 v49, v49, s30, -v247
    v_fma_f32 v50, v50, s30, -v247
    v_fma_f32 v51, v51, s30, -v247
    v_exp_f32 v48, v48
    v_mfma_f32_16x16x32_bf16 v[64:67], a[168:171], a[108:111], v[64:67]
    v_exp_f32 v49, v49
    v_exp_f32 v50, v50
    v_exp_f32 v51, v51
    v_mfma_f32_16x16x32_bf16 v[68:71], a[168:171], a[112:115], v[68:71]
    v_cvt_pk_bf16_f32 v230, v48, v49
    v_add_f32 v252, v252, v48
    v_cvt_pk_bf16_f32 v231, v50, v51
    v_add_f32 v252, v252, v49
    ds_write_b64 v243, v[230:231] offset:12288
    v_mfma_f32_16x16x32_bf16 v[72:75], a[168:171], a[116:119], v[72:75]
    v_add_f32 v252, v252, v50
    v_add_f32 v252, v252, v51
    s_add_u32 m0, s29, 12672
    s_add_u32 s36, s98, 262144
    s_waitcnt lgkmcnt(2)
    buffer_load_dwordx4 v233, s[16:19], s36 offen nt lds
    v_mfma_f32_16x16x32_bf16 v[76:79], a[172:175], a[100:103], v[76:79]
    v_mfma_f32_16x16x32_bf16 v[80:83], a[172:175], a[104:107], v[80:83]
    v_mfma_f32_16x16x32_bf16 v[84:87], a[172:175], a[108:111], v[84:87]
    buffer_load_dwordx4 v234, s[16:19], s36 offen offset:1056 nt lds
    v_mfma_f32_16x16x32_bf16 v[88:91], a[172:175], a[112:115], v[88:91]
    v_mfma_f32_16x16x32_bf16 v[92:95], a[172:175], a[116:119], v[92:95]
    v_mfma_f32_16x16x32_bf16 v[136:139], a[232:235], v[176:179], v[136:139]
    buffer_load_dwordx4 v235, s[16:19], s36 offen offset:2112 nt lds
    v_mfma_f32_16x16x32_bf16 v[140:143], a[232:235], v[180:183], v[140:143]
    v_mfma_f32_16x16x32_bf16 v[144:147], a[232:235], v[184:187], v[144:147]
    v_mfma_f32_16x16x32_bf16 v[148:151], a[232:235], v[188:191], v[148:151]
    buffer_load_dwordx4 v236, s[16:19], s36 offen offset:3168 nt lds
    v_mfma_f32_16x16x32_bf16 v[152:155], a[232:235], v[192:195], v[152:155]
    v_mfma_f32_16x16x32_bf16 v[156:159], a[236:239], v[176:179], v[156:159]
    v_mfma_f32_16x16x32_bf16 v[160:163], a[236:239], v[180:183], v[160:163]
    v_fma_f32 v32, v32, s30, -v248
    v_fma_f32 v33, v33, s30, -v248
    v_fma_f32 v34, v34, s30, -v248
    v_fma_f32 v35, v35, s30, -v248
    v_exp_f32 v32, v32
    v_mfma_f32_16x16x32_bf16 v[164:167], a[236:239], v[184:187], v[164:167]
    v_exp_f32 v33, v33
    v_exp_f32 v34, v34
    v_exp_f32 v35, v35
    v_mfma_f32_16x16x32_bf16 v[168:171], a[236:239], v[188:191], v[168:171]
    v_cvt_pk_bf16_f32 v216, v32, v33
    v_add_f32 v253, v253, v32
    v_cvt_pk_bf16_f32 v217, v34, v35
    v_add_f32 v253, v253, v33
    ds_write_b64 v242, v[216:217] offset:16384
    v_mfma_f32_16x16x32_bf16 v[172:175], a[236:239], v[192:195], v[172:175]
    v_add_f32 v253, v253, v34
    v_add_f32 v253, v253, v35
    v_mfma_f32_16x16x32_bf16 v[56:59], a[176:179], a[120:123], v[56:59]
    s_waitcnt vmcnt(20)
    ds_read_b128 a[160:163], v232 offset:0
    ds_read_b128 a[164:167], v232 offset:512
    ds_read_b128 a[168:171], v232 offset:64
    ds_read_b128 a[172:175], v232 offset:576
    v_mfma_f32_16x16x32_bf16 v[60:63], a[176:179], a[124:127], v[60:63]
    s_waitcnt vmcnt(16)
    ds_read_b64_tr_b16 a[224:225], v237 offset:4224
    ds_read_b64_tr_b16 a[226:227], v237 offset:4480
    ds_read_b64_tr_b16 a[228:229], v237 offset:4256
    ds_read_b64_tr_b16 a[230:231], v237 offset:4512
    ds_read_b64_tr_b16 a[232:233], v237 offset:4288
    v_mfma_f32_16x16x32_bf16 v[64:67], a[176:179], a[128:131], v[64:67]
    ds_read_b64_tr_b16 a[234:235], v237 offset:4544
    ds_read_b64_tr_b16 a[236:237], v237 offset:4320
    ds_read_b64_tr_b16 a[238:239], v237 offset:4576
    v_mfma_f32_16x16x32_bf16 v[68:71], a[176:179], a[132:135], v[68:71]
    v_mfma_f32_16x16x32_bf16 v[72:75], a[176:179], a[136:139], v[72:75]
    v_mfma_f32_16x16x32_bf16 v[76:79], a[180:183], a[120:123], v[76:79]
    v_mfma_f32_16x16x32_bf16 v[80:83], a[180:183], a[124:127], v[80:83]
    v_mfma_f32_16x16x32_bf16 v[84:87], a[180:183], a[128:131], v[84:87]
    v_mfma_f32_16x16x32_bf16 v[88:91], a[180:183], a[132:135], v[88:91]
    s_add_u32 m0, s29, 0
    s_add_u32 s37, s95, 393216
    s_waitcnt lgkmcnt(8)
    buffer_load_dwordx4 v9, s[12:15], s37 offen nt lds
    v_mfma_f32_16x16x32_bf16 v[92:95], a[180:183], a[136:139], v[92:95]
    v_mfma_f32_16x16x32_bf16 v[96:99], a[240:243], v[196:199], v[96:99]
    v_fma_f32 v52, v52, s30, -v248
    v_fma_f32 v53, v53, s30, -v248
    v_fma_f32 v54, v54, s30, -v248
    v_fma_f32 v55, v55, s30, -v248
    v_exp_f32 v52, v52
    v_mfma_f32_16x16x32_bf16 v[100:103], a[240:243], v[200:203], v[100:103]
    buffer_load_dwordx4 v10, s[12:15], s37 offen offset:1056 nt lds
    v_exp_f32 v53, v53
    v_exp_f32 v54, v54
    v_mfma_f32_16x16x32_bf16 v[104:107], a[240:243], v[204:207], v[104:107]
    v_exp_f32 v55, v55
    v_cvt_pk_bf16_f32 v218, v52, v53
    v_add_f32 v253, v253, v52
    v_cvt_pk_bf16_f32 v219, v54, v55
    v_mfma_f32_16x16x32_bf16 v[108:111], a[240:243], v[208:211], v[108:111]
    v_add_f32 v253, v253, v53
    ds_write_b64 v243, v[218:219] offset:16384
    v_add_f32 v253, v253, v54
    v_add_f32 v253, v253, v55
    v_mfma_f32_16x16x32_bf16 v[112:115], a[240:243], v[212:215], v[112:115]
    buffer_load_dwordx4 v11, s[12:15], s37 offen offset:2112 nt lds
    v_mfma_f32_16x16x32_bf16 v[116:119], a[244:247], v[196:199], v[116:119]
    v_mfma_f32_16x16x32_bf16 v[120:123], a[244:247], v[200:203], v[120:123]
    v_mfma_f32_16x16x32_bf16 v[124:127], a[244:247], v[204:207], v[124:127]
    buffer_load_dwordx4 v12, s[12:15], s37 offen offset:3168 nt lds
    v_mfma_f32_16x16x32_bf16 v[128:131], a[244:247], v[208:211], v[128:131]
    v_mfma_f32_16x16x32_bf16 v[132:135], a[244:247], v[212:215], v[132:135]
    v_mfma_f32_16x16x32_bf16 v[56:59], a[184:187], a[140:143], v[56:59]
    v_mfma_f32_16x16x32_bf16 v[60:63], a[184:187], a[144:147], v[60:63]
    v_mfma_f32_16x16x32_bf16 v[64:67], a[184:187], a[148:151], v[64:67]
    v_mfma_f32_16x16x32_bf16 v[68:71], a[184:187], a[152:155], v[68:71]
    v_mfma_f32_16x16x32_bf16 v[72:75], a[184:187], a[156:159], v[72:75]
    s_add_u32 m0, s29, 4224
    s_add_u32 s38, s99, 262144
    s_waitcnt lgkmcnt(1)
    buffer_load_dwordx4 v233, s[16:19], s38 offen nt lds
    v_mfma_f32_16x16x32_bf16 v[76:79], a[188:191], a[140:143], v[76:79]
    v_mfma_f32_16x16x32_bf16 v[80:83], a[188:191], a[144:147], v[80:83]
    v_mfma_f32_16x16x32_bf16 v[84:87], a[188:191], a[148:151], v[84:87]
    buffer_load_dwordx4 v234, s[16:19], s38 offen offset:1056 nt lds
    v_mfma_f32_16x16x32_bf16 v[88:91], a[188:191], a[152:155], v[88:91]
    v_mfma_f32_16x16x32_bf16 v[92:95], a[188:191], a[156:159], v[92:95]
    v_mfma_f32_16x16x32_bf16 v[136:139], a[248:251], v[196:199], v[136:139]
    buffer_load_dwordx4 v235, s[16:19], s38 offen offset:2112 nt lds
    v_mfma_f32_16x16x32_bf16 v[140:143], a[248:251], v[200:203], v[140:143]
    v_mfma_f32_16x16x32_bf16 v[144:147], a[248:251], v[204:207], v[144:147]
    v_mfma_f32_16x16x32_bf16 v[148:151], a[248:251], v[208:211], v[148:151]
    buffer_load_dwordx4 v236, s[16:19], s38 offen offset:3168 nt lds
    v_mfma_f32_16x16x32_bf16 v[152:155], a[248:251], v[212:215], v[152:155]
    v_mfma_f32_16x16x32_bf16 v[156:159], a[252:255], v[196:199], v[156:159]
    v_mfma_f32_16x16x32_bf16 v[160:163], a[252:255], v[200:203], v[160:163]
    v_mfma_f32_16x16x32_bf16 v[164:167], a[252:255], v[204:207], v[164:167]
    v_mfma_f32_16x16x32_bf16 v[168:171], a[252:255], v[208:211], v[168:171]
    v_mfma_f32_16x16x32_bf16 v[172:175], a[252:255], v[212:215], v[172:175]
    s_waitcnt lgkmcnt(0)
    s_barrier
    v_mfma_f32_16x16x32_bf16 v[16:19], a[160:163], a[0:3], 0
    s_waitcnt vmcnt(20)
    ds_read_b128 a[176:179], v232 offset:16896
    ds_read_b128 a[180:183], v232 offset:17408
    ds_read_b128 a[184:187], v232 offset:16960
    ds_read_b128 a[188:191], v232 offset:17472
    ds_read_b128 v[176:179], v238 offset:0
    v_mfma_f32_16x16x32_bf16 v[20:23], a[160:163], a[4:7], 0
    ds_read_b128 v[180:183], v238 offset:4096
    ds_read_b128 v[184:187], v238 offset:8192
    ds_read_b128 v[188:191], v238 offset:12288
    ds_read_b128 v[192:195], v238 offset:16384
    s_waitcnt vmcnt(16)
    ds_read_b64_tr_b16 a[240:241], v237 offset:21120
    v_mfma_f32_16x16x32_bf16 v[24:27], a[160:163], a[8:11], 0
    ds_read_b64_tr_b16 a[242:243], v237 offset:21376
    ds_read_b64_tr_b16 a[244:245], v237 offset:21152
    ds_read_b64_tr_b16 a[246:247], v237 offset:21408
    ds_read_b64_tr_b16 a[248:249], v237 offset:21184
    ds_read_b64_tr_b16 a[250:251], v237 offset:21440
    v_mfma_f32_16x16x32_bf16 v[28:31], a[160:163], a[12:15], 0
    ds_read_b64_tr_b16 a[252:253], v237 offset:21216
    ds_read_b64_tr_b16 a[254:255], v237 offset:21472
    v_fma_f32 v56, v56, s30, -v244
    v_fma_f32 v57, v57, s30, -v244
    v_fma_f32 v58, v58, s30, -v244
    v_mfma_f32_16x16x32_bf16 v[32:35], a[160:163], a[16:19], 0
    v_fma_f32 v59, v59, s30, -v244
    v_exp_f32 v56, v56
    v_exp_f32 v57, v57
    v_mfma_f32_16x16x32_bf16 v[36:39], a[164:167], a[0:3], 0
    v_exp_f32 v58, v58
    v_exp_f32 v59, v59
    v_cvt_pk_bf16_f32 v220, v56, v57
    v_mfma_f32_16x16x32_bf16 v[40:43], a[164:167], a[4:7], 0
    v_add_f32 v249, v249, v56
    v_cvt_pk_bf16_f32 v221, v58, v59
    v_add_f32 v249, v249, v57
    ds_write_b64 v242, v[220:221] offset:20480
    v_add_f32 v249, v249, v58
    v_mfma_f32_16x16x32_bf16 v[44:47], a[164:167], a[8:11], 0
    v_add_f32 v249, v249, v59
    ds_read_b128 v[196:199], v239 offset:0
    ds_read_b128 v[200:203], v239 offset:4096
    ds_read_b128 v[204:207], v239 offset:8192
    ds_read_b128 v[208:211], v239 offset:12288
    v_mfma_f32_16x16x32_bf16 v[48:51], a[164:167], a[12:15], 0
    ds_read_b128 v[212:215], v239 offset:16384
    s_add_u32 m0, s29, 16896
    s_add_u32 s39, s92, 458752
    s_waitcnt lgkmcnt(15)
    buffer_load_dwordx4 v9, s[12:15], s39 offen nt lds
    v_mfma_f32_16x16x32_bf16 v[52:55], a[164:167], a[16:19], 0
    v_mfma_f32_16x16x32_bf16 v[96:99], a[224:227], v[176:179], v[96:99]
    v_mfma_f32_16x16x32_bf16 v[100:103], a[224:227], v[180:183], v[100:103]
    buffer_load_dwordx4 v10, s[12:15], s39 offen offset:1056 nt lds
    v_mfma_f32_16x16x32_bf16 v[104:107], a[224:227], v[184:187], v[104:107]
    v_mfma_f32_16x16x32_bf16 v[108:111], a[224:227], v[188:191], v[108:111]
    s_waitcnt lgkmcnt(14)
    v_mfma_f32_16x16x32_bf16 v[112:115], a[224:227], v[192:195], v[112:115]
    v_fma_f32 v76, v76, s30, -v244
    v_fma_f32 v77, v77, s30, -v244
    v_fma_f32 v78, v78, s30, -v244
    v_fma_f32 v79, v79, s30, -v244
    v_exp_f32 v76, v76
    v_mfma_f32_16x16x32_bf16 v[116:119], a[228:231], v[176:179], v[116:119]
    v_exp_f32 v77, v77
    v_exp_f32 v78, v78
    v_exp_f32 v79, v79
    v_mfma_f32_16x16x32_bf16 v[120:123], a[228:231], v[180:183], v[120:123]
    v_cvt_pk_bf16_f32 v222, v76, v77
    v_add_f32 v249, v249, v76
    v_cvt_pk_bf16_f32 v223, v78, v79
    v_add_f32 v249, v249, v77
    ds_write_b64 v243, v[222:223] offset:20480
    v_mfma_f32_16x16x32_bf16 v[124:127], a[228:231], v[184:187], v[124:127]
    v_add_f32 v249, v249, v78
    v_add_f32 v249, v249, v79
    buffer_load_dwordx4 v11, s[12:15], s39 offen offset:2112 nt lds
    buffer_load_dwordx4 v12, s[12:15], s39 offen offset:3168 nt lds
    v_mfma_f32_16x16x32_bf16 v[128:131], a[228:231], v[188:191], v[128:131]
    v_mfma_f32_16x16x32_bf16 v[132:135], a[228:231], v[192:195], v[132:135]
    v_mfma_f32_16x16x32_bf16 v[16:19], a[168:171], a[20:23], v[16:19]
    v_mfma_f32_16x16x32_bf16 v[20:23], a[168:171], a[24:27], v[20:23]
    v_mfma_f32_16x16x32_bf16 v[24:27], a[168:171], a[28:31], v[24:27]
    v_mfma_f32_16x16x32_bf16 v[28:31], a[168:171], a[32:35], v[28:31]
    v_mfma_f32_16x16x32_bf16 v[32:35], a[168:171], a[36:39], v[32:35]
    s_add_u32 m0, s29, 21120
    s_add_u32 s32, s96, 327680
    s_waitcnt lgkmcnt(7)
    buffer_load_dwordx4 v233, s[16:19], s32 offen nt lds
    v_mfma_f32_16x16x32_bf16 v[36:39], a[172:175], a[20:23], v[36:39]
    v_mfma_f32_16x16x32_bf16 v[40:43], a[172:175], a[24:27], v[40:43]
    v_mfma_f32_16x16x32_bf16 v[44:47], a[172:175], a[28:31], v[44:47]
    buffer_load_dwordx4 v234, s[16:19], s32 offen offset:1056 nt lds
    v_mfma_f32_16x16x32_bf16 v[48:51], a[172:175], a[32:35], v[48:51]
    v_mfma_f32_16x16x32_bf16 v[52:55], a[172:175], a[36:39], v[52:55]
    v_fma_f32 v60, v60, s30, -v245
    v_fma_f32 v61, v61, s30, -v245
    v_fma_f32 v62, v62, s30, -v245
    v_fma_f32 v63, v63, s30, -v245
    v_exp_f32 v60, v60
    v_mfma_f32_16x16x32_bf16 v[136:139], a[232:235], v[176:179], v[136:139]
    v_exp_f32 v61, v61
    v_exp_f32 v62, v62
    v_exp_f32 v63, v63
    v_mfma_f32_16x16x32_bf16 v[140:143], a[232:235], v[180:183], v[140:143]
    v_cvt_pk_bf16_f32 v224, v60, v61
    v_add_f32 v250, v250, v60
    v_cvt_pk_bf16_f32 v225, v62, v63
    v_add_f32 v250, v250, v61
    ds_write_b64 v242, v[224:225] offset:24576
    v_mfma_f32_16x16x32_bf16 v[144:147], a[232:235], v[184:187], v[144:147]
    v_add_f32 v250, v250, v62
    v_add_f32 v250, v250, v63
    buffer_load_dwordx4 v235, s[16:19], s32 offen offset:2112 nt lds
    v_mfma_f32_16x16x32_bf16 v[148:151], a[232:235], v[188:191], v[148:151]
    buffer_load_dwordx4 v236, s[16:19], s32 offen offset:3168 nt lds
    v_mfma_f32_16x16x32_bf16 v[152:155], a[232:235], v[192:195], v[152:155]
    v_mfma_f32_16x16x32_bf16 v[156:159], a[236:239], v[176:179], v[156:159]
    v_mfma_f32_16x16x32_bf16 v[160:163], a[236:239], v[180:183], v[160:163]
    v_mfma_f32_16x16x32_bf16 v[164:167], a[236:239], v[184:187], v[164:167]
    v_mfma_f32_16x16x32_bf16 v[168:171], a[236:239], v[188:191], v[168:171]
    v_mfma_f32_16x16x32_bf16 v[172:175], a[236:239], v[192:195], v[172:175]
    ds_read_b128 v[176:179], v240 offset:0
    ds_read_b128 v[180:183], v240 offset:4096
    ds_read_b128 v[184:187], v240 offset:8192
    ds_read_b128 v[188:191], v240 offset:12288
    ds_read_b128 v[192:195], v240 offset:16384
    v_mfma_f32_16x16x32_bf16 v[16:19], a[176:179], a[40:43], v[16:19]
    s_waitcnt vmcnt(20)
    ds_read_b128 a[160:163], v232 offset:8448
    ds_read_b128 a[164:167], v232 offset:8960
    ds_read_b128 a[168:171], v232 offset:8512
    ds_read_b128 a[172:175], v232 offset:9024
    v_mfma_f32_16x16x32_bf16 v[20:23], a[176:179], a[44:47], v[20:23]
    s_waitcnt vmcnt(16)
    ds_read_b64_tr_b16 a[224:225], v237 offset:12672
    ds_read_b64_tr_b16 a[226:227], v237 offset:12928
    ds_read_b64_tr_b16 a[228:229], v237 offset:12704
    ds_read_b64_tr_b16 a[230:231], v237 offset:12960
    ds_read_b64_tr_b16 a[232:233], v237 offset:12736
    v_mfma_f32_16x16x32_bf16 v[24:27], a[176:179], a[48:51], v[24:27]
    ds_read_b64_tr_b16 a[234:235], v237 offset:12992
    ds_read_b64_tr_b16 a[236:237], v237 offset:12768
    ds_read_b64_tr_b16 a[238:239], v237 offset:13024
    v_mfma_f32_16x16x32_bf16 v[28:31], a[176:179], a[52:55], v[28:31]
    v_fma_f32 v80, v80, s30, -v245
    v_fma_f32 v81, v81, s30, -v245
    v_fma_f32 v82, v82, s30, -v245
    v_fma_f32 v83, v83, s30, -v245
    v_exp_f32 v80, v80
    v_mfma_f32_16x16x32_bf16 v[32:35], a[176:179], a[56:59], v[32:35]
    v_exp_f32 v81, v81
    v_exp_f32 v82, v82
    v_exp_f32 v83, v83
    v_mfma_f32_16x16x32_bf16 v[36:39], a[180:183], a[40:43], v[36:39]
    v_cvt_pk_bf16_f32 v226, v80, v81
    v_add_f32 v250, v250, v80
    v_cvt_pk_bf16_f32 v227, v82, v83
    v_add_f32 v250, v250, v81
    ds_write_b64 v243, v[226:227] offset:24576
    v_mfma_f32_16x16x32_bf16 v[40:43], a[180:183], a[44:47], v[40:43]
    v_add_f32 v250, v250, v82
    v_add_f32 v250, v250, v83
    v_mfma_f32_16x16x32_bf16 v[44:47], a[180:183], a[48:51], v[44:47]
    v_mfma_f32_16x16x32_bf16 v[48:51], a[180:183], a[52:55], v[48:51]
    s_add_u32 m0, s29, 8448
    s_add_u32 s33, s93, 458752
    s_waitcnt lgkmcnt(9)
    buffer_load_dwordx4 v9, s[12:15], s33 offen nt lds
    v_mfma_f32_16x16x32_bf16 v[52:55], a[180:183], a[56:59], v[52:55]
    v_mfma_f32_16x16x32_bf16 v[96:99], a[240:243], v[196:199], v[96:99]
    v_mfma_f32_16x16x32_bf16 v[100:103], a[240:243], v[200:203], v[100:103]
    buffer_load_dwordx4 v10, s[12:15], s33 offen offset:1056 nt lds
    v_mfma_f32_16x16x32_bf16 v[104:107], a[240:243], v[204:207], v[104:107]
    v_mfma_f32_16x16x32_bf16 v[108:111], a[240:243], v[208:211], v[108:111]
    v_mfma_f32_16x16x32_bf16 v[112:115], a[240:243], v[212:215], v[112:115]
    buffer_load_dwordx4 v11, s[12:15], s33 offen offset:2112 nt lds
    v_mfma_f32_16x16x32_bf16 v[116:119], a[244:247], v[196:199], v[116:119]
    v_mfma_f32_16x16x32_bf16 v[120:123], a[244:247], v[200:203], v[120:123]
    v_mfma_f32_16x16x32_bf16 v[124:127], a[244:247], v[204:207], v[124:127]
    buffer_load_dwordx4 v12, s[12:15], s33 offen offset:3168 nt lds
    v_mfma_f32_16x16x32_bf16 v[128:131], a[244:247], v[208:211], v[128:131]
    v_fma_f32 v64, v64, s30, -v246
    v_fma_f32 v65, v65, s30, -v246
    v_fma_f32 v66, v66, s30, -v246
    v_fma_f32 v67, v67, s30, -v246
    v_exp_f32 v64, v64
    v_mfma_f32_16x16x32_bf16 v[132:135], a[244:247], v[212:215], v[132:135]
    v_exp_f32 v65, v65
    v_exp_f32 v66, v66
    v_exp_f32 v67, v67
    v_mfma_f32_16x16x32_bf16 v[16:19], a[184:187], a[60:63], v[16:19]
    v_cvt_pk_bf16_f32 v228, v64, v65
    v_add_f32 v251, v251, v64
    v_cvt_pk_bf16_f32 v229, v66, v67
    v_add_f32 v251, v251, v65
    ds_write_b64 v242, v[228:229] offset:28672
    v_mfma_f32_16x16x32_bf16 v[20:23], a[184:187], a[64:67], v[20:23]
    v_add_f32 v251, v251, v66
    v_add_f32 v251, v251, v67
    v_mfma_f32_16x16x32_bf16 v[24:27], a[184:187], a[68:71], v[24:27]
    v_mfma_f32_16x16x32_bf16 v[28:31], a[184:187], a[72:75], v[28:31]
    v_mfma_f32_16x16x32_bf16 v[32:35], a[184:187], a[76:79], v[32:35]
    s_add_u32 m0, s29, 12672
    s_add_u32 s34, s97, 327680
    s_waitcnt lgkmcnt(2)
    buffer_load_dwordx4 v233, s[16:19], s34 offen nt lds
    v_mfma_f32_16x16x32_bf16 v[36:39], a[188:191], a[60:63], v[36:39]
    v_mfma_f32_16x16x32_bf16 v[40:43], a[188:191], a[64:67], v[40:43]
    v_mfma_f32_16x16x32_bf16 v[44:47], a[188:191], a[68:71], v[44:47]
    buffer_load_dwordx4 v234, s[16:19], s34 offen offset:1056 nt lds
    v_mfma_f32_16x16x32_bf16 v[48:51], a[188:191], a[72:75], v[48:51]
    v_mfma_f32_16x16x32_bf16 v[52:55], a[188:191], a[76:79], v[52:55]
    v_mfma_f32_16x16x32_bf16 v[136:139], a[248:251], v[196:199], v[136:139]
    buffer_load_dwordx4 v235, s[16:19], s34 offen offset:2112 nt lds
    v_mfma_f32_16x16x32_bf16 v[140:143], a[248:251], v[200:203], v[140:143]
    v_mfma_f32_16x16x32_bf16 v[144:147], a[248:251], v[204:207], v[144:147]
    v_fma_f32 v84, v84, s30, -v246
    v_fma_f32 v85, v85, s30, -v246
    v_fma_f32 v86, v86, s30, -v246
    v_fma_f32 v87, v87, s30, -v246
    v_exp_f32 v84, v84
    v_mfma_f32_16x16x32_bf16 v[148:151], a[248:251], v[208:211], v[148:151]
    v_exp_f32 v85, v85
    v_exp_f32 v86, v86
    v_exp_f32 v87, v87
    v_mfma_f32_16x16x32_bf16 v[152:155], a[248:251], v[212:215], v[152:155]
    v_cvt_pk_bf16_f32 v230, v84, v85
    v_add_f32 v251, v251, v84
    v_cvt_pk_bf16_f32 v231, v86, v87
    v_add_f32 v251, v251, v85
    ds_write_b64 v243, v[230:231] offset:28672
    v_mfma_f32_16x16x32_bf16 v[156:159], a[252:255], v[196:199], v[156:159]
    v_add_f32 v251, v251, v86
    v_add_f32 v251, v251, v87
    buffer_load_dwordx4 v236, s[16:19], s34 offen offset:3168 nt lds
    v_mfma_f32_16x16x32_bf16 v[160:163], a[252:255], v[200:203], v[160:163]
    v_mfma_f32_16x16x32_bf16 v[164:167], a[252:255], v[204:207], v[164:167]
    v_mfma_f32_16x16x32_bf16 v[168:171], a[252:255], v[208:211], v[168:171]
    v_mfma_f32_16x16x32_bf16 v[172:175], a[252:255], v[212:215], v[172:175]
    ds_read_b128 v[196:199], v241 offset:0
    ds_read_b128 v[200:203], v241 offset:4096
    ds_read_b128 v[204:207], v241 offset:8192
    ds_read_b128 v[208:211], v241 offset:12288
    ds_read_b128 v[212:215], v241 offset:16384
    v_mfma_f32_16x16x32_bf16 v[16:19], a[160:163], a[80:83], v[16:19]
    s_waitcnt vmcnt(20)
    ds_read_b128 a[176:179], v232 offset:0
    ds_read_b128 a[180:183], v232 offset:512
    ds_read_b128 a[184:187], v232 offset:64
    ds_read_b128 a[188:191], v232 offset:576
    v_mfma_f32_16x16x32_bf16 v[20:23], a[160:163], a[84:87], v[20:23]
    s_waitcnt vmcnt(16)
    ds_read_b64_tr_b16 a[240:241], v237 offset:4224
    ds_read_b64_tr_b16 a[242:243], v237 offset:4480
    ds_read_b64_tr_b16 a[244:245], v237 offset:4256
    ds_read_b64_tr_b16 a[246:247], v237 offset:4512
    ds_read_b64_tr_b16 a[248:249], v237 offset:4288
    v_mfma_f32_16x16x32_bf16 v[24:27], a[160:163], a[88:91], v[24:27]
    ds_read_b64_tr_b16 a[250:251], v237 offset:4544
    ds_read_b64_tr_b16 a[252:253], v237 offset:4320
    ds_read_b64_tr_b16 a[254:255], v237 offset:4576
    v_mfma_f32_16x16x32_bf16 v[28:31], a[160:163], a[92:95], v[28:31]
    v_mfma_f32_16x16x32_bf16 v[32:35], a[160:163], a[96:99], v[32:35]
    v_mfma_f32_16x16x32_bf16 v[36:39], a[164:167], a[80:83], v[36:39]
    v_mfma_f32_16x16x32_bf16 v[40:43], a[164:167], a[84:87], v[40:43]
    v_mfma_f32_16x16x32_bf16 v[44:47], a[164:167], a[88:91], v[44:47]
    v_fma_f32 v68, v68, s30, -v247
    v_fma_f32 v69, v69, s30, -v247
    v_fma_f32 v70, v70, s30, -v247
    v_fma_f32 v71, v71, s30, -v247
    v_exp_f32 v68, v68
    v_mfma_f32_16x16x32_bf16 v[48:51], a[164:167], a[92:95], v[48:51]
    v_exp_f32 v69, v69
    v_exp_f32 v70, v70
    v_exp_f32 v71, v71
    v_mfma_f32_16x16x32_bf16 v[52:55], a[164:167], a[96:99], v[52:55]
    v_cvt_pk_bf16_f32 v216, v68, v69
    v_add_f32 v252, v252, v68
    v_cvt_pk_bf16_f32 v217, v70, v71
    v_add_f32 v252, v252, v69
    ds_write_b64 v242, v[216:217] offset:32768
    v_mfma_f32_16x16x32_bf16 v[96:99], a[224:227], v[176:179], v[96:99]
    v_add_f32 v252, v252, v70
    v_add_f32 v252, v252, v71
    s_add_u32 m0, s29, 0
    s_add_u32 s35, s94, 458752
    s_waitcnt lgkmcnt(9)
    buffer_load_dwordx4 v9, s[12:15], s35 offen nt lds
    v_mfma_f32_16x16x32_bf16 v[100:103], a[224:227], v[180:183], v[100:103]
    buffer_load_dwordx4 v10, s[12:15], s35 offen offset:1056 nt lds
    v_mfma_f32_16x16x32_bf16 v[104:107], a[224:227], v[184:187], v[104:107]
    v_mfma_f32_16x16x32_bf16 v[108:111], a[224:227], v[188:191], v[108:111]
    v_mfma_f32_16x16x32_bf16 v[112:115], a[224:227], v[192:195], v[112:115]
    buffer_load_dwordx4 v11, s[12:15], s35 offen offset:2112 nt lds
    v_mfma_f32_16x16x32_bf16 v[116:119], a[228:231], v[176:179], v[116:119]
    v_mfma_f32_16x16x32_bf16 v[120:123], a[228:231], v[180:183], v[120:123]
    v_mfma_f32_16x16x32_bf16 v[124:127], a[228:231], v[184:187], v[124:127]
    buffer_load_dwordx4 v12, s[12:15], s35 offen offset:3168 nt lds
    v_mfma_f32_16x16x32_bf16 v[128:131], a[228:231], v[188:191], v[128:131]
    v_mfma_f32_16x16x32_bf16 v[132:135], a[228:231], v[192:195], v[132:135]
    v_mfma_f32_16x16x32_bf16 v[16:19], a[168:171], a[100:103], v[16:19]
    v_mfma_f32_16x16x32_bf16 v[20:23], a[168:171], a[104:107], v[20:23]
    v_fma_f32 v88, v88, s30, -v247
    v_fma_f32 v89, v89, s30, -v247
    v_fma_f32 v90, v90, s30, -v247
    v_fma_f32 v91, v91, s30, -v247
    v_exp_f32 v88, v88
    v_mfma_f32_16x16x32_bf16 v[24:27], a[168:171], a[108:111], v[24:27]
    v_exp_f32 v89, v89
    v_exp_f32 v90, v90
    v_exp_f32 v91, v91
    v_mfma_f32_16x16x32_bf16 v[28:31], a[168:171], a[112:115], v[28:31]
    v_cvt_pk_bf16_f32 v218, v88, v89
    v_add_f32 v252, v252, v88
    v_cvt_pk_bf16_f32 v219, v90, v91
    v_add_f32 v252, v252, v89
    ds_write_b64 v243, v[218:219] offset:32768
    v_mfma_f32_16x16x32_bf16 v[32:35], a[168:171], a[116:119], v[32:35]
    v_add_f32 v252, v252, v90
    v_add_f32 v252, v252, v91
    s_add_u32 m0, s29, 4224
    s_add_u32 s36, s98, 327680
    s_waitcnt lgkmcnt(2)
    buffer_load_dwordx4 v233, s[16:19], s36 offen nt lds
    v_mfma_f32_16x16x32_bf16 v[36:39], a[172:175], a[100:103], v[36:39]
    v_mfma_f32_16x16x32_bf16 v[40:43], a[172:175], a[104:107], v[40:43]
    v_mfma_f32_16x16x32_bf16 v[44:47], a[172:175], a[108:111], v[44:47]
    buffer_load_dwordx4 v234, s[16:19], s36 offen offset:1056 nt lds
    v_mfma_f32_16x16x32_bf16 v[48:51], a[172:175], a[112:115], v[48:51]
    v_mfma_f32_16x16x32_bf16 v[52:55], a[172:175], a[116:119], v[52:55]
    v_mfma_f32_16x16x32_bf16 v[136:139], a[232:235], v[176:179], v[136:139]
    buffer_load_dwordx4 v235, s[16:19], s36 offen offset:2112 nt lds
    v_mfma_f32_16x16x32_bf16 v[140:143], a[232:235], v[180:183], v[140:143]
    v_mfma_f32_16x16x32_bf16 v[144:147], a[232:235], v[184:187], v[144:147]
    v_mfma_f32_16x16x32_bf16 v[148:151], a[232:235], v[188:191], v[148:151]
    buffer_load_dwordx4 v236, s[16:19], s36 offen offset:3168 nt lds
    v_mfma_f32_16x16x32_bf16 v[152:155], a[232:235], v[192:195], v[152:155]
    v_mfma_f32_16x16x32_bf16 v[156:159], a[236:239], v[176:179], v[156:159]
    v_mfma_f32_16x16x32_bf16 v[160:163], a[236:239], v[180:183], v[160:163]
    v_fma_f32 v72, v72, s30, -v248
    v_fma_f32 v73, v73, s30, -v248
    v_fma_f32 v74, v74, s30, -v248
    v_fma_f32 v75, v75, s30, -v248
    v_exp_f32 v72, v72
    v_mfma_f32_16x16x32_bf16 v[164:167], a[236:239], v[184:187], v[164:167]
    v_exp_f32 v73, v73
    v_exp_f32 v74, v74
    v_exp_f32 v75, v75
    v_mfma_f32_16x16x32_bf16 v[168:171], a[236:239], v[188:191], v[168:171]
    v_cvt_pk_bf16_f32 v220, v72, v73
    v_add_f32 v253, v253, v72
    v_cvt_pk_bf16_f32 v221, v74, v75
    v_add_f32 v253, v253, v73
    ds_write_b64 v242, v[220:221] offset:36864
    v_mfma_f32_16x16x32_bf16 v[172:175], a[236:239], v[192:195], v[172:175]
    v_add_f32 v253, v253, v74
    v_add_f32 v253, v253, v75
    v_mfma_f32_16x16x32_bf16 v[16:19], a[176:179], a[120:123], v[16:19]
    s_waitcnt vmcnt(20)
    ds_read_b128 a[160:163], v232 offset:16896
    ds_read_b128 a[164:167], v232 offset:17408
    ds_read_b128 a[168:171], v232 offset:16960
    ds_read_b128 a[172:175], v232 offset:17472
    v_mfma_f32_16x16x32_bf16 v[20:23], a[176:179], a[124:127], v[20:23]
    s_waitcnt vmcnt(16)
    ds_read_b64_tr_b16 a[224:225], v237 offset:21120
    ds_read_b64_tr_b16 a[226:227], v237 offset:21376
    ds_read_b64_tr_b16 a[228:229], v237 offset:21152
    ds_read_b64_tr_b16 a[230:231], v237 offset:21408
    ds_read_b64_tr_b16 a[232:233], v237 offset:21184
    v_mfma_f32_16x16x32_bf16 v[24:27], a[176:179], a[128:131], v[24:27]
    ds_read_b64_tr_b16 a[234:235], v237 offset:21440
    ds_read_b64_tr_b16 a[236:237], v237 offset:21216
    ds_read_b64_tr_b16 a[238:239], v237 offset:21472
    v_mfma_f32_16x16x32_bf16 v[28:31], a[176:179], a[132:135], v[28:31]
    v_mfma_f32_16x16x32_bf16 v[32:35], a[176:179], a[136:139], v[32:35]
    v_mfma_f32_16x16x32_bf16 v[36:39], a[180:183], a[120:123], v[36:39]
    v_mfma_f32_16x16x32_bf16 v[40:43], a[180:183], a[124:127], v[40:43]
    v_mfma_f32_16x16x32_bf16 v[44:47], a[180:183], a[128:131], v[44:47]
    v_mfma_f32_16x16x32_bf16 v[48:51], a[180:183], a[132:135], v[48:51]
    s_add_u32 m0, s29, 16896
    s_add_u32 s37, s95, 458752
    s_waitcnt lgkmcnt(8)
    buffer_load_dwordx4 v9, s[12:15], s37 offen nt lds
    v_mfma_f32_16x16x32_bf16 v[52:55], a[180:183], a[136:139], v[52:55]
    v_mfma_f32_16x16x32_bf16 v[96:99], a[240:243], v[196:199], v[96:99]
    v_fma_f32 v92, v92, s30, -v248
    v_fma_f32 v93, v93, s30, -v248
    v_fma_f32 v94, v94, s30, -v248
    v_fma_f32 v95, v95, s30, -v248
    v_exp_f32 v92, v92
    v_mfma_f32_16x16x32_bf16 v[100:103], a[240:243], v[200:203], v[100:103]
    buffer_load_dwordx4 v10, s[12:15], s37 offen offset:1056 nt lds
    v_exp_f32 v93, v93
    v_exp_f32 v94, v94
    v_mfma_f32_16x16x32_bf16 v[104:107], a[240:243], v[204:207], v[104:107]
    v_exp_f32 v95, v95
    v_cvt_pk_bf16_f32 v222, v92, v93
    v_add_f32 v253, v253, v92
    v_cvt_pk_bf16_f32 v223, v94, v95
    v_mfma_f32_16x16x32_bf16 v[108:111], a[240:243], v[208:211], v[108:111]
    v_add_f32 v253, v253, v93
    ds_write_b64 v243, v[222:223] offset:36864
    v_add_f32 v253, v253, v94
    v_add_f32 v253, v253, v95
    v_mfma_f32_16x16x32_bf16 v[112:115], a[240:243], v[212:215], v[112:115]
    buffer_load_dwordx4 v11, s[12:15], s37 offen offset:2112 nt lds
    v_mfma_f32_16x16x32_bf16 v[116:119], a[244:247], v[196:199], v[116:119]
    v_mfma_f32_16x16x32_bf16 v[120:123], a[244:247], v[200:203], v[120:123]
    v_mfma_f32_16x16x32_bf16 v[124:127], a[244:247], v[204:207], v[124:127]
    buffer_load_dwordx4 v12, s[12:15], s37 offen offset:3168 nt lds
    v_mfma_f32_16x16x32_bf16 v[128:131], a[244:247], v[208:211], v[128:131]
    v_mfma_f32_16x16x32_bf16 v[132:135], a[244:247], v[212:215], v[132:135]
    v_mfma_f32_16x16x32_bf16 v[16:19], a[184:187], a[140:143], v[16:19]
    v_mfma_f32_16x16x32_bf16 v[20:23], a[184:187], a[144:147], v[20:23]
    v_mfma_f32_16x16x32_bf16 v[24:27], a[184:187], a[148:151], v[24:27]
    v_mfma_f32_16x16x32_bf16 v[28:31], a[184:187], a[152:155], v[28:31]
    v_mfma_f32_16x16x32_bf16 v[32:35], a[184:187], a[156:159], v[32:35]
    s_add_u32 m0, s29, 21120
    s_add_u32 s38, s99, 327680
    s_waitcnt lgkmcnt(1)
    buffer_load_dwordx4 v233, s[16:19], s38 offen nt lds
    v_mfma_f32_16x16x32_bf16 v[36:39], a[188:191], a[140:143], v[36:39]
    v_mfma_f32_16x16x32_bf16 v[40:43], a[188:191], a[144:147], v[40:43]
    v_mfma_f32_16x16x32_bf16 v[44:47], a[188:191], a[148:151], v[44:47]
    buffer_load_dwordx4 v234, s[16:19], s38 offen offset:1056 nt lds
    v_mfma_f32_16x16x32_bf16 v[48:51], a[188:191], a[152:155], v[48:51]
    v_mfma_f32_16x16x32_bf16 v[52:55], a[188:191], a[156:159], v[52:55]
    v_mfma_f32_16x16x32_bf16 v[136:139], a[248:251], v[196:199], v[136:139]
    buffer_load_dwordx4 v235, s[16:19], s38 offen offset:2112 nt lds
    v_mfma_f32_16x16x32_bf16 v[140:143], a[248:251], v[200:203], v[140:143]
    v_mfma_f32_16x16x32_bf16 v[144:147], a[248:251], v[204:207], v[144:147]
    v_mfma_f32_16x16x32_bf16 v[148:151], a[248:251], v[208:211], v[148:151]
    buffer_load_dwordx4 v236, s[16:19], s38 offen offset:3168 nt lds
    v_mfma_f32_16x16x32_bf16 v[152:155], a[248:251], v[212:215], v[152:155]
    v_mfma_f32_16x16x32_bf16 v[156:159], a[252:255], v[196:199], v[156:159]
    v_mfma_f32_16x16x32_bf16 v[160:163], a[252:255], v[200:203], v[160:163]
    v_mfma_f32_16x16x32_bf16 v[164:167], a[252:255], v[204:207], v[164:167]
    v_mfma_f32_16x16x32_bf16 v[168:171], a[252:255], v[208:211], v[168:171]
    v_mfma_f32_16x16x32_bf16 v[172:175], a[252:255], v[212:215], v[172:175]
    s_waitcnt lgkmcnt(0)
    s_barrier
    v_mfma_f32_16x16x32_bf16 v[56:59], a[160:163], a[0:3], 0
    s_waitcnt vmcnt(20)
    ds_read_b128 a[176:179], v232 offset:8448
    ds_read_b128 a[180:183], v232 offset:8960
    ds_read_b128 a[184:187], v232 offset:8512
    ds_read_b128 a[188:191], v232 offset:9024
    ds_read_b128 v[176:179], v238 offset:20480
    v_mfma_f32_16x16x32_bf16 v[60:63], a[160:163], a[4:7], 0
    ds_read_b128 v[180:183], v238 offset:24576
    ds_read_b128 v[184:187], v238 offset:28672
    ds_read_b128 v[188:191], v238 offset:32768
    ds_read_b128 v[192:195], v238 offset:36864
    s_waitcnt vmcnt(16)
    ds_read_b64_tr_b16 a[240:241], v237 offset:12672
    v_mfma_f32_16x16x32_bf16 v[64:67], a[160:163], a[8:11], 0
    ds_read_b64_tr_b16 a[242:243], v237 offset:12928
    ds_read_b64_tr_b16 a[244:245], v237 offset:12704
    ds_read_b64_tr_b16 a[246:247], v237 offset:12960
    ds_read_b64_tr_b16 a[248:249], v237 offset:12736
    ds_read_b64_tr_b16 a[250:251], v237 offset:12992
    v_mfma_f32_16x16x32_bf16 v[68:71], a[160:163], a[12:15], 0
    ds_read_b64_tr_b16 a[252:253], v237 offset:12768
    ds_read_b64_tr_b16 a[254:255], v237 offset:13024
    v_fma_f32 v16, v16, s30, -v244
    v_fma_f32 v17, v17, s30, -v244
    v_fma_f32 v18, v18, s30, -v244
    v_mfma_f32_16x16x32_bf16 v[72:75], a[160:163], a[16:19], 0
    v_fma_f32 v19, v19, s30, -v244
    v_exp_f32 v16, v16
    v_exp_f32 v17, v17
    v_mfma_f32_16x16x32_bf16 v[76:79], a[164:167], a[0:3], 0
    v_exp_f32 v18, v18
    v_exp_f32 v19, v19
    v_cvt_pk_bf16_f32 v224, v16, v17
    v_mfma_f32_16x16x32_bf16 v[80:83], a[164:167], a[4:7], 0
    v_add_f32 v249, v249, v16
    v_cvt_pk_bf16_f32 v225, v18, v19
    v_add_f32 v249, v249, v17
    ds_write_b64 v242, v[224:225] offset:0
    v_add_f32 v249, v249, v18
    v_mfma_f32_16x16x32_bf16 v[84:87], a[164:167], a[8:11], 0
    v_add_f32 v249, v249, v19
    ds_read_b128 v[196:199], v239 offset:20480
    ds_read_b128 v[200:203], v239 offset:24576
    ds_read_b128 v[204:207], v239 offset:28672
    ds_read_b128 v[208:211], v239 offset:32768
    v_mfma_f32_16x16x32_bf16 v[88:91], a[164:167], a[12:15], 0
    ds_read_b128 v[212:215], v239 offset:36864
    s_add_u32 m0, s29, 8448
    s_add_u32 s39, s96, 393216
    s_waitcnt lgkmcnt(15)
    buffer_load_dwordx4 v233, s[16:19], s39 offen nt lds
    v_mfma_f32_16x16x32_bf16 v[92:95], a[164:167], a[16:19], 0
    v_mfma_f32_16x16x32_bf16 v[96:99], a[224:227], v[176:179], v[96:99]
    v_mfma_f32_16x16x32_bf16 v[100:103], a[224:227], v[180:183], v[100:103]
    buffer_load_dwordx4 v234, s[16:19], s39 offen offset:1056 nt lds
    v_mfma_f32_16x16x32_bf16 v[104:107], a[224:227], v[184:187], v[104:107]
    v_mfma_f32_16x16x32_bf16 v[108:111], a[224:227], v[188:191], v[108:111]
    s_waitcnt lgkmcnt(14)
    v_mfma_f32_16x16x32_bf16 v[112:115], a[224:227], v[192:195], v[112:115]
    v_fma_f32 v36, v36, s30, -v244
    v_fma_f32 v37, v37, s30, -v244
    v_fma_f32 v38, v38, s30, -v244
    v_fma_f32 v39, v39, s30, -v244
    v_exp_f32 v36, v36
    v_mfma_f32_16x16x32_bf16 v[116:119], a[228:231], v[176:179], v[116:119]
    v_exp_f32 v37, v37
    v_exp_f32 v38, v38
    v_exp_f32 v39, v39
    v_mfma_f32_16x16x32_bf16 v[120:123], a[228:231], v[180:183], v[120:123]
    v_cvt_pk_bf16_f32 v226, v36, v37
    v_add_f32 v249, v249, v36
    v_cvt_pk_bf16_f32 v227, v38, v39
    v_add_f32 v249, v249, v37
    ds_write_b64 v243, v[226:227] offset:0
    v_mfma_f32_16x16x32_bf16 v[124:127], a[228:231], v[184:187], v[124:127]
    v_add_f32 v249, v249, v38
    v_add_f32 v249, v249, v39
    buffer_load_dwordx4 v235, s[16:19], s39 offen offset:2112 nt lds
    buffer_load_dwordx4 v236, s[16:19], s39 offen offset:3168 nt lds
    v_mfma_f32_16x16x32_bf16 v[128:131], a[228:231], v[188:191], v[128:131]
    v_mfma_f32_16x16x32_bf16 v[132:135], a[228:231], v[192:195], v[132:135]
    v_mfma_f32_16x16x32_bf16 v[56:59], a[168:171], a[20:23], v[56:59]
    v_mfma_f32_16x16x32_bf16 v[60:63], a[168:171], a[24:27], v[60:63]
    v_mfma_f32_16x16x32_bf16 v[64:67], a[168:171], a[28:31], v[64:67]
    v_mfma_f32_16x16x32_bf16 v[68:71], a[168:171], a[32:35], v[68:71]
    v_mfma_f32_16x16x32_bf16 v[72:75], a[168:171], a[36:39], v[72:75]
    s_add_u32 m0, s29, 12672
    s_add_u32 s32, s97, 393216
    s_waitcnt lgkmcnt(7)
    buffer_load_dwordx4 v233, s[16:19], s32 offen nt lds
    v_mfma_f32_16x16x32_bf16 v[76:79], a[172:175], a[20:23], v[76:79]
    v_mfma_f32_16x16x32_bf16 v[80:83], a[172:175], a[24:27], v[80:83]
    v_mfma_f32_16x16x32_bf16 v[84:87], a[172:175], a[28:31], v[84:87]
    buffer_load_dwordx4 v234, s[16:19], s32 offen offset:1056 nt lds
    v_mfma_f32_16x16x32_bf16 v[88:91], a[172:175], a[32:35], v[88:91]
    v_mfma_f32_16x16x32_bf16 v[92:95], a[172:175], a[36:39], v[92:95]
    v_fma_f32 v20, v20, s30, -v245
    v_fma_f32 v21, v21, s30, -v245
    v_fma_f32 v22, v22, s30, -v245
    v_fma_f32 v23, v23, s30, -v245
    v_exp_f32 v20, v20
    v_mfma_f32_16x16x32_bf16 v[136:139], a[232:235], v[176:179], v[136:139]
    v_exp_f32 v21, v21
    v_exp_f32 v22, v22
    v_exp_f32 v23, v23
    v_mfma_f32_16x16x32_bf16 v[140:143], a[232:235], v[180:183], v[140:143]
    v_cvt_pk_bf16_f32 v228, v20, v21
    v_add_f32 v250, v250, v20
    v_cvt_pk_bf16_f32 v229, v22, v23
    v_add_f32 v250, v250, v21
    ds_write_b64 v242, v[228:229] offset:4096
    v_mfma_f32_16x16x32_bf16 v[144:147], a[232:235], v[184:187], v[144:147]
    v_add_f32 v250, v250, v22
    v_add_f32 v250, v250, v23
    buffer_load_dwordx4 v235, s[16:19], s32 offen offset:2112 nt lds
    v_mfma_f32_16x16x32_bf16 v[148:151], a[232:235], v[188:191], v[148:151]
    buffer_load_dwordx4 v236, s[16:19], s32 offen offset:3168 nt lds
    v_mfma_f32_16x16x32_bf16 v[152:155], a[232:235], v[192:195], v[152:155]
    v_mfma_f32_16x16x32_bf16 v[156:159], a[236:239], v[176:179], v[156:159]
    v_mfma_f32_16x16x32_bf16 v[160:163], a[236:239], v[180:183], v[160:163]
    v_mfma_f32_16x16x32_bf16 v[164:167], a[236:239], v[184:187], v[164:167]
    v_mfma_f32_16x16x32_bf16 v[168:171], a[236:239], v[188:191], v[168:171]
    v_mfma_f32_16x16x32_bf16 v[172:175], a[236:239], v[192:195], v[172:175]
    ds_read_b128 v[176:179], v240 offset:20480
    ds_read_b128 v[180:183], v240 offset:24576
    ds_read_b128 v[184:187], v240 offset:28672
    ds_read_b128 v[188:191], v240 offset:32768
    ds_read_b128 v[192:195], v240 offset:36864
    v_mfma_f32_16x16x32_bf16 v[56:59], a[176:179], a[40:43], v[56:59]
    s_waitcnt vmcnt(20)
    ds_read_b128 a[160:163], v232 offset:0
    ds_read_b128 a[164:167], v232 offset:512
    ds_read_b128 a[168:171], v232 offset:64
    ds_read_b128 a[172:175], v232 offset:576
    v_mfma_f32_16x16x32_bf16 v[60:63], a[176:179], a[44:47], v[60:63]
    s_waitcnt vmcnt(16)
    ds_read_b64_tr_b16 a[224:225], v237 offset:4224
    ds_read_b64_tr_b16 a[226:227], v237 offset:4480
    ds_read_b64_tr_b16 a[228:229], v237 offset:4256
    ds_read_b64_tr_b16 a[230:231], v237 offset:4512
    ds_read_b64_tr_b16 a[232:233], v237 offset:4288
    v_mfma_f32_16x16x32_bf16 v[64:67], a[176:179], a[48:51], v[64:67]
    ds_read_b64_tr_b16 a[234:235], v237 offset:4544
    ds_read_b64_tr_b16 a[236:237], v237 offset:4320
    ds_read_b64_tr_b16 a[238:239], v237 offset:4576
    v_mfma_f32_16x16x32_bf16 v[68:71], a[176:179], a[52:55], v[68:71]
    v_fma_f32 v40, v40, s30, -v245
    v_fma_f32 v41, v41, s30, -v245
    v_fma_f32 v42, v42, s30, -v245
    v_fma_f32 v43, v43, s30, -v245
    v_exp_f32 v40, v40
    v_mfma_f32_16x16x32_bf16 v[72:75], a[176:179], a[56:59], v[72:75]
    v_exp_f32 v41, v41
    v_exp_f32 v42, v42
    v_exp_f32 v43, v43
    v_mfma_f32_16x16x32_bf16 v[76:79], a[180:183], a[40:43], v[76:79]
    v_cvt_pk_bf16_f32 v230, v40, v41
    v_add_f32 v250, v250, v40
    v_cvt_pk_bf16_f32 v231, v42, v43
    v_add_f32 v250, v250, v41
    ds_write_b64 v243, v[230:231] offset:4096
    v_mfma_f32_16x16x32_bf16 v[80:83], a[180:183], a[44:47], v[80:83]
    v_add_f32 v250, v250, v42
    v_add_f32 v250, v250, v43
    v_mfma_f32_16x16x32_bf16 v[84:87], a[180:183], a[48:51], v[84:87]
    v_mfma_f32_16x16x32_bf16 v[88:91], a[180:183], a[52:55], v[88:91]
    s_add_u32 m0, s29, 0
    s_add_u32 s33, s98, 393216
    s_waitcnt lgkmcnt(9)
    buffer_load_dwordx4 v233, s[16:19], s33 offen nt lds
    v_mfma_f32_16x16x32_bf16 v[92:95], a[180:183], a[56:59], v[92:95]
    v_mfma_f32_16x16x32_bf16 v[96:99], a[240:243], v[196:199], v[96:99]
    v_mfma_f32_16x16x32_bf16 v[100:103], a[240:243], v[200:203], v[100:103]
    buffer_load_dwordx4 v234, s[16:19], s33 offen offset:1056 nt lds
    v_mfma_f32_16x16x32_bf16 v[104:107], a[240:243], v[204:207], v[104:107]
    v_mfma_f32_16x16x32_bf16 v[108:111], a[240:243], v[208:211], v[108:111]
    v_mfma_f32_16x16x32_bf16 v[112:115], a[240:243], v[212:215], v[112:115]
    buffer_load_dwordx4 v235, s[16:19], s33 offen offset:2112 nt lds
    v_mfma_f32_16x16x32_bf16 v[116:119], a[244:247], v[196:199], v[116:119]
    v_mfma_f32_16x16x32_bf16 v[120:123], a[244:247], v[200:203], v[120:123]
    v_mfma_f32_16x16x32_bf16 v[124:127], a[244:247], v[204:207], v[124:127]
    buffer_load_dwordx4 v236, s[16:19], s33 offen offset:3168 nt lds
    v_mfma_f32_16x16x32_bf16 v[128:131], a[244:247], v[208:211], v[128:131]
    v_fma_f32 v24, v24, s30, -v246
    v_fma_f32 v25, v25, s30, -v246
    v_fma_f32 v26, v26, s30, -v246
    v_fma_f32 v27, v27, s30, -v246
    v_exp_f32 v24, v24
    v_mfma_f32_16x16x32_bf16 v[132:135], a[244:247], v[212:215], v[132:135]
    v_exp_f32 v25, v25
    v_exp_f32 v26, v26
    v_exp_f32 v27, v27
    v_mfma_f32_16x16x32_bf16 v[56:59], a[184:187], a[60:63], v[56:59]
    v_cvt_pk_bf16_f32 v216, v24, v25
    v_add_f32 v251, v251, v24
    v_cvt_pk_bf16_f32 v217, v26, v27
    v_add_f32 v251, v251, v25
    ds_write_b64 v242, v[216:217] offset:8192
    v_mfma_f32_16x16x32_bf16 v[60:63], a[184:187], a[64:67], v[60:63]
    v_add_f32 v251, v251, v26
    v_add_f32 v251, v251, v27
    v_mfma_f32_16x16x32_bf16 v[64:67], a[184:187], a[68:71], v[64:67]
    v_mfma_f32_16x16x32_bf16 v[68:71], a[184:187], a[72:75], v[68:71]
    v_mfma_f32_16x16x32_bf16 v[72:75], a[184:187], a[76:79], v[72:75]
    s_add_u32 m0, s29, 4224
    s_add_u32 s34, s99, 393216
    s_waitcnt lgkmcnt(2)
    buffer_load_dwordx4 v233, s[16:19], s34 offen nt lds
    v_mfma_f32_16x16x32_bf16 v[76:79], a[188:191], a[60:63], v[76:79]
    v_mfma_f32_16x16x32_bf16 v[80:83], a[188:191], a[64:67], v[80:83]
    v_mfma_f32_16x16x32_bf16 v[84:87], a[188:191], a[68:71], v[84:87]
    buffer_load_dwordx4 v234, s[16:19], s34 offen offset:1056 nt lds
    v_mfma_f32_16x16x32_bf16 v[88:91], a[188:191], a[72:75], v[88:91]
    v_mfma_f32_16x16x32_bf16 v[92:95], a[188:191], a[76:79], v[92:95]
    v_mfma_f32_16x16x32_bf16 v[136:139], a[248:251], v[196:199], v[136:139]
    buffer_load_dwordx4 v235, s[16:19], s34 offen offset:2112 nt lds
    v_mfma_f32_16x16x32_bf16 v[140:143], a[248:251], v[200:203], v[140:143]
    v_mfma_f32_16x16x32_bf16 v[144:147], a[248:251], v[204:207], v[144:147]
    v_fma_f32 v44, v44, s30, -v246
    v_fma_f32 v45, v45, s30, -v246
    v_fma_f32 v46, v46, s30, -v246
    v_fma_f32 v47, v47, s30, -v246
    v_exp_f32 v44, v44
    v_mfma_f32_16x16x32_bf16 v[148:151], a[248:251], v[208:211], v[148:151]
    v_exp_f32 v45, v45
    v_exp_f32 v46, v46
    v_exp_f32 v47, v47
    v_mfma_f32_16x16x32_bf16 v[152:155], a[248:251], v[212:215], v[152:155]
    v_cvt_pk_bf16_f32 v218, v44, v45
    v_add_f32 v251, v251, v44
    v_cvt_pk_bf16_f32 v219, v46, v47
    v_add_f32 v251, v251, v45
    ds_write_b64 v243, v[218:219] offset:8192
    v_mfma_f32_16x16x32_bf16 v[156:159], a[252:255], v[196:199], v[156:159]
    v_add_f32 v251, v251, v46
    v_add_f32 v251, v251, v47
    buffer_load_dwordx4 v236, s[16:19], s34 offen offset:3168 nt lds
    v_mfma_f32_16x16x32_bf16 v[160:163], a[252:255], v[200:203], v[160:163]
    v_mfma_f32_16x16x32_bf16 v[164:167], a[252:255], v[204:207], v[164:167]
    v_mfma_f32_16x16x32_bf16 v[168:171], a[252:255], v[208:211], v[168:171]
    v_mfma_f32_16x16x32_bf16 v[172:175], a[252:255], v[212:215], v[172:175]
    ds_read_b128 v[196:199], v241 offset:20480
    ds_read_b128 v[200:203], v241 offset:24576
    ds_read_b128 v[204:207], v241 offset:28672
    ds_read_b128 v[208:211], v241 offset:32768
    ds_read_b128 v[212:215], v241 offset:36864
    v_mfma_f32_16x16x32_bf16 v[56:59], a[160:163], a[80:83], v[56:59]
    s_waitcnt vmcnt(20)
    ds_read_b128 a[176:179], v232 offset:16896
    ds_read_b128 a[180:183], v232 offset:17408
    ds_read_b128 a[184:187], v232 offset:16960
    ds_read_b128 a[188:191], v232 offset:17472
    v_mfma_f32_16x16x32_bf16 v[60:63], a[160:163], a[84:87], v[60:63]
    s_waitcnt vmcnt(16)
    ds_read_b64_tr_b16 a[240:241], v237 offset:21120
    ds_read_b64_tr_b16 a[242:243], v237 offset:21376
    ds_read_b64_tr_b16 a[244:245], v237 offset:21152
    ds_read_b64_tr_b16 a[246:247], v237 offset:21408
    ds_read_b64_tr_b16 a[248:249], v237 offset:21184
    v_mfma_f32_16x16x32_bf16 v[64:67], a[160:163], a[88:91], v[64:67]
    ds_read_b64_tr_b16 a[250:251], v237 offset:21440
    ds_read_b64_tr_b16 a[252:253], v237 offset:21216
    ds_read_b64_tr_b16 a[254:255], v237 offset:21472
    v_mfma_f32_16x16x32_bf16 v[68:71], a[160:163], a[92:95], v[68:71]
    v_mfma_f32_16x16x32_bf16 v[72:75], a[160:163], a[96:99], v[72:75]
    v_mfma_f32_16x16x32_bf16 v[76:79], a[164:167], a[80:83], v[76:79]
    v_mfma_f32_16x16x32_bf16 v[80:83], a[164:167], a[84:87], v[80:83]
    v_mfma_f32_16x16x32_bf16 v[84:87], a[164:167], a[88:91], v[84:87]
    v_fma_f32 v28, v28, s30, -v247
    v_fma_f32 v29, v29, s30, -v247
    v_fma_f32 v30, v30, s30, -v247
    v_fma_f32 v31, v31, s30, -v247
    v_exp_f32 v28, v28
    v_mfma_f32_16x16x32_bf16 v[88:91], a[164:167], a[92:95], v[88:91]
    v_exp_f32 v29, v29
    v_exp_f32 v30, v30
    v_exp_f32 v31, v31
    v_mfma_f32_16x16x32_bf16 v[92:95], a[164:167], a[96:99], v[92:95]
    v_cvt_pk_bf16_f32 v220, v28, v29
    v_add_f32 v252, v252, v28
    v_cvt_pk_bf16_f32 v221, v30, v31
    v_add_f32 v252, v252, v29
    ds_write_b64 v242, v[220:221] offset:12288
    v_mfma_f32_16x16x32_bf16 v[96:99], a[224:227], v[176:179], v[96:99]
    v_add_f32 v252, v252, v30
    v_add_f32 v252, v252, v31
    s_add_u32 m0, s29, 16896
    s_add_u32 s35, s96, 458752
    s_waitcnt lgkmcnt(9)
    buffer_load_dwordx4 v233, s[16:19], s35 offen nt lds
    v_mfma_f32_16x16x32_bf16 v[100:103], a[224:227], v[180:183], v[100:103]
    buffer_load_dwordx4 v234, s[16:19], s35 offen offset:1056 nt lds
    v_mfma_f32_16x16x32_bf16 v[104:107], a[224:227], v[184:187], v[104:107]
    v_mfma_f32_16x16x32_bf16 v[108:111], a[224:227], v[188:191], v[108:111]
    v_mfma_f32_16x16x32_bf16 v[112:115], a[224:227], v[192:195], v[112:115]
    buffer_load_dwordx4 v235, s[16:19], s35 offen offset:2112 nt lds
    v_mfma_f32_16x16x32_bf16 v[116:119], a[228:231], v[176:179], v[116:119]
    v_mfma_f32_16x16x32_bf16 v[120:123], a[228:231], v[180:183], v[120:123]
    v_mfma_f32_16x16x32_bf16 v[124:127], a[228:231], v[184:187], v[124:127]
    buffer_load_dwordx4 v236, s[16:19], s35 offen offset:3168 nt lds
    v_mfma_f32_16x16x32_bf16 v[128:131], a[228:231], v[188:191], v[128:131]
    v_mfma_f32_16x16x32_bf16 v[132:135], a[228:231], v[192:195], v[132:135]
    v_mfma_f32_16x16x32_bf16 v[56:59], a[168:171], a[100:103], v[56:59]
    v_mfma_f32_16x16x32_bf16 v[60:63], a[168:171], a[104:107], v[60:63]
    v_fma_f32 v48, v48, s30, -v247
    v_fma_f32 v49, v49, s30, -v247
    v_fma_f32 v50, v50, s30, -v247
    v_fma_f32 v51, v51, s30, -v247
    v_exp_f32 v48, v48
    v_mfma_f32_16x16x32_bf16 v[64:67], a[168:171], a[108:111], v[64:67]
    v_exp_f32 v49, v49
    v_exp_f32 v50, v50
    v_exp_f32 v51, v51
    v_mfma_f32_16x16x32_bf16 v[68:71], a[168:171], a[112:115], v[68:71]
    v_cvt_pk_bf16_f32 v222, v48, v49
    v_add_f32 v252, v252, v48
    v_cvt_pk_bf16_f32 v223, v50, v51
    v_add_f32 v252, v252, v49
    ds_write_b64 v243, v[222:223] offset:12288
    v_mfma_f32_16x16x32_bf16 v[72:75], a[168:171], a[116:119], v[72:75]
    v_add_f32 v252, v252, v50
    v_add_f32 v252, v252, v51
    s_add_u32 m0, s29, 21120
    s_add_u32 s36, s97, 458752
    s_waitcnt lgkmcnt(2)
    buffer_load_dwordx4 v233, s[16:19], s36 offen nt lds
    v_mfma_f32_16x16x32_bf16 v[76:79], a[172:175], a[100:103], v[76:79]
    v_mfma_f32_16x16x32_bf16 v[80:83], a[172:175], a[104:107], v[80:83]
    v_mfma_f32_16x16x32_bf16 v[84:87], a[172:175], a[108:111], v[84:87]
    buffer_load_dwordx4 v234, s[16:19], s36 offen offset:1056 nt lds
    v_mfma_f32_16x16x32_bf16 v[88:91], a[172:175], a[112:115], v[88:91]
    v_mfma_f32_16x16x32_bf16 v[92:95], a[172:175], a[116:119], v[92:95]
    v_mfma_f32_16x16x32_bf16 v[136:139], a[232:235], v[176:179], v[136:139]
    buffer_load_dwordx4 v235, s[16:19], s36 offen offset:2112 nt lds
    v_mfma_f32_16x16x32_bf16 v[140:143], a[232:235], v[180:183], v[140:143]
    v_mfma_f32_16x16x32_bf16 v[144:147], a[232:235], v[184:187], v[144:147]
    v_mfma_f32_16x16x32_bf16 v[148:151], a[232:235], v[188:191], v[148:151]
    buffer_load_dwordx4 v236, s[16:19], s36 offen offset:3168 nt lds
    v_mfma_f32_16x16x32_bf16 v[152:155], a[232:235], v[192:195], v[152:155]
    v_mfma_f32_16x16x32_bf16 v[156:159], a[236:239], v[176:179], v[156:159]
    v_mfma_f32_16x16x32_bf16 v[160:163], a[236:239], v[180:183], v[160:163]
    v_fma_f32 v32, v32, s30, -v248
    v_fma_f32 v33, v33, s30, -v248
    v_fma_f32 v34, v34, s30, -v248
    v_fma_f32 v35, v35, s30, -v248
    v_exp_f32 v32, v32
    v_mfma_f32_16x16x32_bf16 v[164:167], a[236:239], v[184:187], v[164:167]
    v_exp_f32 v33, v33
    v_exp_f32 v34, v34
    v_exp_f32 v35, v35
    v_mfma_f32_16x16x32_bf16 v[168:171], a[236:239], v[188:191], v[168:171]
    v_cvt_pk_bf16_f32 v224, v32, v33
    v_add_f32 v253, v253, v32
    v_cvt_pk_bf16_f32 v225, v34, v35
    v_add_f32 v253, v253, v33
    ds_write_b64 v242, v[224:225] offset:16384
    v_mfma_f32_16x16x32_bf16 v[172:175], a[236:239], v[192:195], v[172:175]
    v_add_f32 v253, v253, v34
    v_add_f32 v253, v253, v35
    v_mfma_f32_16x16x32_bf16 v[56:59], a[176:179], a[120:123], v[56:59]
    v_mfma_f32_16x16x32_bf16 v[60:63], a[176:179], a[124:127], v[60:63]
    s_waitcnt vmcnt(20)
    ds_read_b64_tr_b16 a[224:225], v237 offset:8448
    ds_read_b64_tr_b16 a[226:227], v237 offset:8704
    ds_read_b64_tr_b16 a[228:229], v237 offset:8480
    ds_read_b64_tr_b16 a[230:231], v237 offset:8736
    ds_read_b64_tr_b16 a[232:233], v237 offset:8512
    v_mfma_f32_16x16x32_bf16 v[64:67], a[176:179], a[128:131], v[64:67]
    ds_read_b64_tr_b16 a[234:235], v237 offset:8768
    ds_read_b64_tr_b16 a[236:237], v237 offset:8544
    ds_read_b64_tr_b16 a[238:239], v237 offset:8800
    v_mfma_f32_16x16x32_bf16 v[68:71], a[176:179], a[132:135], v[68:71]
    v_mfma_f32_16x16x32_bf16 v[72:75], a[176:179], a[136:139], v[72:75]
    v_mfma_f32_16x16x32_bf16 v[76:79], a[180:183], a[120:123], v[76:79]
    v_mfma_f32_16x16x32_bf16 v[80:83], a[180:183], a[124:127], v[80:83]
    v_mfma_f32_16x16x32_bf16 v[84:87], a[180:183], a[128:131], v[84:87]
    v_mfma_f32_16x16x32_bf16 v[88:91], a[180:183], a[132:135], v[88:91]
    v_mfma_f32_16x16x32_bf16 v[92:95], a[180:183], a[136:139], v[92:95]
    v_mfma_f32_16x16x32_bf16 v[96:99], a[240:243], v[196:199], v[96:99]
    v_fma_f32 v52, v52, s30, -v248
    v_fma_f32 v53, v53, s30, -v248
    v_fma_f32 v54, v54, s30, -v248
    v_fma_f32 v55, v55, s30, -v248
    v_exp_f32 v52, v52
    v_mfma_f32_16x16x32_bf16 v[100:103], a[240:243], v[200:203], v[100:103]
    v_exp_f32 v53, v53
    v_exp_f32 v54, v54
    v_exp_f32 v55, v55
    v_mfma_f32_16x16x32_bf16 v[104:107], a[240:243], v[204:207], v[104:107]
    v_cvt_pk_bf16_f32 v226, v52, v53
    v_add_f32 v253, v253, v52
    v_cvt_pk_bf16_f32 v227, v54, v55
    v_add_f32 v253, v253, v53
    ds_write_b64 v243, v[226:227] offset:16384
    v_mfma_f32_16x16x32_bf16 v[108:111], a[240:243], v[208:211], v[108:111]
    v_add_f32 v253, v253, v54
    v_add_f32 v253, v253, v55
    v_mfma_f32_16x16x32_bf16 v[112:115], a[240:243], v[212:215], v[112:115]
    v_mfma_f32_16x16x32_bf16 v[116:119], a[244:247], v[196:199], v[116:119]
    v_mfma_f32_16x16x32_bf16 v[120:123], a[244:247], v[200:203], v[120:123]
    v_mfma_f32_16x16x32_bf16 v[124:127], a[244:247], v[204:207], v[124:127]
    v_mfma_f32_16x16x32_bf16 v[128:131], a[244:247], v[208:211], v[128:131]
    v_mfma_f32_16x16x32_bf16 v[132:135], a[244:247], v[212:215], v[132:135]
    v_mfma_f32_16x16x32_bf16 v[56:59], a[184:187], a[140:143], v[56:59]
    v_mfma_f32_16x16x32_bf16 v[60:63], a[184:187], a[144:147], v[60:63]
    v_mfma_f32_16x16x32_bf16 v[64:67], a[184:187], a[148:151], v[64:67]
    v_mfma_f32_16x16x32_bf16 v[68:71], a[184:187], a[152:155], v[68:71]
    v_mfma_f32_16x16x32_bf16 v[72:75], a[184:187], a[156:159], v[72:75]
    s_add_u32 m0, s29, 8448
    s_add_u32 s37, s98, 458752
    s_waitcnt lgkmcnt(1)
    buffer_load_dwordx4 v233, s[16:19], s37 offen nt lds
    v_mfma_f32_16x16x32_bf16 v[76:79], a[188:191], a[140:143], v[76:79]
    v_mfma_f32_16x16x32_bf16 v[80:83], a[188:191], a[144:147], v[80:83]
    v_mfma_f32_16x16x32_bf16 v[84:87], a[188:191], a[148:151], v[84:87]
    buffer_load_dwordx4 v234, s[16:19], s37 offen offset:1056 nt lds
    v_mfma_f32_16x16x32_bf16 v[88:91], a[188:191], a[152:155], v[88:91]
    v_mfma_f32_16x16x32_bf16 v[92:95], a[188:191], a[156:159], v[92:95]
    v_mfma_f32_16x16x32_bf16 v[136:139], a[248:251], v[196:199], v[136:139]
    buffer_load_dwordx4 v235, s[16:19], s37 offen offset:2112 nt lds
    v_mfma_f32_16x16x32_bf16 v[140:143], a[248:251], v[200:203], v[140:143]
    v_mfma_f32_16x16x32_bf16 v[144:147], a[248:251], v[204:207], v[144:147]
    v_mfma_f32_16x16x32_bf16 v[148:151], a[248:251], v[208:211], v[148:151]
    buffer_load_dwordx4 v236, s[16:19], s37 offen offset:3168 nt lds
    v_mfma_f32_16x16x32_bf16 v[152:155], a[248:251], v[212:215], v[152:155]
    v_mfma_f32_16x16x32_bf16 v[156:159], a[252:255], v[196:199], v[156:159]
    v_mfma_f32_16x16x32_bf16 v[160:163], a[252:255], v[200:203], v[160:163]
    v_mfma_f32_16x16x32_bf16 v[164:167], a[252:255], v[204:207], v[164:167]
    v_mfma_f32_16x16x32_bf16 v[168:171], a[252:255], v[208:211], v[168:171]
    v_mfma_f32_16x16x32_bf16 v[172:175], a[252:255], v[212:215], v[172:175]
    s_waitcnt lgkmcnt(0)
    s_barrier
    ds_read_b128 v[176:179], v238 offset:0
    ds_read_b128 v[180:183], v238 offset:4096
    ds_read_b128 v[184:187], v238 offset:8192
    ds_read_b128 v[188:191], v238 offset:12288
    ds_read_b128 v[192:195], v238 offset:16384
    s_waitcnt lgkmcnt(4)
    v_mfma_f32_16x16x32_bf16 v[96:99], a[224:227], v[176:179], v[96:99]
    s_waitcnt vmcnt(20)
    ds_read_b64_tr_b16 a[240:241], v237 offset:12672
    ds_read_b64_tr_b16 a[242:243], v237 offset:12928
    ds_read_b64_tr_b16 a[244:245], v237 offset:12704
    ds_read_b64_tr_b16 a[246:247], v237 offset:12960
    ds_read_b64_tr_b16 a[248:249], v237 offset:12736
    s_waitcnt lgkmcnt(8)
    v_mfma_f32_16x16x32_bf16 v[100:103], a[224:227], v[180:183], v[100:103]
    ds_read_b64_tr_b16 a[250:251], v237 offset:12992
    ds_read_b64_tr_b16 a[252:253], v237 offset:12768
    ds_read_b64_tr_b16 a[254:255], v237 offset:13024
    v_fma_f32 v56, v56, s30, -v244
    v_fma_f32 v57, v57, s30, -v244
    s_waitcnt lgkmcnt(10)
    v_mfma_f32_16x16x32_bf16 v[104:107], a[224:227], v[184:187], v[104:107]
    v_fma_f32 v58, v58, s30, -v244
    v_fma_f32 v59, v59, s30, -v244
    v_exp_f32 v56, v56
    v_exp_f32 v57, v57
    s_waitcnt lgkmcnt(9)
    v_mfma_f32_16x16x32_bf16 v[108:111], a[224:227], v[188:191], v[108:111]
    v_exp_f32 v58, v58
    v_exp_f32 v59, v59
    v_cvt_pk_bf16_f32 v228, v56, v57
    s_waitcnt lgkmcnt(8)
    v_mfma_f32_16x16x32_bf16 v[112:115], a[224:227], v[192:195], v[112:115]
    v_add_f32 v249, v249, v56
    v_cvt_pk_bf16_f32 v229, v58, v59
    v_add_f32 v249, v249, v57
    ds_write_b64 v242, v[228:229] offset:20480
    v_add_f32 v249, v249, v58
    v_mfma_f32_16x16x32_bf16 v[116:119], a[228:231], v[176:179], v[116:119]
    v_add_f32 v249, v249, v59
    ds_read_b128 v[196:199], v239 offset:0
    ds_read_b128 v[200:203], v239 offset:4096
    ds_read_b128 v[204:207], v239 offset:8192
    ds_read_b128 v[208:211], v239 offset:12288
    v_mfma_f32_16x16x32_bf16 v[120:123], a[228:231], v[180:183], v[120:123]
    ds_read_b128 v[212:215], v239 offset:16384
    s_lshl_b32 s74, s66, 1
    s_add_u32 s74, s74, s68
    s_lshl_b32 s74, s74, 2
    s_add_u32 s74, s74, s28
    v_mfma_f32_16x16x32_bf16 v[124:127], a[228:231], v[184:187], v[124:127]
    v_fma_f32 v76, v76, s30, -v244
    v_fma_f32 v77, v77, s30, -v244
    v_fma_f32 v78, v78, s30, -v244
    v_fma_f32 v79, v79, s30, -v244
    v_exp_f32 v76, v76
    v_mfma_f32_16x16x32_bf16 v[128:131], a[228:231], v[188:191], v[128:131]
    v_exp_f32 v77, v77
    v_exp_f32 v78, v78
    v_exp_f32 v79, v79
    v_mfma_f32_16x16x32_bf16 v[132:135], a[228:231], v[192:195], v[132:135]
    v_cvt_pk_bf16_f32 v230, v76, v77
    v_add_f32 v249, v249, v76
    v_cvt_pk_bf16_f32 v231, v78, v79
    v_add_f32 v249, v249, v77
    ds_write_b64 v243, v[230:231] offset:20480
    v_mfma_f32_16x16x32_bf16 v[136:139], a[232:235], v[176:179], v[136:139]
    v_add_f32 v249, v249, v78
    v_add_f32 v249, v249, v79
    s_add_u32 m0, s29, 12672
    s_add_u32 s38, s99, 458752
    s_waitcnt lgkmcnt(7)
    buffer_load_dwordx4 v233, s[16:19], s38 offen nt lds
    v_mfma_f32_16x16x32_bf16 v[140:143], a[232:235], v[180:183], v[140:143]
    buffer_load_dwordx4 v234, s[16:19], s38 offen offset:1056 nt lds
    v_and_b32 v1, 63, v0
    v_min_u32 v1, 27, v1
    s_mul_i32 s75, s74, 28
    v_add_u32 v2, s75, v1
    v_mfma_f32_16x16x32_bf16 v[144:147], a[232:235], v[184:187], v[144:147]
    buffer_load_dwordx4 v235, s[16:19], s38 offen offset:2112 nt lds
    v_lshlrev_b32 v2, 7, v2
    v_add_u32 v2, 128, v2
    buffer_load_dword v255, v2, s[20:23], 0 offen
    v_mfma_f32_16x16x32_bf16 v[148:151], a[232:235], v[188:191], v[148:151]
    v_mfma_f32_16x16x32_bf16 v[152:155], a[232:235], v[192:195], v[152:155]
    v_fma_f32 v60, v60, s30, -v245
    v_fma_f32 v61, v61, s30, -v245
    v_fma_f32 v62, v62, s30, -v245
    v_fma_f32 v63, v63, s30, -v245
    v_exp_f32 v60, v60
    v_mfma_f32_16x16x32_bf16 v[156:159], a[236:239], v[176:179], v[156:159]
    v_exp_f32 v61, v61
    v_exp_f32 v62, v62
    v_exp_f32 v63, v63
    v_mfma_f32_16x16x32_bf16 v[160:163], a[236:239], v[180:183], v[160:163]
    v_cvt_pk_bf16_f32 v216, v60, v61
    v_add_f32 v250, v250, v60
    v_cvt_pk_bf16_f32 v217, v62, v63
    v_add_f32 v250, v250, v61
    ds_write_b64 v242, v[216:217] offset:24576
    v_mfma_f32_16x16x32_bf16 v[164:167], a[236:239], v[184:187], v[164:167]
    v_add_f32 v250, v250, v62
    v_add_f32 v250, v250, v63
    buffer_load_dwordx4 v236, s[16:19], s38 offen offset:3168 nt lds
    v_mfma_f32_16x16x32_bf16 v[168:171], a[236:239], v[188:191], v[168:171]
    v_mfma_f32_16x16x32_bf16 v[172:175], a[236:239], v[192:195], v[172:175]
    ds_read_b128 v[176:179], v240 offset:0
    ds_read_b128 v[180:183], v240 offset:4096
    ds_read_b128 v[184:187], v240 offset:8192
    ds_read_b128 v[188:191], v240 offset:12288
    ds_read_b128 v[192:195], v240 offset:16384
    s_waitcnt lgkmcnt(11)
    v_mfma_f32_16x16x32_bf16 v[96:99], a[240:243], v[196:199], v[96:99]
    s_waitcnt vmcnt(21)
    ds_read_b64_tr_b16 a[224:225], v237 offset:0
    ds_read_b64_tr_b16 a[226:227], v237 offset:256
    ds_read_b64_tr_b16 a[228:229], v237 offset:32
    ds_read_b64_tr_b16 a[230:231], v237 offset:288
    ds_read_b64_tr_b16 a[232:233], v237 offset:64
    s_waitcnt lgkmcnt(15)
    v_mfma_f32_16x16x32_bf16 v[100:103], a[240:243], v[200:203], v[100:103]
    ds_read_b64_tr_b16 a[234:235], v237 offset:320
    ds_read_b64_tr_b16 a[236:237], v237 offset:96
    ds_read_b64_tr_b16 a[238:239], v237 offset:352
    v_fma_f32 v80, v80, s30, -v245
    v_fma_f32 v81, v81, s30, -v245
    s_waitcnt lgkmcnt(15)
    v_mfma_f32_16x16x32_bf16 v[104:107], a[240:243], v[204:207], v[104:107]
    v_fma_f32 v82, v82, s30, -v245
    v_fma_f32 v83, v83, s30, -v245
    v_exp_f32 v80, v80
    v_exp_f32 v81, v81
    v_mfma_f32_16x16x32_bf16 v[108:111], a[240:243], v[208:211], v[108:111]
    v_exp_f32 v82, v82
    v_exp_f32 v83, v83
    v_cvt_pk_bf16_f32 v218, v80, v81
    v_mfma_f32_16x16x32_bf16 v[112:115], a[240:243], v[212:215], v[112:115]
    v_add_f32 v250, v250, v80
    v_cvt_pk_bf16_f32 v219, v82, v83
    v_add_f32 v250, v250, v81
    ds_write_b64 v243, v[218:219] offset:24576
    v_add_f32 v250, v250, v82
    v_mfma_f32_16x16x32_bf16 v[116:119], a[244:247], v[196:199], v[116:119]
    v_add_f32 v250, v250, v83
    v_mfma_f32_16x16x32_bf16 v[120:123], a[244:247], v[200:203], v[120:123]
    v_mfma_f32_16x16x32_bf16 v[124:127], a[244:247], v[204:207], v[124:127]
    v_mfma_f32_16x16x32_bf16 v[128:131], a[244:247], v[208:211], v[128:131]
    s_mov_b32 s39, 896
    v_mad_u32_u24 v233, v5, s39, v7
    s_mul_i32 s32, s28, 224
    v_add_u32 v233, s32, v233
    v_add_u32 v234, 864, v233
    v_mfma_f32_16x16x32_bf16 v[132:135], a[244:247], v[212:215], v[132:135]
    v_fma_f32 v64, v64, s30, -v246
    v_fma_f32 v65, v65, s30, -v246
    v_fma_f32 v66, v66, s30, -v246
    v_fma_f32 v67, v67, s30, -v246
    v_exp_f32 v64, v64
    v_mfma_f32_16x16x32_bf16 v[136:139], a[248:251], v[196:199], v[136:139]
    v_exp_f32 v65, v65
    v_exp_f32 v66, v66
    v_exp_f32 v67, v67
    v_mfma_f32_16x16x32_bf16 v[140:143], a[248:251], v[200:203], v[140:143]
    v_cvt_pk_bf16_f32 v220, v64, v65
    v_add_f32 v251, v251, v64
    v_cvt_pk_bf16_f32 v221, v66, v67
    v_add_f32 v251, v251, v65
    ds_write_b64 v242, v[220:221] offset:28672
    v_mfma_f32_16x16x32_bf16 v[144:147], a[248:251], v[204:207], v[144:147]
    v_add_f32 v251, v251, v66
    v_add_f32 v251, v251, v67
    v_add_u32 v235, 5184, v233
    v_add_u32 v236, 5920, v233
    v_add_u32 v233, 128, v233
    v_mfma_f32_16x16x32_bf16 v[148:151], a[248:251], v[208:211], v[148:151]
    s_add_u32 m0, s29, 0
    s_mov_b32 s33, 0
    s_waitcnt lgkmcnt(2)
    buffer_load_dwordx4 v233, s[20:23], s33 offen lds
    buffer_load_dwordx4 v234, s[20:23], s33 offen offset:1056 lds
    buffer_load_dwordx4 v235, s[20:23], s33 offen offset:2112 lds
    v_mfma_f32_16x16x32_bf16 v[152:155], a[248:251], v[212:215], v[152:155]
    buffer_load_dwordx4 v236, s[20:23], s33 offen offset:3168 lds
    v_mfma_f32_16x16x32_bf16 v[156:159], a[252:255], v[196:199], v[156:159]
    v_mfma_f32_16x16x32_bf16 v[160:163], a[252:255], v[200:203], v[160:163]
    v_fma_f32 v84, v84, s30, -v246
    v_fma_f32 v85, v85, s30, -v246
    v_fma_f32 v86, v86, s30, -v246
    v_fma_f32 v87, v87, s30, -v246
    v_exp_f32 v84, v84
    v_mfma_f32_16x16x32_bf16 v[164:167], a[252:255], v[204:207], v[164:167]
    v_exp_f32 v85, v85
    v_exp_f32 v86, v86
    v_exp_f32 v87, v87
    v_mfma_f32_16x16x32_bf16 v[168:171], a[252:255], v[208:211], v[168:171]
    v_cvt_pk_bf16_f32 v222, v84, v85
    v_add_f32 v251, v251, v84
    v_cvt_pk_bf16_f32 v223, v86, v87
    v_add_f32 v251, v251, v85
    ds_write_b64 v243, v[222:223] offset:28672
    v_mfma_f32_16x16x32_bf16 v[172:175], a[252:255], v[212:215], v[172:175]
    v_add_f32 v251, v251, v86
    v_add_f32 v251, v251, v87
    ds_read_b128 v[196:199], v241 offset:0
    ds_read_b128 v[200:203], v241 offset:4096
    ds_read_b128 v[204:207], v241 offset:8192
    v_mfma_f32_16x16x32_bf16 v[96:99], a[224:227], v[176:179], v[96:99]
    s_waitcnt vmcnt(21)
    ds_read_b64_tr_b16 a[240:241], v237 offset:4224
    ds_read_b64_tr_b16 a[242:243], v237 offset:4480
    ds_read_b64_tr_b16 a[244:245], v237 offset:4256
    ds_read_b64_tr_b16 a[246:247], v237 offset:4512
    ds_read_b64_tr_b16 a[248:249], v237 offset:4288
    v_mfma_f32_16x16x32_bf16 v[100:103], a[224:227], v[180:183], v[100:103]
    ds_read_b64_tr_b16 a[250:251], v237 offset:4544
    ds_read_b64_tr_b16 a[252:253], v237 offset:4320
    ds_read_b64_tr_b16 a[254:255], v237 offset:4576
    ds_read_b128 v[208:211], v241 offset:12288
    ds_read_b128 v[212:215], v241 offset:16384
    v_mfma_f32_16x16x32_bf16 v[104:107], a[224:227], v[184:187], v[104:107]
    v_mfma_f32_16x16x32_bf16 v[108:111], a[224:227], v[188:191], v[108:111]
    v_fma_f32 v68, v68, s30, -v247
    v_fma_f32 v69, v69, s30, -v247
    v_fma_f32 v70, v70, s30, -v247
    v_fma_f32 v71, v71, s30, -v247
    v_exp_f32 v68, v68
    v_mfma_f32_16x16x32_bf16 v[112:115], a[224:227], v[192:195], v[112:115]
    v_exp_f32 v69, v69
    v_exp_f32 v70, v70
    v_exp_f32 v71, v71
    v_mfma_f32_16x16x32_bf16 v[116:119], a[228:231], v[176:179], v[116:119]
    v_cvt_pk_bf16_f32 v224, v68, v69
    v_add_f32 v252, v252, v68
    v_cvt_pk_bf16_f32 v225, v70, v71
    v_add_f32 v252, v252, v69
    ds_write_b64 v242, v[224:225] offset:32768
    v_mfma_f32_16x16x32_bf16 v[120:123], a[228:231], v[180:183], v[120:123]
    v_add_f32 v252, v252, v70
    v_add_f32 v252, v252, v71
    v_mfma_f32_16x16x32_bf16 v[124:127], a[228:231], v[184:187], v[124:127]
    v_mfma_f32_16x16x32_bf16 v[128:131], a[228:231], v[188:191], v[128:131]
    s_add_u32 m0, s29, 4224
    s_mov_b32 s34, 28672
    s_waitcnt lgkmcnt(3)
    buffer_load_dwordx4 v233, s[20:23], s34 offen lds
    v_mfma_f32_16x16x32_bf16 v[132:135], a[228:231], v[192:195], v[132:135]
    v_mfma_f32_16x16x32_bf16 v[136:139], a[232:235], v[176:179], v[136:139]
    v_fma_f32 v88, v88, s30, -v247
    v_fma_f32 v89, v89, s30, -v247
    v_fma_f32 v90, v90, s30, -v247
    v_fma_f32 v91, v91, s30, -v247
    v_exp_f32 v88, v88
    v_mfma_f32_16x16x32_bf16 v[140:143], a[232:235], v[180:183], v[140:143]
    v_exp_f32 v89, v89
    v_exp_f32 v90, v90
    v_exp_f32 v91, v91
    v_mfma_f32_16x16x32_bf16 v[144:147], a[232:235], v[184:187], v[144:147]
    v_cvt_pk_bf16_f32 v226, v88, v89
    v_add_f32 v252, v252, v88
    v_cvt_pk_bf16_f32 v227, v90, v91
    v_add_f32 v252, v252, v89
    ds_write_b64 v243, v[226:227] offset:32768
    v_mfma_f32_16x16x32_bf16 v[148:151], a[232:235], v[188:191], v[148:151]
    v_add_f32 v252, v252, v90
    v_add_f32 v252, v252, v91
    buffer_load_dwordx4 v234, s[20:23], s34 offen offset:1056 lds
    buffer_load_dwordx4 v235, s[20:23], s34 offen offset:2112 lds
    v_mfma_f32_16x16x32_bf16 v[152:155], a[232:235], v[192:195], v[152:155]
    buffer_load_dwordx4 v236, s[20:23], s34 offen offset:3168 lds
    v_mfma_f32_16x16x32_bf16 v[156:159], a[236:239], v[176:179], v[156:159]
    v_mfma_f32_16x16x32_bf16 v[160:163], a[236:239], v[180:183], v[160:163]
    v_mfma_f32_16x16x32_bf16 v[164:167], a[236:239], v[184:187], v[164:167]
    v_mfma_f32_16x16x32_bf16 v[168:171], a[236:239], v[188:191], v[168:171]
    v_fma_f32 v72, v72, s30, -v248
    v_fma_f32 v73, v73, s30, -v248
    v_fma_f32 v74, v74, s30, -v248
    v_fma_f32 v75, v75, s30, -v248
    v_exp_f32 v72, v72
    v_mfma_f32_16x16x32_bf16 v[172:175], a[236:239], v[192:195], v[172:175]
    v_exp_f32 v73, v73
    v_exp_f32 v74, v74
    v_exp_f32 v75, v75
    v_mfma_f32_16x16x32_bf16 v[96:99], a[240:243], v[196:199], v[96:99]
    s_waitcnt vmcnt(21)
    ds_read_b64_tr_b16 a[224:225], v237 offset:16896
    ds_read_b64_tr_b16 a[226:227], v237 offset:17152
    ds_read_b64_tr_b16 a[228:229], v237 offset:16928
    ds_read_b64_tr_b16 a[230:231], v237 offset:17184
    ds_read_b64_tr_b16 a[232:233], v237 offset:16960
    v_mfma_f32_16x16x32_bf16 v[100:103], a[240:243], v[200:203], v[100:103]
    ds_read_b64_tr_b16 a[234:235], v237 offset:17216
    ds_read_b64_tr_b16 a[236:237], v237 offset:16992
    ds_read_b64_tr_b16 a[238:239], v237 offset:17248
    v_cvt_pk_bf16_f32 v228, v72, v73
    v_add_f32 v253, v253, v72
    v_mfma_f32_16x16x32_bf16 v[104:107], a[240:243], v[204:207], v[104:107]
    v_cvt_pk_bf16_f32 v229, v74, v75
    v_add_f32 v253, v253, v73
    ds_write_b64 v242, v[228:229] offset:36864
    v_add_f32 v253, v253, v74
    v_add_f32 v253, v253, v75
    s_waitcnt lgkmcnt(12)
    v_mfma_f32_16x16x32_bf16 v[108:111], a[240:243], v[208:211], v[108:111]
    s_waitcnt lgkmcnt(11)
    v_mfma_f32_16x16x32_bf16 v[112:115], a[240:243], v[212:215], v[112:115]
    v_mfma_f32_16x16x32_bf16 v[116:119], a[244:247], v[196:199], v[116:119]
    v_fma_f32 v92, v92, s30, -v248
    v_fma_f32 v93, v93, s30, -v248
    v_fma_f32 v94, v94, s30, -v248
    v_fma_f32 v95, v95, s30, -v248
    v_exp_f32 v92, v92
    v_mfma_f32_16x16x32_bf16 v[120:123], a[244:247], v[200:203], v[120:123]
    v_exp_f32 v93, v93
    v_exp_f32 v94, v94
    v_exp_f32 v95, v95
    v_mfma_f32_16x16x32_bf16 v[124:127], a[244:247], v[204:207], v[124:127]
    v_cvt_pk_bf16_f32 v230, v92, v93
    v_add_f32 v253, v253, v92
    v_cvt_pk_bf16_f32 v231, v94, v95
    v_add_f32 v253, v253, v93
    ds_write_b64 v243, v[230:231] offset:36864
    v_mfma_f32_16x16x32_bf16 v[128:131], a[244:247], v[208:211], v[128:131]
    s_add_u32 m0, s29, 16896
    s_mov_b32 s35, 57344
    s_waitcnt lgkmcnt(2)
    buffer_load_dwordx4 v233, s[20:23], s35 offen lds
    v_add_f32 v253, v253, v94
    v_add_f32 v253, v253, v95
    v_mfma_f32_16x16x32_bf16 v[132:135], a[244:247], v[212:215], v[132:135]
    v_mfma_f32_16x16x32_bf16 v[136:139], a[248:251], v[196:199], v[136:139]
    buffer_load_dwordx4 v234, s[20:23], s35 offen offset:1056 lds
    v_mfma_f32_16x16x32_bf16 v[140:143], a[248:251], v[200:203], v[140:143]
    v_mfma_f32_16x16x32_bf16 v[144:147], a[248:251], v[204:207], v[144:147]
    buffer_load_dwordx4 v235, s[20:23], s35 offen offset:2112 lds
    v_mfma_f32_16x16x32_bf16 v[148:151], a[248:251], v[208:211], v[148:151]
    v_mfma_f32_16x16x32_bf16 v[152:155], a[248:251], v[212:215], v[152:155]
    buffer_load_dwordx4 v236, s[20:23], s35 offen offset:3168 lds
    v_mfma_f32_16x16x32_bf16 v[156:159], a[252:255], v[196:199], v[156:159]
    v_mfma_f32_16x16x32_bf16 v[160:163], a[252:255], v[200:203], v[160:163]
    v_mfma_f32_16x16x32_bf16 v[164:167], a[252:255], v[204:207], v[164:167]
    v_mfma_f32_16x16x32_bf16 v[168:171], a[252:255], v[208:211], v[168:171]
    v_mfma_f32_16x16x32_bf16 v[172:175], a[252:255], v[212:215], v[172:175]
    s_waitcnt lgkmcnt(0)
    s_barrier
    ds_read_b128 v[176:179], v238 offset:20480
    ds_read_b128 v[180:183], v238 offset:24576
    ds_read_b128 v[184:187], v238 offset:28672
    ds_read_b128 v[188:191], v238 offset:32768
    ds_read_b128 v[192:195], v238 offset:36864
    s_waitcnt lgkmcnt(4)
    v_mfma_f32_16x16x32_bf16 v[96:99], a[224:227], v[176:179], v[96:99]
    s_waitcnt vmcnt(21)
    ds_read_b64_tr_b16 a[240:241], v237 offset:21120
    ds_read_b64_tr_b16 a[242:243], v237 offset:21376
    ds_read_b64_tr_b16 a[244:245], v237 offset:21152
    ds_read_b64_tr_b16 a[246:247], v237 offset:21408
    ds_read_b64_tr_b16 a[248:249], v237 offset:21184
    s_waitcnt lgkmcnt(8)
    v_mfma_f32_16x16x32_bf16 v[100:103], a[224:227], v[180:183], v[100:103]
    ds_read_b64_tr_b16 a[250:251], v237 offset:21440
    ds_read_b64_tr_b16 a[252:253], v237 offset:21216
    ds_read_b64_tr_b16 a[254:255], v237 offset:21472
    ds_read_b128 v[196:199], v239 offset:20480
    ds_read_b128 v[200:203], v239 offset:24576
    s_waitcnt lgkmcnt(12)
    v_mfma_f32_16x16x32_bf16 v[104:107], a[224:227], v[184:187], v[104:107]
    ds_read_b128 v[204:207], v239 offset:28672
    ds_read_b128 v[208:211], v239 offset:32768
    ds_read_b128 v[212:215], v239 offset:36864
    v_mov_b32 v216, v249
    v_mov_b32 v217, v250
    s_waitcnt lgkmcnt(14)
    v_mfma_f32_16x16x32_bf16 v[108:111], a[224:227], v[188:191], v[108:111]
    v_mov_b32 v218, v251
    v_mov_b32 v219, v252
    v_mov_b32 v220, v253
    v_permlane32_swap_b32 v216, v249
    v_permlane32_swap_b32 v217, v250
    s_waitcnt lgkmcnt(13)
    v_mfma_f32_16x16x32_bf16 v[112:115], a[224:227], v[192:195], v[112:115]
    v_permlane32_swap_b32 v218, v251
    v_permlane32_swap_b32 v219, v252
    v_permlane32_swap_b32 v220, v253
    v_add_f32 v249, v249, v216
    v_add_f32 v250, v250, v217
    v_mfma_f32_16x16x32_bf16 v[116:119], a[228:231], v[176:179], v[116:119]
    v_add_f32 v251, v251, v218
    v_add_f32 v252, v252, v219
    v_add_f32 v253, v253, v220
    v_mov_b32 v216, v249
    v_mov_b32 v217, v250
    v_mfma_f32_16x16x32_bf16 v[120:123], a[228:231], v[180:183], v[120:123]
    v_mov_b32 v218, v251
    v_mov_b32 v219, v252
    v_mov_b32 v220, v253
    v_permlane16_swap_b32 v216, v249
    v_permlane16_swap_b32 v217, v250
    v_mfma_f32_16x16x32_bf16 v[124:127], a[228:231], v[184:187], v[124:127]
    v_permlane16_swap_b32 v218, v251
    v_permlane16_swap_b32 v219, v252
    v_permlane16_swap_b32 v220, v253
    v_add_f32 v249, v249, v216
    v_add_f32 v250, v250, v217
    v_mfma_f32_16x16x32_bf16 v[128:131], a[228:231], v[188:191], v[128:131]
    s_add_u32 m0, s29, 21120
    s_mov_b32 s36, 86016
    s_waitcnt lgkmcnt(5)
    buffer_load_dwordx4 v233, s[20:23], s36 offen lds
    v_add_f32 v251, v251, v218
    v_add_f32 v252, v252, v219
    v_mfma_f32_16x16x32_bf16 v[132:135], a[228:231], v[192:195], v[132:135]
    v_add_f32 v253, v253, v220
    s_lshl_b32 s74, s28, 2
    v_lshlrev_b32 v15, 4, v3
    v_add_u32 v14, s74, v15
    ds_write_b32 v14, v249 offset:42240
    v_mfma_f32_16x16x32_bf16 v[136:139], a[232:235], v[176:179], v[136:139]
    buffer_load_dwordx4 v234, s[20:23], s36 offen offset:1056 lds
    ds_write_b32 v14, v250 offset:42496
    ds_write_b32 v14, v251 offset:42752
    ds_write_b32 v14, v252 offset:43008
    ds_write_b32 v14, v253 offset:43264
    v_mfma_f32_16x16x32_bf16 v[140:143], a[232:235], v[180:183], v[140:143]
    s_waitcnt lgkmcnt(0)
    s_barrier
    ds_read_b128 v[16:19], v15 offset:42240
    ds_read_b128 v[20:23], v15 offset:42496
    ds_read_b128 v[24:27], v15 offset:42752
    ds_read_b128 v[28:31], v15 offset:43008
    v_mfma_f32_16x16x32_bf16 v[144:147], a[232:235], v[184:187], v[144:147]
    buffer_load_dwordx4 v235, s[20:23], s36 offen offset:2112 lds
    ds_read_b128 v[32:35], v15 offset:43264
    s_waitcnt lgkmcnt(4)
    v_add_f32 v16, v16, v17
    v_add_f32 v18, v18, v19
    v_add_f32 v249, v16, v18
    v_mfma_f32_16x16x32_bf16 v[148:151], a[232:235], v[188:191], v[148:151]
    s_waitcnt lgkmcnt(3)
    v_add_f32 v20, v20, v21
    v_add_f32 v22, v22, v23
    v_add_f32 v250, v20, v22
    s_waitcnt lgkmcnt(2)
    v_add_f32 v24, v24, v25
    v_add_f32 v26, v26, v27
    v_mfma_f32_16x16x32_bf16 v[152:155], a[232:235], v[192:195], v[152:155]
    buffer_load_dwordx4 v236, s[20:23], s36 offen offset:3168 lds
    v_add_f32 v251, v24, v26
    s_waitcnt lgkmcnt(1)
    v_add_f32 v28, v28, v29
    v_add_f32 v30, v30, v31
    v_add_f32 v252, v28, v30
    v_mfma_f32_16x16x32_bf16 v[156:159], a[236:239], v[176:179], v[156:159]
    s_waitcnt lgkmcnt(0)
    v_add_f32 v32, v32, v33
    v_add_f32 v34, v34, v35
    v_add_f32 v253, v32, v34
    s_mov_b32 s74, 0x4b800000
    v_cmp_nge_f32 vcc, s74, v249
    v_mfma_f32_16x16x32_bf16 v[160:163], a[236:239], v[180:183], v[160:163]
    s_nop 1
    s_or_b64 s[100:101], s[100:101], vcc
    v_cmp_nge_f32 vcc, s74, v250
    s_nop 1
    s_or_b64 s[100:101], s[100:101], vcc
    v_mfma_f32_16x16x32_bf16 v[164:167], a[236:239], v[184:187], v[164:167]
    v_cmp_nge_f32 vcc, s74, v251
    s_nop 1
    s_or_b64 s[100:101], s[100:101], vcc
    v_cmp_nge_f32 vcc, s74, v252
    s_nop 1
    v_mfma_f32_16x16x32_bf16 v[168:171], a[236:239], v[188:191], v[168:171]
    s_or_b64 s[100:101], s[100:101], vcc
    v_cmp_nge_f32 vcc, s74, v253
    s_nop 1
    s_or_b64 s[100:101], s[100:101], vcc
    v_rcp_f32 v249, v249
    v_mfma_f32_16x16x32_bf16 v[172:175], a[236:239], v[192:195], v[172:175]
    ds_read_b128 v[176:179], v240 offset:20480
    ds_read_b128 v[180:183], v240 offset:24576
    ds_read_b128 v[184:187], v240 offset:28672
    ds_read_b128 v[188:191], v240 offset:32768
    ds_read_b128 v[192:195], v240 offset:36864
    v_mfma_f32_16x16x32_bf16 v[96:99], a[240:243], v[196:199], v[96:99]
    s_waitcnt vmcnt(21)
    ds_read_b64_tr_b16 a[224:225], v237 offset:8448
    ds_read_b64_tr_b16 a[226:227], v237 offset:8704
    ds_read_b64_tr_b16 a[228:229], v237 offset:8480
    ds_read_b64_tr_b16 a[230:231], v237 offset:8736
    ds_read_b64_tr_b16 a[232:233], v237 offset:8512
    v_mfma_f32_16x16x32_bf16 v[100:103], a[240:243], v[200:203], v[100:103]
    ds_read_b64_tr_b16 a[234:235], v237 offset:8768
    ds_read_b64_tr_b16 a[236:237], v237 offset:8544
    ds_read_b64_tr_b16 a[238:239], v237 offset:8800
    v_rcp_f32 v250, v250
    v_rcp_f32 v251, v251
    v_mfma_f32_16x16x32_bf16 v[104:107], a[240:243], v[204:207], v[104:107]
    v_rcp_f32 v252, v252
    v_rcp_f32 v253, v253
    v_mfma_f32_16x16x32_bf16 v[108:111], a[240:243], v[208:211], v[108:111]
    v_mfma_f32_16x16x32_bf16 v[112:115], a[240:243], v[212:215], v[112:115]
    v_mfma_f32_16x16x32_bf16 v[116:119], a[244:247], v[196:199], v[116:119]
    v_mfma_f32_16x16x32_bf16 v[120:123], a[244:247], v[200:203], v[120:123]
    v_mfma_f32_16x16x32_bf16 v[124:127], a[244:247], v[204:207], v[124:127]
    v_mfma_f32_16x16x32_bf16 v[128:131], a[244:247], v[208:211], v[128:131]
    s_add_u32 m0, s29, 8448
    s_mov_b32 s37, 114688
    s_waitcnt lgkmcnt(0)
    buffer_load_dwordx4 v233, s[20:23], s37 offen lds
    v_mfma_f32_16x16x32_bf16 v[132:135], a[244:247], v[212:215], v[132:135]
    v_mfma_f32_16x16x32_bf16 v[136:139], a[248:251], v[196:199], v[136:139]
    buffer_load_dwordx4 v234, s[20:23], s37 offen offset:1056 lds
    v_mfma_f32_16x16x32_bf16 v[140:143], a[248:251], v[200:203], v[140:143]
    v_mfma_f32_16x16x32_bf16 v[144:147], a[248:251], v[204:207], v[144:147]
    buffer_load_dwordx4 v235, s[20:23], s37 offen offset:2112 lds
    v_mfma_f32_16x16x32_bf16 v[148:151], a[248:251], v[208:211], v[148:151]
    v_mfma_f32_16x16x32_bf16 v[152:155], a[248:251], v[212:215], v[152:155]
    buffer_load_dwordx4 v236, s[20:23], s37 offen offset:3168 lds
    v_mfma_f32_16x16x32_bf16 v[156:159], a[252:255], v[196:199], v[156:159]
    v_mfma_f32_16x16x32_bf16 v[160:163], a[252:255], v[200:203], v[160:163]
    v_mfma_f32_16x16x32_bf16 v[164:167], a[252:255], v[204:207], v[164:167]
    v_mfma_f32_16x16x32_bf16 v[168:171], a[252:255], v[208:211], v[168:171]
    v_mfma_f32_16x16x32_bf16 v[172:175], a[252:255], v[212:215], v[172:175]
    ds_read_b128 v[196:199], v241 offset:20480
    ds_read_b128 v[200:203], v241 offset:24576
    ds_read_b128 v[204:207], v241 offset:28672
    ds_read_b128 v[208:211], v241 offset:32768
    ds_read_b128 v[212:215], v241 offset:36864
    v_mfma_f32_16x16x32_bf16 v[96:99], a[224:227], v[176:179], v[96:99]
    s_waitcnt vmcnt(20)
    ds_read_b64_tr_b16 a[240:241], v237 offset:12672
    ds_read_b64_tr_b16 a[242:243], v237 offset:12928
    ds_read_b64_tr_b16 a[244:245], v237 offset:12704
    ds_read_b64_tr_b16 a[246:247], v237 offset:12960
    ds_read_b64_tr_b16 a[248:249], v237 offset:12736
    v_mfma_f32_16x16x32_bf16 v[100:103], a[224:227], v[180:183], v[100:103]
    ds_read_b64_tr_b16 a[250:251], v237 offset:12992
    ds_read_b64_tr_b16 a[252:253], v237 offset:12768
    ds_read_b64_tr_b16 a[254:255], v237 offset:13024
    v_mfma_f32_16x16x32_bf16 v[104:107], a[224:227], v[184:187], v[104:107]
    v_mfma_f32_16x16x32_bf16 v[108:111], a[224:227], v[188:191], v[108:111]
    v_mfma_f32_16x16x32_bf16 v[112:115], a[224:227], v[192:195], v[112:115]
    v_mfma_f32_16x16x32_bf16 v[116:119], a[228:231], v[176:179], v[116:119]
    v_mfma_f32_16x16x32_bf16 v[120:123], a[228:231], v[180:183], v[120:123]
    v_mfma_f32_16x16x32_bf16 v[124:127], a[228:231], v[184:187], v[124:127]
    v_mfma_f32_16x16x32_bf16 v[128:131], a[228:231], v[188:191], v[128:131]
    s_add_u32 m0, s29, 12672
    s_mov_b32 s38, 143360
    s_waitcnt lgkmcnt(0)
    buffer_load_dwordx4 v233, s[20:23], s38 offen lds
    v_mfma_f32_16x16x32_bf16 v[132:135], a[228:231], v[192:195], v[132:135]
    v_mfma_f32_16x16x32_bf16 v[136:139], a[232:235], v[176:179], v[136:139]
    buffer_load_dwordx4 v234, s[20:23], s38 offen offset:1056 lds
    v_mfma_f32_16x16x32_bf16 v[140:143], a[232:235], v[180:183], v[140:143]
    v_mfma_f32_16x16x32_bf16 v[144:147], a[232:235], v[184:187], v[144:147]
    buffer_load_dwordx4 v235, s[20:23], s38 offen offset:2112 lds
    v_mfma_f32_16x16x32_bf16 v[148:151], a[232:235], v[188:191], v[148:151]
    v_mfma_f32_16x16x32_bf16 v[152:155], a[232:235], v[192:195], v[152:155]
    buffer_load_dwordx4 v236, s[20:23], s38 offen offset:3168 lds
    v_mfma_f32_16x16x32_bf16 v[156:159], a[236:239], v[176:179], v[156:159]
    v_mfma_f32_16x16x32_bf16 v[160:163], a[236:239], v[180:183], v[160:163]
    v_mfma_f32_16x16x32_bf16 v[164:167], a[236:239], v[184:187], v[164:167]
    v_mfma_f32_16x16x32_bf16 v[168:171], a[236:239], v[188:191], v[168:171]
    v_mfma_f32_16x16x32_bf16 v[172:175], a[236:239], v[192:195], v[172:175]
    v_mfma_f32_16x16x32_bf16 v[96:99], a[240:243], v[196:199], v[96:99]
    v_mfma_f32_16x16x32_bf16 v[100:103], a[240:243], v[200:203], v[100:103]
    v_mfma_f32_16x16x32_bf16 v[104:107], a[240:243], v[204:207], v[104:107]
    v_mfma_f32_16x16x32_bf16 v[108:111], a[240:243], v[208:211], v[108:111]
    v_mfma_f32_16x16x32_bf16 v[112:115], a[240:243], v[212:215], v[112:115]
    v_mfma_f32_16x16x32_bf16 v[116:119], a[244:247], v[196:199], v[116:119]
    v_mfma_f32_16x16x32_bf16 v[120:123], a[244:247], v[200:203], v[120:123]
    v_mfma_f32_16x16x32_bf16 v[124:127], a[244:247], v[204:207], v[124:127]
    v_mfma_f32_16x16x32_bf16 v[128:131], a[244:247], v[208:211], v[128:131]
    v_mfma_f32_16x16x32_bf16 v[132:135], a[244:247], v[212:215], v[132:135]
    v_mfma_f32_16x16x32_bf16 v[136:139], a[248:251], v[196:199], v[136:139]
    v_mfma_f32_16x16x32_bf16 v[140:143], a[248:251], v[200:203], v[140:143]
    v_mfma_f32_16x16x32_bf16 v[144:147], a[248:251], v[204:207], v[144:147]
    v_mfma_f32_16x16x32_bf16 v[148:151], a[248:251], v[208:211], v[148:151]
    v_mfma_f32_16x16x32_bf16 v[152:155], a[248:251], v[212:215], v[152:155]
    v_mfma_f32_16x16x32_bf16 v[156:159], a[252:255], v[196:199], v[156:159]
    v_mfma_f32_16x16x32_bf16 v[160:163], a[252:255], v[200:203], v[160:163]
    v_mfma_f32_16x16x32_bf16 v[164:167], a[252:255], v[204:207], v[164:167]
    v_mfma_f32_16x16x32_bf16 v[168:171], a[252:255], v[208:211], v[168:171]
    v_mfma_f32_16x16x32_bf16 v[172:175], a[252:255], v[212:215], v[172:175]
    s_waitcnt lgkmcnt(0)
    s_barrier
    s_cmp_eq_u32 s87, 1
    s_cbranch_scc1 L_nofb
    s_cmp_lg_u64 s[100:101], 0
    s_cbranch_scc1 L_fallback
L_nofb:
    v_lshlrev_b32 v1, 9, v3
    v_and_b32 v2, 1, v4
    v_lshl_add_u32 v2, v2, 3, v1
    s_lshl_b32 s74, s28, 3
    v_lshrrev_b32 v13, 1, v4
    v_add_u32 v13, s74, v13
    v_add_u32 v14, 0, v13
    v_xor_b32 v14, v14, v3
    v_lshl_add_u32 v176, v14, 4, v2
    v_add_u32 v14, 2, v13
    v_xor_b32 v14, v14, v3
    v_lshl_add_u32 v177, v14, 4, v2
    v_add_u32 v14, 4, v13
    v_xor_b32 v14, v14, v3
    v_lshl_add_u32 v178, v14, 4, v2
    v_add_u32 v14, 6, v13
    v_xor_b32 v14, v14, v3
    v_lshl_add_u32 v179, v14, 4, v2
    v_mul_f32 v96, v96, v249
    v_mul_f32 v97, v97, v249
    v_mul_f32 v98, v98, v249
    v_mul_f32 v99, v99, v249
    v_cvt_pk_bf16_f32 v216, v96, v97
    v_cvt_pk_bf16_f32 v217, v98, v99
    ds_write_b64 v176, v[216:217] offset:0
    v_mul_f32 v100, v100, v250
    v_mul_f32 v101, v101, v250
    v_mul_f32 v102, v102, v250
    v_mul_f32 v103, v103, v250
    v_cvt_pk_bf16_f32 v218, v100, v101
    v_cvt_pk_bf16_f32 v219, v102, v103
    ds_write_b64 v176, v[218:219] offset:8192
    v_mul_f32 v104, v104, v251
    v_mul_f32 v105, v105, v251
    v_mul_f32 v106, v106, v251
    v_mul_f32 v107, v107, v251
    v_cvt_pk_bf16_f32 v220, v104, v105
    v_cvt_pk_bf16_f32 v221, v106, v107
    ds_write_b64 v176, v[220:221] offset:16384
    v_mul_f32 v108, v108, v252
    v_mul_f32 v109, v109, v252
    v_mul_f32 v110, v110, v252
    v_mul_f32 v111, v111, v252
    v_cvt_pk_bf16_f32 v222, v108, v109
    v_cvt_pk_bf16_f32 v223, v110, v111
    ds_write_b64 v176, v[222:223] offset:24576
    v_mul_f32 v112, v112, v253
    v_mul_f32 v113, v113, v253
    v_mul_f32 v114, v114, v253
    v_mul_f32 v115, v115, v253
    v_cvt_pk_bf16_f32 v224, v112, v113
    v_cvt_pk_bf16_f32 v225, v114, v115
    ds_write_b64 v176, v[224:225] offset:32768
    v_mul_f32 v116, v116, v249
    v_mul_f32 v117, v117, v249
    v_mul_f32 v118, v118, v249
    v_mul_f32 v119, v119, v249
    v_cvt_pk_bf16_f32 v226, v116, v117
    v_cvt_pk_bf16_f32 v227, v118, v119
    ds_write_b64 v177, v[226:227] offset:0
    v_mul_f32 v120, v120, v250
    v_mul_f32 v121, v121, v250
    v_mul_f32 v122, v122, v250
    v_mul_f32 v123, v123, v250
    v_cvt_pk_bf16_f32 v228, v120, v121
    v_cvt_pk_bf16_f32 v229, v122, v123
    ds_write_b64 v177, v[228:229] offset:8192
    v_mul_f32 v124, v124, v251
    v_mul_f32 v125, v125, v251
    v_mul_f32 v126, v126, v251
    v_mul_f32 v127, v127, v251
    v_cvt_pk_bf16_f32 v230, v124, v125
    v_cvt_pk_bf16_f32 v231, v126, v127
    ds_write_b64 v177, v[230:231] offset:16384
    v_mul_f32 v128, v128, v252
    v_mul_f32 v129, v129, v252
    v_mul_f32 v130, v130, v252
    v_mul_f32 v131, v131, v252
    v_cvt_pk_bf16_f32 v216, v128, v129
    v_cvt_pk_bf16_f32 v217, v130, v131
    ds_write_b64 v177, v[216:217] offset:24576
    v_mul_f32 v132, v132, v253
    v_mul_f32 v133, v133, v253
    v_mul_f32 v134, v134, v253
    v_mul_f32 v135, v135, v253
    v_cvt_pk_bf16_f32 v218, v132, v133
    v_cvt_pk_bf16_f32 v219, v134, v135
    ds_write_b64 v177, v[218:219] offset:32768
    v_mul_f32 v136, v136, v249
    v_mul_f32 v137, v137, v249
    v_mul_f32 v138, v138, v249
    v_mul_f32 v139, v139, v249
    v_cvt_pk_bf16_f32 v220, v136, v137
    v_cvt_pk_bf16_f32 v221, v138, v139
    ds_write_b64 v178, v[220:221] offset:0
    v_mul_f32 v140, v140, v250
    v_mul_f32 v141, v141, v250
    v_mul_f32 v142, v142, v250
    v_mul_f32 v143, v143, v250
    v_cvt_pk_bf16_f32 v222, v140, v141
    v_cvt_pk_bf16_f32 v223, v142, v143
    ds_write_b64 v178, v[222:223] offset:8192
    v_mul_f32 v144, v144, v251
    v_mul_f32 v145, v145, v251
    v_mul_f32 v146, v146, v251
    v_mul_f32 v147, v147, v251
    v_cvt_pk_bf16_f32 v224, v144, v145
    v_cvt_pk_bf16_f32 v225, v146, v147
    ds_write_b64 v178, v[224:225] offset:16384
    v_mul_f32 v148, v148, v252
    v_mul_f32 v149, v149, v252
    v_mul_f32 v150, v150, v252
    v_mul_f32 v151, v151, v252
    v_cvt_pk_bf16_f32 v226, v148, v149
    v_cvt_pk_bf16_f32 v227, v150, v151
    ds_write_b64 v178, v[226:227] offset:24576
    v_mul_f32 v152, v152, v253
    v_mul_f32 v153, v153, v253
    v_mul_f32 v154, v154, v253
    v_mul_f32 v155, v155, v253
    v_cvt_pk_bf16_f32 v228, v152, v153
    v_cvt_pk_bf16_f32 v229, v154, v155
    ds_write_b64 v178, v[228:229] offset:32768
    v_mul_f32 v156, v156, v249
    v_mul_f32 v157, v157, v249
    v_mul_f32 v158, v158, v249
    v_mul_f32 v159, v159, v249
    v_cvt_pk_bf16_f32 v230, v156, v157
    v_cvt_pk_bf16_f32 v231, v158, v159
    ds_write_b64 v179, v[230:231] offset:0
    v_mul_f32 v160, v160, v250
    v_mul_f32 v161, v161, v250
    v_mul_f32 v162, v162, v250
    v_mul_f32 v163, v163, v250
    v_cvt_pk_bf16_f32 v216, v160, v161
    v_cvt_pk_bf16_f32 v217, v162, v163
    ds_write_b64 v179, v[216:217] offset:8192
    v_mul_f32 v164, v164, v251
    v_mul_f32 v165, v165, v251
    v_mul_f32 v166, v166, v251
    v_mul_f32 v167, v167, v251
    v_cvt_pk_bf16_f32 v218, v164, v165
    v_cvt_pk_bf16_f32 v219, v166, v167
    ds_write_b64 v179, v[218:219] offset:16384
    v_mul_f32 v168, v168, v252
    v_mul_f32 v169, v169, v252
    v_mul_f32 v170, v170, v252
    v_mul_f32 v171, v171, v252
    v_cvt_pk_bf16_f32 v220, v168, v169
    v_cvt_pk_bf16_f32 v221, v170, v171
    ds_write_b64 v179, v[220:221] offset:24576
    v_mul_f32 v172, v172, v253
    v_mul_f32 v173, v173, v253
    v_mul_f32 v174, v174, v253
    v_mul_f32 v175, v175, v253
    v_cvt_pk_bf16_f32 v222, v172, v173
    v_cvt_pk_bf16_f32 v223, v174, v175
    ds_write_b64 v179, v[222:223] offset:32768
    v_lshlrev_b32 v1, 9, v3
    s_mov_b32 s74, 0
    v_add_u32 v2, s74, v4
    v_xor_b32 v2, v2, v3
    v_lshl_add_u32 v216, v2, 4, v1
    s_mov_b32 s74, 4
    v_add_u32 v2, s74, v4
    v_xor_b32 v2, v2, v3
    v_lshl_add_u32 v217, v2, 4, v1
    s_mov_b32 s74, 8
    v_add_u32 v2, s74, v4
    v_xor_b32 v2, v2, v3
    v_lshl_add_u32 v218, v2, 4, v1
    s_mov_b32 s74, 12
    v_add_u32 v2, s74, v4
    v_xor_b32 v2, v2, v3
    v_lshl_add_u32 v219, v2, 4, v1
    s_mov_b32 s74, 16
    v_add_u32 v2, s74, v4
    v_xor_b32 v2, v2, v3
    v_lshl_add_u32 v220, v2, 4, v1
    s_mov_b32 s74, 20
    v_add_u32 v2, s74, v4
    v_xor_b32 v2, v2, v3
    v_lshl_add_u32 v221, v2, 4, v1
    s_mov_b32 s74, 24
    v_add_u32 v2, s74, v4
    v_xor_b32 v2, v2, v3
    v_lshl_add_u32 v222, v2, 4, v1
    s_mov_b32 s74, 28
    v_add_u32 v2, s74, v4
    v_xor_b32 v2, v2, v3
    v_lshl_add_u32 v223, v2, 4, v1
    s_waitcnt lgkmcnt(0)
    s_barrier
    ds_read_b128 a[0:3], v216 offset:0
    ds_read_b128 a[4:7], v216 offset:8192
    ds_read_b128 a[8:11], v216 offset:16384
    ds_read_b128 a[12:15], v216 offset:24576
    ds_read_b128 a[16:19], v216 offset:32768
    ds_read_b128 a[20:23], v217 offset:0
    ds_read_b128 a[24:27], v217 offset:8192
    ds_read_b128 a[28:31], v217 offset:16384
    ds_read_b128 a[32:35], v217 offset:24576
    ds_read_b128 a[36:39], v217 offset:32768
    ds_read_b128 a[40:43], v218 offset:0
    ds_read_b128 a[44:47], v218 offset:8192
    ds_read_b128 a[48:51], v218 offset:16384
    ds_read_b128 a[52:55], v218 offset:24576
    ds_read_b128 a[56:59], v218 offset:32768
    ds_read_b128 a[60:63], v219 offset:0
    ds_read_b128 a[64:67], v219 offset:8192
    ds_read_b128 a[68:71], v219 offset:16384
    ds_read_b128 a[72:75], v219 offset:24576
    ds_read_b128 a[76:79], v219 offset:32768
    ds_read_b128 a[80:83], v220 offset:0
    ds_read_b128 a[84:87], v220 offset:8192
    ds_read_b128 a[88:91], v220 offset:16384
    ds_read_b128 a[92:95], v220 offset:24576
    ds_read_b128 a[96:99], v220 offset:32768
    ds_read_b128 a[100:103], v221 offset:0
    ds_read_b128 a[104:107], v221 offset:8192
    ds_read_b128 a[108:111], v221 offset:16384
    ds_read_b128 a[112:115], v221 offset:24576
    ds_read_b128 a[116:119], v221 offset:32768
    ds_read_b128 a[120:123], v222 offset:0
    ds_read_b128 a[124:127], v222 offset:8192
    ds_read_b128 a[128:131], v222 offset:16384
    ds_read_b128 a[132:135], v222 offset:24576
    ds_read_b128 a[136:139], v222 offset:32768
    ds_read_b128 a[140:143], v223 offset:0
    ds_read_b128 a[144:147], v223 offset:8192
    ds_read_b128 a[148:151], v223 offset:16384
    ds_read_b128 a[152:155], v223 offset:24576
    ds_read_b128 a[156:159], v223 offset:32768
    v_and_b32 v2, 63, v0
    s_mul_i32 s74, s28, 17920
    v_lshlrev_b32 v1, 4, v2
    v_add_u32 v1, s74, v1
    v_lshlrev_b32 v2, 3, v2
    v_add_u32 v2, s74, v2
    s_waitcnt vmcnt(20)
    ds_read_b64_tr_b16 a[160:161], v237 offset:0
    ds_read_b64_tr_b16 a[162:163], v237 offset:256
    ds_read_b64_tr_b16 a[164:165], v237 offset:32
    ds_read_b64_tr_b16 a[166:167], v237 offset:288
    ds_read_b64_tr_b16 a[168:169], v237 offset:64
    ds_read_b64_tr_b16 a[170:171], v237 offset:320
    ds_read_b64_tr_b16 a[172:173], v237 offset:96
    ds_read_b64_tr_b16 a[174:175], v237 offset:352
    s_waitcnt lgkmcnt(6)
    v_mfma_f32_16x16x32_bf16 v[16:19], a[160:163], a[0:3], 0
    s_waitcnt vmcnt(16)
    ds_read_b64_tr_b16 a[176:177], v237 offset:4224
    ds_read_b64_tr_b16 a[178:179], v237 offset:4480
    ds_read_b64_tr_b16 a[180:181], v237 offset:4256
    v_mfma_f32_16x16x32_bf16 v[20:23], a[160:163], a[4:7], 0
    ds_read_b64_tr_b16 a[182:183], v237 offset:4512
    ds_read_b64_tr_b16 a[184:185], v237 offset:4288
    ds_read_b64_tr_b16 a[186:187], v237 offset:4544
    v_mfma_f32_16x16x32_bf16 v[24:27], a[160:163], a[8:11], 0
    ds_read_b64_tr_b16 a[188:189], v237 offset:4320
    ds_read_b64_tr_b16 a[190:191], v237 offset:4576
    s_add_u32 m0, s29, 0
    v_mfma_f32_16x16x32_bf16 v[28:31], a[160:163], a[12:15], 0
    s_mov_b32 s39, 172032
    s_waitcnt lgkmcnt(8)
    buffer_load_dwordx4 v233, s[20:23], s39 offen lds
    v_mfma_f32_16x16x32_bf16 v[32:35], a[160:163], a[16:19], 0
    buffer_load_dwordx4 v234, s[20:23], s39 offen offset:1056 lds
    v_mfma_f32_16x16x32_bf16 v[36:39], a[164:167], a[0:3], 0
    v_mfma_f32_16x16x32_bf16 v[40:43], a[164:167], a[4:7], 0
    buffer_load_dwordx4 v235, s[20:23], s39 offen offset:2112 lds
    v_mfma_f32_16x16x32_bf16 v[44:47], a[164:167], a[8:11], 0
    v_mfma_f32_16x16x32_bf16 v[48:51], a[164:167], a[12:15], 0
    buffer_load_dwordx4 v236, s[20:23], s39 offen offset:3168 lds
    s_add_u32 m0, s29, 4224
    s_mov_b32 s32, 200704
    v_mfma_f32_16x16x32_bf16 v[52:55], a[164:167], a[16:19], 0
    s_waitcnt lgkmcnt(0)
    buffer_load_dwordx4 v233, s[20:23], s32 offen lds
    buffer_load_dwordx4 v234, s[20:23], s32 offen offset:1056 lds
    v_mfma_f32_16x16x32_bf16 v[56:59], a[168:171], a[0:3], 0
    buffer_load_dwordx4 v235, s[20:23], s32 offen offset:2112 lds
    v_mfma_f32_16x16x32_bf16 v[60:63], a[168:171], a[4:7], 0
    buffer_load_dwordx4 v236, s[20:23], s32 offen offset:3168 lds
    v_mfma_f32_16x16x32_bf16 v[64:67], a[168:171], a[8:11], 0
    v_mfma_f32_16x16x32_bf16 v[68:71], a[168:171], a[12:15], 0
    v_mfma_f32_16x16x32_bf16 v[72:75], a[168:171], a[16:19], 0
    v_mfma_f32_16x16x32_bf16 v[76:79], a[172:175], a[0:3], 0
    v_mfma_f32_16x16x32_bf16 v[80:83], a[172:175], a[4:7], 0
    v_mfma_f32_16x16x32_bf16 v[84:87], a[172:175], a[8:11], 0
    v_mfma_f32_16x16x32_bf16 v[88:91], a[172:175], a[12:15], 0
    v_mfma_f32_16x16x32_bf16 v[92:95], a[172:175], a[16:19], 0
    v_mfma_f32_16x16x32_bf16 v[16:19], a[176:179], a[20:23], v[16:19]
    s_waitcnt vmcnt(20)
    ds_read_b64_tr_b16 a[160:161], v237 offset:16896
    ds_read_b64_tr_b16 a[162:163], v237 offset:17152
    ds_read_b64_tr_b16 a[164:165], v237 offset:16928
    v_mfma_f32_16x16x32_bf16 v[20:23], a[176:179], a[24:27], v[20:23]
    ds_read_b64_tr_b16 a[166:167], v237 offset:17184
    ds_read_b64_tr_b16 a[168:169], v237 offset:16960
    ds_read_b64_tr_b16 a[170:171], v237 offset:17216
    v_mfma_f32_16x16x32_bf16 v[24:27], a[176:179], a[28:31], v[24:27]
    ds_read_b64_tr_b16 a[172:173], v237 offset:16992
    ds_read_b64_tr_b16 a[174:175], v237 offset:17248
    v_mfma_f32_16x16x32_bf16 v[28:31], a[176:179], a[32:35], v[28:31]
    v_mfma_f32_16x16x32_bf16 v[32:35], a[176:179], a[36:39], v[32:35]
    v_mfma_f32_16x16x32_bf16 v[36:39], a[180:183], a[20:23], v[36:39]
    v_mfma_f32_16x16x32_bf16 v[40:43], a[180:183], a[24:27], v[40:43]
    v_mfma_f32_16x16x32_bf16 v[44:47], a[180:183], a[28:31], v[44:47]
    v_mfma_f32_16x16x32_bf16 v[48:51], a[180:183], a[32:35], v[48:51]
    s_add_u32 m0, s29, 16896
    s_mov_b32 s33, 128
    s_waitcnt lgkmcnt(0)
    buffer_load_dwordx4 v233, s[20:23], s33 offen lds
    v_mfma_f32_16x16x32_bf16 v[52:55], a[180:183], a[36:39], v[52:55]
    buffer_load_dwordx4 v234, s[20:23], s33 offen offset:1056 lds
    v_mfma_f32_16x16x32_bf16 v[56:59], a[184:187], a[20:23], v[56:59]
    buffer_load_dwordx4 v235, s[20:23], s33 offen offset:2112 lds
    v_mfma_f32_16x16x32_bf16 v[60:63], a[184:187], a[24:27], v[60:63]
    buffer_load_dwordx4 v236, s[20:23], s33 offen offset:3168 lds
    v_mfma_f32_16x16x32_bf16 v[64:67], a[184:187], a[28:31], v[64:67]
    v_mfma_f32_16x16x32_bf16 v[68:71], a[184:187], a[32:35], v[68:71]
    v_mfma_f32_16x16x32_bf16 v[72:75], a[184:187], a[36:39], v[72:75]
    v_mfma_f32_16x16x32_bf16 v[76:79], a[188:191], a[20:23], v[76:79]
    v_mfma_f32_16x16x32_bf16 v[80:83], a[188:191], a[24:27], v[80:83]
    v_mfma_f32_16x16x32_bf16 v[84:87], a[188:191], a[28:31], v[84:87]
    v_mfma_f32_16x16x32_bf16 v[88:91], a[188:191], a[32:35], v[88:91]
    v_mfma_f32_16x16x32_bf16 v[92:95], a[188:191], a[36:39], v[92:95]
    v_mfma_f32_16x16x32_bf16 v[16:19], a[160:163], a[40:43], v[16:19]
    s_waitcnt vmcnt(20)
    ds_read_b64_tr_b16 a[176:177], v237 offset:21120
    ds_read_b64_tr_b16 a[178:179], v237 offset:21376
    ds_read_b64_tr_b16 a[180:181], v237 offset:21152
    v_mfma_f32_16x16x32_bf16 v[20:23], a[160:163], a[44:47], v[20:23]
    ds_read_b64_tr_b16 a[182:183], v237 offset:21408
    ds_read_b64_tr_b16 a[184:185], v237 offset:21184
    ds_read_b64_tr_b16 a[186:187], v237 offset:21440
    v_mfma_f32_16x16x32_bf16 v[24:27], a[160:163], a[48:51], v[24:27]
    ds_read_b64_tr_b16 a[188:189], v237 offset:21216
    ds_read_b64_tr_b16 a[190:191], v237 offset:21472
    v_mfma_f32_16x16x32_bf16 v[28:31], a[160:163], a[52:55], v[28:31]
    v_mfma_f32_16x16x32_bf16 v[32:35], a[160:163], a[56:59], v[32:35]
    v_mfma_f32_16x16x32_bf16 v[36:39], a[164:167], a[40:43], v[36:39]
    v_mfma_f32_16x16x32_bf16 v[40:43], a[164:167], a[44:47], v[40:43]
    v_mfma_f32_16x16x32_bf16 v[44:47], a[164:167], a[48:51], v[44:47]
    v_mfma_f32_16x16x32_bf16 v[48:51], a[164:167], a[52:55], v[48:51]
    s_add_u32 m0, s29, 21120
    s_mov_b32 s34, 28800
    s_waitcnt lgkmcnt(0)
    buffer_load_dwordx4 v233, s[20:23], s34 offen lds
    v_mfma_f32_16x16x32_bf16 v[52:55], a[164:167], a[56:59], v[52:55]
    buffer_load_dwordx4 v234, s[20:23], s34 offen offset:1056 lds
    v_mfma_f32_16x16x32_bf16 v[56:59], a[168:171], a[40:43], v[56:59]
    buffer_load_dwordx4 v235, s[20:23], s34 offen offset:2112 lds
    v_mfma_f32_16x16x32_bf16 v[60:63], a[168:171], a[44:47], v[60:63]
    buffer_load_dwordx4 v236, s[20:23], s34 offen offset:3168 lds
    v_mfma_f32_16x16x32_bf16 v[64:67], a[168:171], a[48:51], v[64:67]
    v_mfma_f32_16x16x32_bf16 v[68:71], a[168:171], a[52:55], v[68:71]
    v_mfma_f32_16x16x32_bf16 v[72:75], a[168:171], a[56:59], v[72:75]
    v_mfma_f32_16x16x32_bf16 v[76:79], a[172:175], a[40:43], v[76:79]
    v_mfma_f32_16x16x32_bf16 v[80:83], a[172:175], a[44:47], v[80:83]
    v_mfma_f32_16x16x32_bf16 v[84:87], a[172:175], a[48:51], v[84:87]
    v_mfma_f32_16x16x32_bf16 v[88:91], a[172:175], a[52:55], v[88:91]
    v_mfma_f32_16x16x32_bf16 v[92:95], a[172:175], a[56:59], v[92:95]
    v_mfma_f32_16x16x32_bf16 v[16:19], a[176:179], a[60:63], v[16:19]
    s_waitcnt vmcnt(20)
    ds_read_b64_tr_b16 a[160:161], v237 offset:8448
    ds_read_b64_tr_b16 a[162:163], v237 offset:8704
    ds_read_b64_tr_b16 a[164:165], v237 offset:8480
    v_mfma_f32_16x16x32_bf16 v[20:23], a[176:179], a[64:67], v[20:23]
    ds_read_b64_tr_b16 a[166:167], v237 offset:8736
    ds_read_b64_tr_b16 a[168:169], v237 offset:8512
    ds_read_b64_tr_b16 a[170:171], v237 offset:8768
    v_mfma_f32_16x16x32_bf16 v[24:27], a[176:179], a[68:71], v[24:27]
    ds_read_b64_tr_b16 a[172:173], v237 offset:8544
    ds_read_b64_tr_b16 a[174:175], v237 offset:8800
    v_mfma_f32_16x16x32_bf16 v[28:31], a[176:179], a[72:75], v[28:31]
    v_mfma_f32_16x16x32_bf16 v[32:35], a[176:179], a[76:79], v[32:35]
    v_mfma_f32_16x16x32_bf16 v[36:39], a[180:183], a[60:63], v[36:39]
    v_mfma_f32_16x16x32_bf16 v[40:43], a[180:183], a[64:67], v[40:43]
    v_mfma_f32_16x16x32_bf16 v[44:47], a[180:183], a[68:71], v[44:47]
    v_mfma_f32_16x16x32_bf16 v[48:51], a[180:183], a[72:75], v[48:51]
    s_add_u32 m0, s29, 8448
    s_mov_b32 s35, 57472
    s_waitcnt lgkmcnt(0)
    buffer_load_dwordx4 v233, s[20:23], s35 offen lds
    v_mfma_f32_16x16x32_bf16 v[52:55], a[180:183], a[76:79], v[52:55]
    buffer_load_dwordx4 v234, s[20:23], s35 offen offset:1056 lds
    v_mfma_f32_16x16x32_bf16 v[56:59], a[184:187], a[60:63], v[56:59]
    buffer_load_dwordx4 v235, s[20:23], s35 offen offset:2112 lds
    v_mfma_f32_16x16x32_bf16 v[60:63], a[184:187], a[64:67], v[60:63]
    buffer_load_dwordx4 v236, s[20:23], s35 offen offset:3168 lds
    v_mfma_f32_16x16x32_bf16 v[64:67], a[184:187], a[68:71], v[64:67]
    v_mfma_f32_16x16x32_bf16 v[68:71], a[184:187], a[72:75], v[68:71]
    v_mfma_f32_16x16x32_bf16 v[72:75], a[184:187], a[76:79], v[72:75]
    v_mfma_f32_16x16x32_bf16 v[76:79], a[188:191], a[60:63], v[76:79]
    v_mfma_f32_16x16x32_bf16 v[80:83], a[188:191], a[64:67], v[80:83]
    v_mfma_f32_16x16x32_bf16 v[84:87], a[188:191], a[68:71], v[84:87]
    v_mfma_f32_16x16x32_bf16 v[88:91], a[188:191], a[72:75], v[88:91]
    v_mfma_f32_16x16x32_bf16 v[92:95], a[188:191], a[76:79], v[92:95]
    v_mfma_f32_16x16x32_bf16 v[16:19], a[160:163], a[80:83], v[16:19]
    s_waitcnt vmcnt(20)
    ds_read_b64_tr_b16 a[176:177], v237 offset:12672
    ds_read_b64_tr_b16 a[178:179], v237 offset:12928
    ds_read_b64_tr_b16 a[180:181], v237 offset:12704
    v_mfma_f32_16x16x32_bf16 v[20:23], a[160:163], a[84:87], v[20:23]
    ds_read_b64_tr_b16 a[182:183], v237 offset:12960
    ds_read_b64_tr_b16 a[184:185], v237 offset:12736
    ds_read_b64_tr_b16 a[186:187], v237 offset:12992
    v_mfma_f32_16x16x32_bf16 v[24:27], a[160:163], a[88:91], v[24:27]
    ds_read_b64_tr_b16 a[188:189], v237 offset:12768
    ds_read_b64_tr_b16 a[190:191], v237 offset:13024
    v_mfma_f32_16x16x32_bf16 v[28:31], a[160:163], a[92:95], v[28:31]
    v_mfma_f32_16x16x32_bf16 v[32:35], a[160:163], a[96:99], v[32:35]
    v_mfma_f32_16x16x32_bf16 v[36:39], a[164:167], a[80:83], v[36:39]
    v_mfma_f32_16x16x32_bf16 v[40:43], a[164:167], a[84:87], v[40:43]
    v_mfma_f32_16x16x32_bf16 v[44:47], a[164:167], a[88:91], v[44:47]
    v_mfma_f32_16x16x32_bf16 v[48:51], a[164:167], a[92:95], v[48:51]
    s_add_u32 m0, s29, 12672
    s_mov_b32 s36, 86144
    s_waitcnt lgkmcnt(0)
    buffer_load_dwordx4 v233, s[20:23], s36 offen lds
    v_mfma_f32_16x16x32_bf16 v[52:55], a[164:167], a[96:99], v[52:55]
    buffer_load_dwordx4 v234, s[20:23], s36 offen offset:1056 lds
    v_mfma_f32_16x16x32_bf16 v[56:59], a[168:171], a[80:83], v[56:59]
    buffer_load_dwordx4 v235, s[20:23], s36 offen offset:2112 lds
    v_mfma_f32_16x16x32_bf16 v[60:63], a[168:171], a[84:87], v[60:63]
    buffer_load_dwordx4 v236, s[20:23], s36 offen offset:3168 lds
    v_mfma_f32_16x16x32_bf16 v[64:67], a[168:171], a[88:91], v[64:67]
    v_mfma_f32_16x16x32_bf16 v[68:71], a[168:171], a[92:95], v[68:71]
    v_mfma_f32_16x16x32_bf16 v[72:75], a[168:171], a[96:99], v[72:75]
    v_mfma_f32_16x16x32_bf16 v[76:79], a[172:175], a[80:83], v[76:79]
    v_mfma_f32_16x16x32_bf16 v[80:83], a[172:175], a[84:87], v[80:83]
    v_mfma_f32_16x16x32_bf16 v[84:87], a[172:175], a[88:91], v[84:87]
    v_mfma_f32_16x16x32_bf16 v[88:91], a[172:175], a[92:95], v[88:91]
    v_mfma_f32_16x16x32_bf16 v[92:95], a[172:175], a[96:99], v[92:95]
    v_mfma_f32_16x16x32_bf16 v[16:19], a[176:179], a[100:103], v[16:19]
    s_waitcnt vmcnt(20)
    ds_read_b64_tr_b16 a[160:161], v237 offset:0
    ds_read_b64_tr_b16 a[162:163], v237 offset:256
    ds_read_b64_tr_b16 a[164:165], v237 offset:32
    v_mfma_f32_16x16x32_bf16 v[20:23], a[176:179], a[104:107], v[20:23]
    ds_read_b64_tr_b16 a[166:167], v237 offset:288
    ds_read_b64_tr_b16 a[168:169], v237 offset:64
    ds_read_b64_tr_b16 a[170:171], v237 offset:320
    v_mfma_f32_16x16x32_bf16 v[24:27], a[176:179], a[108:111], v[24:27]
    ds_read_b64_tr_b16 a[172:173], v237 offset:96
    ds_read_b64_tr_b16 a[174:175], v237 offset:352
    v_mfma_f32_16x16x32_bf16 v[28:31], a[176:179], a[112:115], v[28:31]
    v_mfma_f32_16x16x32_bf16 v[32:35], a[176:179], a[116:119], v[32:35]
    v_mfma_f32_16x16x32_bf16 v[36:39], a[180:183], a[100:103], v[36:39]
    v_mfma_f32_16x16x32_bf16 v[40:43], a[180:183], a[104:107], v[40:43]
    v_mfma_f32_16x16x32_bf16 v[44:47], a[180:183], a[108:111], v[44:47]
    v_mfma_f32_16x16x32_bf16 v[48:51], a[180:183], a[112:115], v[48:51]
    s_add_u32 m0, s29, 0
    s_mov_b32 s37, 114816
    s_waitcnt lgkmcnt(0)
    buffer_load_dwordx4 v233, s[20:23], s37 offen lds
    v_mfma_f32_16x16x32_bf16 v[52:55], a[180:183], a[116:119], v[52:55]
    buffer_load_dwordx4 v234, s[20:23], s37 offen offset:1056 lds
    v_mfma_f32_16x16x32_bf16 v[56:59], a[184:187], a[100:103], v[56:59]
    buffer_load_dwordx4 v235, s[20:23], s37 offen offset:2112 lds
    v_mfma_f32_16x16x32_bf16 v[60:63], a[184:187], a[104:107], v[60:63]
    buffer_load_dwordx4 v236, s[20:23], s37 offen offset:3168 lds
    v_mfma_f32_16x16x32_bf16 v[64:67], a[184:187], a[108:111], v[64:67]
    v_mfma_f32_16x16x32_bf16 v[68:71], a[184:187], a[112:115], v[68:71]
    v_mfma_f32_16x16x32_bf16 v[72:75], a[184:187], a[116:119], v[72:75]
    v_mfma_f32_16x16x32_bf16 v[76:79], a[188:191], a[100:103], v[76:79]
    v_mfma_f32_16x16x32_bf16 v[80:83], a[188:191], a[104:107], v[80:83]
    v_mfma_f32_16x16x32_bf16 v[84:87], a[188:191], a[108:111], v[84:87]
    v_mfma_f32_16x16x32_bf16 v[88:91], a[188:191], a[112:115], v[88:91]
    v_mfma_f32_16x16x32_bf16 v[92:95], a[188:191], a[116:119], v[92:95]
    v_mfma_f32_16x16x32_bf16 v[16:19], a[160:163], a[120:123], v[16:19]
    s_waitcnt vmcnt(20)
    ds_read_b64_tr_b16 a[176:177], v237 offset:4224
    ds_read_b64_tr_b16 a[178:179], v237 offset:4480
    ds_read_b64_tr_b16 a[180:181], v237 offset:4256
    v_mfma_f32_16x16x32_bf16 v[20:23], a[160:163], a[124:127], v[20:23]
    ds_read_b64_tr_b16 a[182:183], v237 offset:4512
    ds_read_b64_tr_b16 a[184:185], v237 offset:4288
    ds_read_b64_tr_b16 a[186:187], v237 offset:4544
    v_mfma_f32_16x16x32_bf16 v[24:27], a[160:163], a[128:131], v[24:27]
    ds_read_b64_tr_b16 a[188:189], v237 offset:4320
    ds_read_b64_tr_b16 a[190:191], v237 offset:4576
    v_mfma_f32_16x16x32_bf16 v[28:31], a[160:163], a[132:135], v[28:31]
    v_mfma_f32_16x16x32_bf16 v[32:35], a[160:163], a[136:139], v[32:35]
    v_mfma_f32_16x16x32_bf16 v[36:39], a[164:167], a[120:123], v[36:39]
    v_mfma_f32_16x16x32_bf16 v[40:43], a[164:167], a[124:127], v[40:43]
    v_mfma_f32_16x16x32_bf16 v[44:47], a[164:167], a[128:131], v[44:47]
    v_mfma_f32_16x16x32_bf16 v[48:51], a[164:167], a[132:135], v[48:51]
    s_add_u32 m0, s29, 4224
    s_mov_b32 s38, 143488
    s_waitcnt lgkmcnt(0)
    buffer_load_dwordx4 v233, s[20:23], s38 offen lds
    v_mfma_f32_16x16x32_bf16 v[52:55], a[164:167], a[136:139], v[52:55]
    buffer_load_dwordx4 v234, s[20:23], s38 offen offset:1056 lds
    v_mfma_f32_16x16x32_bf16 v[56:59], a[168:171], a[120:123], v[56:59]
    buffer_load_dwordx4 v235, s[20:23], s38 offen offset:2112 lds
    v_mfma_f32_16x16x32_bf16 v[60:63], a[168:171], a[124:127], v[60:63]
    buffer_load_dwordx4 v236, s[20:23], s38 offen offset:3168 lds
    v_mfma_f32_16x16x32_bf16 v[64:67], a[168:171], a[128:131], v[64:67]
    v_mfma_f32_16x16x32_bf16 v[68:71], a[168:171], a[132:135], v[68:71]
    v_mfma_f32_16x16x32_bf16 v[72:75], a[168:171], a[136:139], v[72:75]
    v_mfma_f32_16x16x32_bf16 v[76:79], a[172:175], a[120:123], v[76:79]
    v_mfma_f32_16x16x32_bf16 v[80:83], a[172:175], a[124:127], v[80:83]
    v_mfma_f32_16x16x32_bf16 v[84:87], a[172:175], a[128:131], v[84:87]
    v_mfma_f32_16x16x32_bf16 v[88:91], a[172:175], a[132:135], v[88:91]
    v_mfma_f32_16x16x32_bf16 v[92:95], a[172:175], a[136:139], v[92:95]
    v_mfma_f32_16x16x32_bf16 v[16:19], a[176:179], a[140:143], v[16:19]
    s_waitcnt vmcnt(20)
    ds_read_b64_tr_b16 a[160:161], v237 offset:16896
    ds_read_b64_tr_b16 a[162:163], v237 offset:17152
    ds_read_b64_tr_b16 a[164:165], v237 offset:16928
    v_mfma_f32_16x16x32_bf16 v[20:23], a[176:179], a[144:147], v[20:23]
    ds_read_b64_tr_b16 a[166:167], v237 offset:17184
    ds_read_b64_tr_b16 a[168:169], v237 offset:16960
    ds_read_b64_tr_b16 a[170:171], v237 offset:17216
    v_mfma_f32_16x16x32_bf16 v[24:27], a[176:179], a[148:151], v[24:27]
    v_mfma_f32_16x16x32_bf16 v[28:31], a[176:179], a[152:155], v[28:31]
    v_mfma_f32_16x16x32_bf16 v[32:35], a[176:179], a[156:159], v[32:35]
    v_mfma_f32_16x16x32_bf16 v[36:39], a[180:183], a[140:143], v[36:39]
    v_mfma_f32_16x16x32_bf16 v[40:43], a[180:183], a[144:147], v[40:43]
    v_mfma_f32_16x16x32_bf16 v[44:47], a[180:183], a[148:151], v[44:47]
    v_mfma_f32_16x16x32_bf16 v[48:51], a[180:183], a[152:155], v[48:51]
    s_add_u32 m0, s29, 16896
    s_mov_b32 s39, 172160
    s_waitcnt lgkmcnt(0)
    buffer_load_dwordx4 v233, s[20:23], s39 offen lds
    v_mfma_f32_16x16x32_bf16 v[52:55], a[180:183], a[156:159], v[52:55]
    buffer_load_dwordx4 v234, s[20:23], s39 offen offset:1056 lds
    v_mfma_f32_16x16x32_bf16 v[56:59], a[184:187], a[140:143], v[56:59]
    buffer_load_dwordx4 v235, s[20:23], s39 offen offset:2112 lds
    v_mfma_f32_16x16x32_bf16 v[60:63], a[184:187], a[144:147], v[60:63]
    buffer_load_dwordx4 v236, s[20:23], s39 offen offset:3168 lds
    v_mfma_f32_16x16x32_bf16 v[64:67], a[184:187], a[148:151], v[64:67]
    v_mfma_f32_16x16x32_bf16 v[68:71], a[184:187], a[152:155], v[68:71]
    v_mfma_f32_16x16x32_bf16 v[72:75], a[184:187], a[156:159], v[72:75]
    v_mfma_f32_16x16x32_bf16 v[76:79], a[188:191], a[140:143], v[76:79]
    v_mfma_f32_16x16x32_bf16 v[80:83], a[188:191], a[144:147], v[80:83]
    v_mfma_f32_16x16x32_bf16 v[84:87], a[188:191], a[148:151], v[84:87]
    v_mfma_f32_16x16x32_bf16 v[88:91], a[188:191], a[152:155], v[88:91]
    v_mfma_f32_16x16x32_bf16 v[92:95], a[188:191], a[156:159], v[92:95]
    v_mfma_f32_16x16x32_bf16 v[96:99], a[160:163], a[0:3], 0
    s_waitcnt vmcnt(20)
    ds_read_b64_tr_b16 a[176:177], v237 offset:21120
    ds_read_b64_tr_b16 a[178:179], v237 offset:21376
    ds_read_b64_tr_b16 a[180:181], v237 offset:21152
    v_mfma_f32_16x16x32_bf16 v[100:103], a[160:163], a[4:7], 0
    ds_read_b64_tr_b16 a[182:183], v237 offset:21408
    ds_read_b64_tr_b16 a[184:185], v237 offset:21184
    ds_read_b64_tr_b16 a[186:187], v237 offset:21440
    v_mfma_f32_16x16x32_bf16 v[104:107], a[160:163], a[8:11], 0
    v_mfma_f32_16x16x32_bf16 v[108:111], a[160:163], a[12:15], 0
    v_mfma_f32_16x16x32_bf16 v[112:115], a[160:163], a[16:19], 0
    v_mfma_f32_16x16x32_bf16 v[116:119], a[164:167], a[0:3], 0
    v_mfma_f32_16x16x32_bf16 v[120:123], a[164:167], a[4:7], 0
    v_mfma_f32_16x16x32_bf16 v[124:127], a[164:167], a[8:11], 0
    v_mfma_f32_16x16x32_bf16 v[128:131], a[164:167], a[12:15], 0
    s_add_u32 m0, s29, 21120
    s_mov_b32 s32, 200832
    s_waitcnt lgkmcnt(0)
    buffer_load_dwordx4 v233, s[20:23], s32 offen lds
    v_mfma_f32_16x16x32_bf16 v[132:135], a[164:167], a[16:19], 0
    buffer_load_dwordx4 v234, s[20:23], s32 offen offset:1056 lds
    v_mfma_f32_16x16x32_bf16 v[136:139], a[168:171], a[0:3], 0
    buffer_load_dwordx4 v235, s[20:23], s32 offen offset:2112 lds
    v_mfma_f32_16x16x32_bf16 v[140:143], a[168:171], a[4:7], 0
    buffer_load_dwordx4 v236, s[20:23], s32 offen offset:3168 lds
    v_mfma_f32_16x16x32_bf16 v[144:147], a[168:171], a[8:11], 0
    s_mov_b32 s40, 0
    v_cvt_pk_bf16_f32 v216, v16, v17
    v_cvt_pk_bf16_f32 v217, v18, v19
    v_mfma_f32_16x16x32_bf16 v[148:151], a[168:171], a[12:15], 0
    v_cvt_pk_bf16_f32 v218, v36, v37
    v_cvt_pk_bf16_f32 v219, v38, v39
    buffer_store_dwordx4 v[216:219], v1, s[24:27], s40 offen offset:0
    v_mfma_f32_16x16x32_bf16 v[152:155], a[168:171], a[16:19], 0
    v_cvt_pk_bf16_f32 v220, v56, v57
    v_cvt_pk_bf16_f32 v221, v58, v59
    v_cvt_pk_bf16_f32 v222, v76, v77
    v_mfma_f32_16x16x32_bf16 v[96:99], a[176:179], a[20:23], v[96:99]
    s_waitcnt vmcnt(21)
    ds_read_b64_tr_b16 a[160:161], v237 offset:8448
    ds_read_b64_tr_b16 a[162:163], v237 offset:8704
    ds_read_b64_tr_b16 a[164:165], v237 offset:8480
    v_mfma_f32_16x16x32_bf16 v[100:103], a[176:179], a[24:27], v[100:103]
    ds_read_b64_tr_b16 a[166:167], v237 offset:8736
    ds_read_b64_tr_b16 a[168:169], v237 offset:8512
    ds_read_b64_tr_b16 a[170:171], v237 offset:8768
    v_mfma_f32_16x16x32_bf16 v[104:107], a[176:179], a[28:31], v[104:107]
    v_cvt_pk_bf16_f32 v223, v78, v79
    buffer_store_dwordx4 v[220:223], v1, s[24:27], s40 offen offset:1024
    s_mov_b32 s41, 3584
    v_mfma_f32_16x16x32_bf16 v[108:111], a[176:179], a[32:35], v[108:111]
    v_cvt_pk_bf16_f32 v224, v20, v21
    v_cvt_pk_bf16_f32 v225, v22, v23
    v_cvt_pk_bf16_f32 v226, v40, v41
    v_mfma_f32_16x16x32_bf16 v[112:115], a[176:179], a[36:39], v[112:115]
    v_cvt_pk_bf16_f32 v227, v42, v43
    buffer_store_dwordx4 v[224:227], v1, s[24:27], s41 offen offset:0
    v_cvt_pk_bf16_f32 v216, v60, v61
    v_mfma_f32_16x16x32_bf16 v[116:119], a[180:183], a[20:23], v[116:119]
    v_cvt_pk_bf16_f32 v217, v62, v63
    v_cvt_pk_bf16_f32 v218, v80, v81
    v_cvt_pk_bf16_f32 v219, v82, v83
    v_mfma_f32_16x16x32_bf16 v[120:123], a[180:183], a[24:27], v[120:123]
    buffer_store_dwordx4 v[216:219], v1, s[24:27], s41 offen offset:1024
    s_mov_b32 s42, 7168
    v_cvt_pk_bf16_f32 v220, v24, v25
    v_mfma_f32_16x16x32_bf16 v[124:127], a[180:183], a[28:31], v[124:127]
    v_cvt_pk_bf16_f32 v221, v26, v27
    v_cvt_pk_bf16_f32 v222, v44, v45
    v_cvt_pk_bf16_f32 v223, v46, v47
    v_mfma_f32_16x16x32_bf16 v[128:131], a[180:183], a[32:35], v[128:131]
    buffer_store_dwordx4 v[220:223], v1, s[24:27], s42 offen offset:0
    v_cvt_pk_bf16_f32 v224, v64, v65
    v_cvt_pk_bf16_f32 v225, v66, v67
    v_mfma_f32_16x16x32_bf16 v[132:135], a[180:183], a[36:39], v[132:135]
    v_cvt_pk_bf16_f32 v226, v84, v85
    v_cvt_pk_bf16_f32 v227, v86, v87
    buffer_store_dwordx4 v[224:227], v1, s[24:27], s42 offen offset:1024
    v_mfma_f32_16x16x32_bf16 v[136:139], a[184:187], a[20:23], v[136:139]
    s_mov_b32 s43, 10752
    v_cvt_pk_bf16_f32 v216, v28, v29
    v_cvt_pk_bf16_f32 v217, v30, v31
    v_mfma_f32_16x16x32_bf16 v[140:143], a[184:187], a[24:27], v[140:143]
    v_cvt_pk_bf16_f32 v218, v48, v49
    v_cvt_pk_bf16_f32 v219, v50, v51
    buffer_store_dwordx4 v[216:219], v1, s[24:27], s43 offen offset:0
    v_mfma_f32_16x16x32_bf16 v[144:147], a[184:187], a[28:31], v[144:147]
    v_cvt_pk_bf16_f32 v220, v68, v69
    v_cvt_pk_bf16_f32 v221, v70, v71
    v_cvt_pk_bf16_f32 v222, v88, v89
    v_mfma_f32_16x16x32_bf16 v[148:151], a[184:187], a[32:35], v[148:151]
    v_cvt_pk_bf16_f32 v223, v90, v91
    buffer_store_dwordx4 v[220:223], v1, s[24:27], s43 offen offset:1024
    v_mfma_f32_16x16x32_bf16 v[152:155], a[184:187], a[36:39], v[152:155]
    s_waitcnt lgkmcnt(4)
    v_mfma_f32_16x16x32_bf16 v[96:99], a[160:163], a[40:43], v[96:99]
    s_waitcnt vmcnt(24)
    ds_read_b64_tr_b16 a[176:177], v237 offset:12672
    ds_read_b64_tr_b16 a[178:179], v237 offset:12928
    ds_read_b64_tr_b16 a[180:181], v237 offset:12704
    v_mfma_f32_16x16x32_bf16 v[100:103], a[160:163], a[44:47], v[100:103]
    ds_read_b64_tr_b16 a[182:183], v237 offset:12960
    ds_read_b64_tr_b16 a[184:185], v237 offset:12736
    ds_read_b64_tr_b16 a[186:187], v237 offset:12992
    v_mfma_f32_16x16x32_bf16 v[104:107], a[160:163], a[48:51], v[104:107]
    v_mfma_f32_16x16x32_bf16 v[108:111], a[160:163], a[52:55], v[108:111]
    v_mfma_f32_16x16x32_bf16 v[112:115], a[160:163], a[56:59], v[112:115]
    s_waitcnt lgkmcnt(8)
    v_mfma_f32_16x16x32_bf16 v[116:119], a[164:167], a[40:43], v[116:119]
    v_mfma_f32_16x16x32_bf16 v[120:123], a[164:167], a[44:47], v[120:123]
    v_mfma_f32_16x16x32_bf16 v[124:127], a[164:167], a[48:51], v[124:127]
    v_mfma_f32_16x16x32_bf16 v[128:131], a[164:167], a[52:55], v[128:131]
    v_mfma_f32_16x16x32_bf16 v[132:135], a[164:167], a[56:59], v[132:135]
    s_waitcnt lgkmcnt(6)
    v_mfma_f32_16x16x32_bf16 v[136:139], a[168:171], a[40:43], v[136:139]
    v_mfma_f32_16x16x32_bf16 v[140:143], a[168:171], a[44:47], v[140:143]
    v_mfma_f32_16x16x32_bf16 v[144:147], a[168:171], a[48:51], v[144:147]
    v_mfma_f32_16x16x32_bf16 v[148:151], a[168:171], a[52:55], v[148:151]
    v_mfma_f32_16x16x32_bf16 v[152:155], a[168:171], a[56:59], v[152:155]
    s_waitcnt lgkmcnt(4)
    v_mfma_f32_16x16x32_bf16 v[96:99], a[176:179], a[60:63], v[96:99]
    s_waitcnt vmcnt(20)
    ds_read_b64_tr_b16 a[160:161], v237 offset:0
    ds_read_b64_tr_b16 a[162:163], v237 offset:256
    ds_read_b64_tr_b16 a[164:165], v237 offset:32
    v_mfma_f32_16x16x32_bf16 v[100:103], a[176:179], a[64:67], v[100:103]
    ds_read_b64_tr_b16 a[166:167], v237 offset:288
    ds_read_b64_tr_b16 a[168:169], v237 offset:64
    ds_read_b64_tr_b16 a[170:171], v237 offset:320
    v_mfma_f32_16x16x32_bf16 v[104:107], a[176:179], a[68:71], v[104:107]
    v_mfma_f32_16x16x32_bf16 v[108:111], a[176:179], a[72:75], v[108:111]
    v_mfma_f32_16x16x32_bf16 v[112:115], a[176:179], a[76:79], v[112:115]
    s_waitcnt lgkmcnt(8)
    v_mfma_f32_16x16x32_bf16 v[116:119], a[180:183], a[60:63], v[116:119]
    v_mfma_f32_16x16x32_bf16 v[120:123], a[180:183], a[64:67], v[120:123]
    v_mfma_f32_16x16x32_bf16 v[124:127], a[180:183], a[68:71], v[124:127]
    v_mfma_f32_16x16x32_bf16 v[128:131], a[180:183], a[72:75], v[128:131]
    v_mfma_f32_16x16x32_bf16 v[132:135], a[180:183], a[76:79], v[132:135]
    s_waitcnt lgkmcnt(6)
    v_mfma_f32_16x16x32_bf16 v[136:139], a[184:187], a[60:63], v[136:139]
    v_mfma_f32_16x16x32_bf16 v[140:143], a[184:187], a[64:67], v[140:143]
    v_mfma_f32_16x16x32_bf16 v[144:147], a[184:187], a[68:71], v[144:147]
    v_mfma_f32_16x16x32_bf16 v[148:151], a[184:187], a[72:75], v[148:151]
    v_mfma_f32_16x16x32_bf16 v[152:155], a[184:187], a[76:79], v[152:155]
    s_waitcnt lgkmcnt(4)
    v_mfma_f32_16x16x32_bf16 v[96:99], a[160:163], a[80:83], v[96:99]
    s_waitcnt vmcnt(16)
    ds_read_b64_tr_b16 a[176:177], v237 offset:4224
    ds_read_b64_tr_b16 a[178:179], v237 offset:4480
    ds_read_b64_tr_b16 a[180:181], v237 offset:4256
    v_mfma_f32_16x16x32_bf16 v[100:103], a[160:163], a[84:87], v[100:103]
    ds_read_b64_tr_b16 a[182:183], v237 offset:4512
    ds_read_b64_tr_b16 a[184:185], v237 offset:4288
    ds_read_b64_tr_b16 a[186:187], v237 offset:4544
    v_mfma_f32_16x16x32_bf16 v[104:107], a[160:163], a[88:91], v[104:107]
    v_mfma_f32_16x16x32_bf16 v[108:111], a[160:163], a[92:95], v[108:111]
    v_mfma_f32_16x16x32_bf16 v[112:115], a[160:163], a[96:99], v[112:115]
    s_waitcnt lgkmcnt(8)
    v_mfma_f32_16x16x32_bf16 v[116:119], a[164:167], a[80:83], v[116:119]
    v_mfma_f32_16x16x32_bf16 v[120:123], a[164:167], a[84:87], v[120:123]
    v_mfma_f32_16x16x32_bf16 v[124:127], a[164:167], a[88:91], v[124:127]
    v_mfma_f32_16x16x32_bf16 v[128:131], a[164:167], a[92:95], v[128:131]
    v_mfma_f32_16x16x32_bf16 v[132:135], a[164:167], a[96:99], v[132:135]
    s_waitcnt lgkmcnt(6)
    v_mfma_f32_16x16x32_bf16 v[136:139], a[168:171], a[80:83], v[136:139]
    v_mfma_f32_16x16x32_bf16 v[140:143], a[168:171], a[84:87], v[140:143]
    v_mfma_f32_16x16x32_bf16 v[144:147], a[168:171], a[88:91], v[144:147]
    v_mfma_f32_16x16x32_bf16 v[148:151], a[168:171], a[92:95], v[148:151]
    v_mfma_f32_16x16x32_bf16 v[152:155], a[168:171], a[96:99], v[152:155]
    s_waitcnt lgkmcnt(4)
    v_mfma_f32_16x16x32_bf16 v[96:99], a[176:179], a[100:103], v[96:99]
    s_waitcnt vmcnt(12)
    ds_read_b64_tr_b16 a[160:161], v237 offset:16896
    ds_read_b64_tr_b16 a[162:163], v237 offset:17152
    ds_read_b64_tr_b16 a[164:165], v237 offset:16928
    v_mfma_f32_16x16x32_bf16 v[100:103], a[176:179], a[104:107], v[100:103]
    ds_read_b64_tr_b16 a[166:167], v237 offset:17184
    ds_read_b64_tr_b16 a[168:169], v237 offset:16960
    ds_read_b64_tr_b16 a[170:171], v237 offset:17216
    v_mfma_f32_16x16x32_bf16 v[104:107], a[176:179], a[108:111], v[104:107]
    v_mfma_f32_16x16x32_bf16 v[108:111], a[176:179], a[112:115], v[108:111]
    v_mfma_f32_16x16x32_bf16 v[112:115], a[176:179], a[116:119], v[112:115]
    s_waitcnt lgkmcnt(8)
    v_mfma_f32_16x16x32_bf16 v[116:119], a[180:183], a[100:103], v[116:119]
    v_mfma_f32_16x16x32_bf16 v[120:123], a[180:183], a[104:107], v[120:123]
    v_mfma_f32_16x16x32_bf16 v[124:127], a[180:183], a[108:111], v[124:127]
    v_mfma_f32_16x16x32_bf16 v[128:131], a[180:183], a[112:115], v[128:131]
    v_mfma_f32_16x16x32_bf16 v[132:135], a[180:183], a[116:119], v[132:135]
    s_waitcnt lgkmcnt(6)
    v_mfma_f32_16x16x32_bf16 v[136:139], a[184:187], a[100:103], v[136:139]
    v_mfma_f32_16x16x32_bf16 v[140:143], a[184:187], a[104:107], v[140:143]
    v_mfma_f32_16x16x32_bf16 v[144:147], a[184:187], a[108:111], v[144:147]
    v_mfma_f32_16x16x32_bf16 v[148:151], a[184:187], a[112:115], v[148:151]
    v_mfma_f32_16x16x32_bf16 v[152:155], a[184:187], a[116:119], v[152:155]
    s_waitcnt lgkmcnt(4)
    v_mfma_f32_16x16x32_bf16 v[96:99], a[160:163], a[120:123], v[96:99]
    s_waitcnt vmcnt(8)
    ds_read_b64_tr_b16 a[176:177], v237 offset:21120
    ds_read_b64_tr_b16 a[178:179], v237 offset:21376
    ds_read_b64_tr_b16 a[180:181], v237 offset:21152
    v_mfma_f32_16x16x32_bf16 v[100:103], a[160:163], a[124:127], v[100:103]
    ds_read_b64_tr_b16 a[182:183], v237 offset:21408
    ds_read_b64_tr_b16 a[184:185], v237 offset:21184
    ds_read_b64_tr_b16 a[186:187], v237 offset:21440
    v_mfma_f32_16x16x32_bf16 v[104:107], a[160:163], a[128:131], v[104:107]
    v_mfma_f32_16x16x32_bf16 v[108:111], a[160:163], a[132:135], v[108:111]
    v_mfma_f32_16x16x32_bf16 v[112:115], a[160:163], a[136:139], v[112:115]
    s_waitcnt lgkmcnt(8)
    v_mfma_f32_16x16x32_bf16 v[116:119], a[164:167], a[120:123], v[116:119]
    v_mfma_f32_16x16x32_bf16 v[120:123], a[164:167], a[124:127], v[120:123]
    v_mfma_f32_16x16x32_bf16 v[124:127], a[164:167], a[128:131], v[124:127]
    v_mfma_f32_16x16x32_bf16 v[128:131], a[164:167], a[132:135], v[128:131]
    v_mfma_f32_16x16x32_bf16 v[132:135], a[164:167], a[136:139], v[132:135]
    s_waitcnt lgkmcnt(6)
    v_mfma_f32_16x16x32_bf16 v[136:139], a[168:171], a[120:123], v[136:139]
    v_mfma_f32_16x16x32_bf16 v[140:143], a[168:171], a[124:127], v[140:143]
    v_mfma_f32_16x16x32_bf16 v[144:147], a[168:171], a[128:131], v[144:147]
    v_mfma_f32_16x16x32_bf16 v[148:151], a[168:171], a[132:135], v[148:151]
    v_mfma_f32_16x16x32_bf16 v[152:155], a[168:171], a[136:139], v[152:155]
    s_waitcnt lgkmcnt(4)
    v_mfma_f32_16x16x32_bf16 v[96:99], a[176:179], a[140:143], v[96:99]
    v_mfma_f32_16x16x32_bf16 v[100:103], a[176:179], a[144:147], v[100:103]
    v_mfma_f32_16x16x32_bf16 v[104:107], a[176:179], a[148:151], v[104:107]
    v_mfma_f32_16x16x32_bf16 v[108:111], a[176:179], a[152:155], v[108:111]
    v_mfma_f32_16x16x32_bf16 v[112:115], a[176:179], a[156:159], v[112:115]
    s_waitcnt lgkmcnt(2)
    v_mfma_f32_16x16x32_bf16 v[116:119], a[180:183], a[140:143], v[116:119]
    v_mfma_f32_16x16x32_bf16 v[120:123], a[180:183], a[144:147], v[120:123]
    v_mfma_f32_16x16x32_bf16 v[124:127], a[180:183], a[148:151], v[124:127]
    v_mfma_f32_16x16x32_bf16 v[128:131], a[180:183], a[152:155], v[128:131]
    v_mfma_f32_16x16x32_bf16 v[132:135], a[180:183], a[156:159], v[132:135]
    s_waitcnt lgkmcnt(0)
    v_mfma_f32_16x16x32_bf16 v[136:139], a[184:187], a[140:143], v[136:139]
    v_mfma_f32_16x16x32_bf16 v[140:143], a[184:187], a[144:147], v[140:143]
    v_mfma_f32_16x16x32_bf16 v[144:147], a[184:187], a[148:151], v[144:147]
    v_mfma_f32_16x16x32_bf16 v[148:151], a[184:187], a[152:155], v[148:151]
    v_mfma_f32_16x16x32_bf16 v[152:155], a[184:187], a[156:159], v[152:155]
    s_mov_b32 s44, 14336
    s_mov_b64 exec, s[46:47]
    v_cvt_pk_bf16_f32 v216, v32, v33
    v_cvt_pk_bf16_f32 v217, v34, v35
    v_cvt_pk_bf16_f32 v218, v52, v53
    v_cvt_pk_bf16_f32 v219, v54, v55
    buffer_store_dwordx4 v[216:219], v1, s[24:27], s44 offen offset:0
    v_cvt_pk_bf16_f32 v220, v72, v73
    v_cvt_pk_bf16_f32 v221, v74, v75
    v_cvt_pk_bf16_f32 v222, v92, v93
    v_cvt_pk_bf16_f32 v223, v94, v95
    buffer_store_dwordx4 v[220:223], v1, s[24:27], s44 offen offset:1024
    s_mov_b64 exec, -1
    s_mov_b32 s40, 0
    v_cvt_pk_bf16_f32 v216, v96, v97
    v_cvt_pk_bf16_f32 v217, v98, v99
    v_cvt_pk_bf16_f32 v218, v116, v117
    v_cvt_pk_bf16_f32 v219, v118, v119
    buffer_store_dwordx4 v[216:219], v1, s[24:27], s40 offen offset:2048
    v_cvt_pk_bf16_f32 v220, v136, v137
    v_cvt_pk_bf16_f32 v221, v138, v139
    buffer_store_dwordx2 v[220:221], v2, s[24:27], s40 offen offset:3072
    s_mov_b32 s41, 3584
    v_cvt_pk_bf16_f32 v224, v100, v101
    v_cvt_pk_bf16_f32 v225, v102, v103
    v_cvt_pk_bf16_f32 v226, v120, v121
    v_cvt_pk_bf16_f32 v227, v122, v123
    buffer_store_dwordx4 v[224:227], v1, s[24:27], s41 offen offset:2048
    v_cvt_pk_bf16_f32 v216, v140, v141
    v_cvt_pk_bf16_f32 v217, v142, v143
    buffer_store_dwordx2 v[216:217], v2, s[24:27], s41 offen offset:3072
    s_mov_b32 s42, 7168
    v_cvt_pk_bf16_f32 v220, v104, v105
    v_cvt_pk_bf16_f32 v221, v106, v107
    v_cvt_pk_bf16_f32 v222, v124, v125
    v_cvt_pk_bf16_f32 v223, v126, v127
    buffer_store_dwordx4 v[220:223], v1, s[24:27], s42 offen offset:2048
    v_cvt_pk_bf16_f32 v224, v144, v145
    v_cvt_pk_bf16_f32 v225, v146, v147
    buffer_store_dwordx2 v[224:225], v2, s[24:27], s42 offen offset:3072
    s_mov_b32 s43, 10752
    v_cvt_pk_bf16_f32 v216, v108, v109
    v_cvt_pk_bf16_f32 v217, v110, v111
    v_cvt_pk_bf16_f32 v218, v128, v129
    v_cvt_pk_bf16_f32 v219, v130, v131
    buffer_store_dwordx4 v[216:219], v1, s[24:27], s43 offen offset:2048
    v_cvt_pk_bf16_f32 v220, v148, v149
    v_cvt_pk_bf16_f32 v221, v150, v151
    buffer_store_dwordx2 v[220:221], v2, s[24:27], s43 offen offset:3072
    s_mov_b32 s44, 14336
    s_mov_b64 exec, s[46:47]
    v_cvt_pk_bf16_f32 v224, v112, v113
    v_cvt_pk_bf16_f32 v225, v114, v115
    v_cvt_pk_bf16_f32 v226, v132, v133
    v_cvt_pk_bf16_f32 v227, v134, v135
    buffer_store_dwordx4 v[224:227], v1, s[24:27], s44 offen offset:2048
    v_cvt_pk_bf16_f32 v216, v152, v153
    v_cvt_pk_bf16_f32 v217, v154, v155
    buffer_store_dwordx2 v[216:217], v2, s[24:27], s44 offen offset:3072
    s_mov_b64 exec, -1
L_main_done:
    s_endpgm
L_fallback:
    s_waitcnt vmcnt(0) lgkmcnt(0)
    s_barrier
    s_mov_b32 s87, 1
    s_lshl_b32 s74, s28, 5
    v_add_u32 v1, s74, v3
    v_lshlrev_b32 v1, 9, v1
    v_lshl_add_u32 v1, v4, 4, v1
    v_add_u32 v1, 2048, v1
    v_mov_b32 v244, 0xff800000
    v_mov_b32 v245, 0xff800000
    v_mov_b32 v246, 0xff800000
    v_mov_b32 v247, 0xff800000
    v_mov_b32 v248, 0xff800000
    s_mov_b32 s75, 0
L_fb_loop:
    s_add_u32 s76, s75, 8192
    buffer_load_dwordx4 a[160:163], v1, s[12:15], s75 offen offset:0
    buffer_load_dwordx4 a[164:167], v1, s[12:15], s76 offen offset:0
    buffer_load_dwordx4 a[168:171], v1, s[12:15], s75 offen offset:64
    buffer_load_dwordx4 a[172:175], v1, s[12:15], s76 offen offset:64
    buffer_load_dwordx4 a[176:179], v1, s[12:15], s75 offen offset:128
    buffer_load_dwordx4 a[180:183], v1, s[12:15], s76 offen offset:128
    buffer_load_dwordx4 a[184:187], v1, s[12:15], s75 offen offset:192
    buffer_load_dwordx4 a[188:191], v1, s[12:15], s76 offen offset:192
    buffer_load_dwordx4 a[192:195], v1, s[12:15], s75 offen offset:256
    buffer_load_dwordx4 a[196:199], v1, s[12:15], s76 offen offset:256
    buffer_load_dwordx4 a[200:203], v1, s[12:15], s75 offen offset:320
    buffer_load_dwordx4 a[204:207], v1, s[12:15], s76 offen offset:320
    buffer_load_dwordx4 a[208:211], v1, s[12:15], s75 offen offset:384
    buffer_load_dwordx4 a[212:215], v1, s[12:15], s76 offen offset:384
    buffer_load_dwordx4 a[216:219], v1, s[12:15], s75 offen offset:448
    buffer_load_dwordx4 a[220:223], v1, s[12:15], s76 offen offset:448
    s_waitcnt vmcnt(0)
    v_mfma_f32_16x16x32_bf16 v[16:19], a[160:163], a[0:3], 0
    v_mfma_f32_16x16x32_bf16 v[20:23], a[160:163], a[4:7], 0
    v_mfma_f32_16x16x32_bf16 v[24:27], a[160:163], a[8:11], 0
    v_mfma_f32_16x16x32_bf16 v[28:31], a[160:163], a[12:15], 0
    v_mfma_f32_16x16x32_bf16 v[32:35], a[160:163], a[16:19], 0
    v_mfma_f32_16x16x32_bf16 v[36:39], a[164:167], a[0:3], 0
    v_mfma_f32_16x16x32_bf16 v[40:43], a[164:167], a[4:7], 0
    v_mfma_f32_16x16x32_bf16 v[44:47], a[164:167], a[8:11], 0
    v_mfma_f32_16x16x32_bf16 v[48:51], a[164:167], a[12:15], 0
    v_mfma_f32_16x16x32_bf16 v[52:55], a[164:167], a[16:19], 0
    v_mfma_f32_16x16x32_bf16 v[16:19], a[168:171], a[20:23], v[16:19]
    v_mfma_f32_16x16x32_bf16 v[20:23], a[168:171], a[24:27], v[20:23]
    v_mfma_f32_16x16x32_bf16 v[24:27], a[168:171], a[28:31], v[24:27]
    v_mfma_f32_16x16x32_bf16 v[28:31], a[168:171], a[32:35], v[28:31]
    v_mfma_f32_16x16x32_bf16 v[32:35], a[168:171], a[36:39], v[32:35]
    v_mfma_f32_16x16x32_bf16 v[36:39], a[172:175], a[20:23], v[36:39]
    v_mfma_f32_16x16x32_bf16 v[40:43], a[172:175], a[24:27], v[40:43]
    v_mfma_f32_16x16x32_bf16 v[44:47], a[172:175], a[28:31], v[44:47]
    v_mfma_f32_16x16x32_bf16 v[48:51], a[172:175], a[32:35], v[48:51]
    v_mfma_f32_16x16x32_bf16 v[52:55], a[172:175], a[36:39], v[52:55]
    v_mfma_f32_16x16x32_bf16 v[16:19], a[176:179], a[40:43], v[16:19]
    v_mfma_f32_16x16x32_bf16 v[20:23], a[176:179], a[44:47], v[20:23]
    v_mfma_f32_16x16x32_bf16 v[24:27], a[176:179], a[48:51], v[24:27]
    v_mfma_f32_16x16x32_bf16 v[28:31], a[176:179], a[52:55], v[28:31]
    v_mfma_f32_16x16x32_bf16 v[32:35], a[176:179], a[56:59], v[32:35]
    v_mfma_f32_16x16x32_bf16 v[36:39], a[180:183], a[40:43], v[36:39]
    v_mfma_f32_16x16x32_bf16 v[40:43], a[180:183], a[44:47], v[40:43]
    v_mfma_f32_16x16x32_bf16 v[44:47], a[180:183], a[48:51], v[44:47]
    v_mfma_f32_16x16x32_bf16 v[48:51], a[180:183], a[52:55], v[48:51]
    v_mfma_f32_16x16x32_bf16 v[52:55], a[180:183], a[56:59], v[52:55]
    v_mfma_f32_16x16x32_bf16 v[16:19], a[184:187], a[60:63], v[16:19]
    v_mfma_f32_16x16x32_bf16 v[20:23], a[184:187], a[64:67], v[20:23]
    v_mfma_f32_16x16x32_bf16 v[24:27], a[184:187], a[68:71], v[24:27]
    v_mfma_f32_16x16x32_bf16 v[28:31], a[184:187], a[72:75], v[28:31]
    v_mfma_f32_16x16x32_bf16 v[32:35], a[184:187], a[76:79], v[32:35]
    v_mfma_f32_16x16x32_bf16 v[36:39], a[188:191], a[60:63], v[36:39]
    v_mfma_f32_16x16x32_bf16 v[40:43], a[188:191], a[64:67], v[40:43]
    v_mfma_f32_16x16x32_bf16 v[44:47], a[188:191], a[68:71], v[44:47]
    v_mfma_f32_16x16x32_bf16 v[48:51], a[188:191], a[72:75], v[48:51]
    v_mfma_f32_16x16x32_bf16 v[52:55], a[188:191], a[76:79], v[52:55]
    v_mfma_f32_16x16x32_bf16 v[16:19], a[192:195], a[80:83], v[16:19]
    v_mfma_f32_16x16x32_bf16 v[20:23], a[192:195], a[84:87], v[20:23]
    v_mfma_f32_16x16x32_bf16 v[24:27], a[192:195], a[88:91], v[24:27]
    v_mfma_f32_16x16x32_bf16 v[28:31], a[192:195], a[92:95], v[28:31]
    v_mfma_f32_16x16x32_bf16 v[32:35], a[192:195], a[96:99], v[32:35]
    v_mfma_f32_16x16x32_bf16 v[36:39], a[196:199], a[80:83], v[36:39]
    v_mfma_f32_16x16x32_bf16 v[40:43], a[196:199], a[84:87], v[40:43]
    v_mfma_f32_16x16x32_bf16 v[44:47], a[196:199], a[88:91], v[44:47]
    v_mfma_f32_16x16x32_bf16 v[48:51], a[196:199], a[92:95], v[48:51]
    v_mfma_f32_16x16x32_bf16 v[52:55], a[196:199], a[96:99], v[52:55]
    v_mfma_f32_16x16x32_bf16 v[16:19], a[200:203], a[100:103], v[16:19]
    v_mfma_f32_16x16x32_bf16 v[20:23], a[200:203], a[104:107], v[20:23]
    v_mfma_f32_16x16x32_bf16 v[24:27], a[200:203], a[108:111], v[24:27]
    v_mfma_f32_16x16x32_bf16 v[28:31], a[200:203], a[112:115], v[28:31]
    v_mfma_f32_16x16x32_bf16 v[32:35], a[200:203], a[116:119], v[32:35]
    v_mfma_f32_16x16x32_bf16 v[36:39], a[204:207], a[100:103], v[36:39]
    v_mfma_f32_16x16x32_bf16 v[40:43], a[204:207], a[104:107], v[40:43]
    v_mfma_f32_16x16x32_bf16 v[44:47], a[204:207], a[108:111], v[44:47]
    v_mfma_f32_16x16x32_bf16 v[48:51], a[204:207], a[112:115], v[48:51]
    v_mfma_f32_16x16x32_bf16 v[52:55], a[204:207], a[116:119], v[52:55]
    v_mfma_f32_16x16x32_bf16 v[16:19], a[208:211], a[120:123], v[16:19]
    v_mfma_f32_16x16x32_bf16 v[20:23], a[208:211], a[124:127], v[20:23]
    v_mfma_f32_16x16x32_bf16 v[24:27], a[208:211], a[128:131], v[24:27]
    v_mfma_f32_16x16x32_bf16 v[28:31], a[208:211], a[132:135], v[28:31]
    v_mfma_f32_16x16x32_bf16 v[32:35], a[208:211], a[136:139], v[32:35]
    v_mfma_f32_16x16x32_bf16 v[36:39], a[212:215], a[120:123], v[36:39]
    v_mfma_f32_16x16x32_bf16 v[40:43], a[212:215], a[124:127], v[40:43]
    v_mfma_f32_16x16x32_bf16 v[44:47], a[212:215], a[128:131], v[44:47]
    v_mfma_f32_16x16x32_bf16 v[48:51], a[212:215], a[132:135], v[48:51]
    v_mfma_f32_16x16x32_bf16 v[52:55], a[212:215], a[136:139], v[52:55]
    v_mfma_f32_16x16x32_bf16 v[16:19], a[216:219], a[140:143], v[16:19]
    v_mfma_f32_16x16x32_bf16 v[20:23], a[216:219], a[144:147], v[20:23]
    v_mfma_f32_16x16x32_bf16 v[24:27], a[216:219], a[148:151], v[24:27]
    v_mfma_f32_16x16x32_bf16 v[28:31], a[216:219], a[152:155], v[28:31]
    v_mfma_f32_16x16x32_bf16 v[32:35], a[216:219], a[156:159], v[32:35]
    v_mfma_f32_16x16x32_bf16 v[36:39], a[220:223], a[140:143], v[36:39]
    v_mfma_f32_16x16x32_bf16 v[40:43], a[220:223], a[144:147], v[40:43]
    v_mfma_f32_16x16x32_bf16 v[44:47], a[220:223], a[148:151], v[44:47]
    v_mfma_f32_16x16x32_bf16 v[48:51], a[220:223], a[152:155], v[48:51]
    v_mfma_f32_16x16x32_bf16 v[52:55], a[220:223], a[156:159], v[52:55]
    s_nop 15
    v_max3_f32 v244, v244, v16, v17
    v_max3_f32 v244, v244, v18, v19
    v_max3_f32 v244, v244, v36, v37
    v_max3_f32 v244, v244, v38, v39
    v_max3_f32 v245, v245, v20, v21
    v_max3_f32 v245, v245, v22, v23
    v_max3_f32 v245, v245, v40, v41
    v_max3_f32 v245, v245, v42, v43
    v_max3_f32 v246, v246, v24, v25
    v_max3_f32 v246, v246, v26, v27
    v_max3_f32 v246, v246, v44, v45
    v_max3_f32 v246, v246, v46, v47
    v_max3_f32 v247, v247, v28, v29
    v_max3_f32 v247, v247, v30, v31
    v_max3_f32 v247, v247, v48, v49
    v_max3_f32 v247, v247, v50, v51
    v_max3_f32 v248, v248, v32, v33
    v_max3_f32 v248, v248, v34, v35
    v_max3_f32 v248, v248, v52, v53
    v_max3_f32 v248, v248, v54, v55
    s_add_u32 s75, s75, 65536
    s_cmp_lt_u32 s75, 524288
    s_cbranch_scc1 L_fb_loop
    s_waitcnt vmcnt(0) lgkmcnt(0)
    v_mov_b32 v216, v244
    v_mov_b32 v217, v245
    v_mov_b32 v218, v246
    v_mov_b32 v219, v247
    v_mov_b32 v220, v248
    v_permlane32_swap_b32 v216, v244
    v_permlane32_swap_b32 v217, v245
    v_permlane32_swap_b32 v218, v246
    v_permlane32_swap_b32 v219, v247
    v_permlane32_swap_b32 v220, v248
    v_max_f32 v244, v244, v216
    v_max_f32 v245, v245, v217
    v_max_f32 v246, v246, v218
    v_max_f32 v247, v247, v219
    v_max_f32 v248, v248, v220
    v_mov_b32 v216, v244
    v_mov_b32 v217, v245
    v_mov_b32 v218, v246
    v_mov_b32 v219, v247
    v_mov_b32 v220, v248
    v_permlane16_swap_b32 v216, v244
    v_permlane16_swap_b32 v217, v245
    v_permlane16_swap_b32 v218, v246
    v_permlane16_swap_b32 v219, v247
    v_permlane16_swap_b32 v220, v248
    v_max_f32 v244, v244, v216
    v_max_f32 v245, v245, v217
    v_max_f32 v246, v246, v218
    v_max_f32 v247, v247, v219
    v_max_f32 v248, v248, v220
    s_lshl_b32 s74, s28, 2
    v_lshlrev_b32 v15, 4, v3
    v_add_u32 v14, s74, v15
    ds_write_b32 v14, v244 offset:40960
    ds_write_b32 v14, v245 offset:41216
    ds_write_b32 v14, v246 offset:41472
    ds_write_b32 v14, v247 offset:41728
    ds_write_b32 v14, v248 offset:41984
    s_waitcnt lgkmcnt(0)
    s_barrier
    ds_read_b128 v[176:179], v15 offset:40960
    ds_read_b128 v[180:183], v15 offset:41216
    ds_read_b128 v[184:187], v15 offset:41472
    ds_read_b128 v[188:191], v15 offset:41728
    ds_read_b128 v[192:195], v15 offset:41984
    s_waitcnt lgkmcnt(4)
    v_max3_f32 v176, v176, v177, v178
    v_max_f32 v244, v176, v179
    s_waitcnt lgkmcnt(3)
    v_max3_f32 v180, v180, v181, v182
    v_max_f32 v245, v180, v183
    s_waitcnt lgkmcnt(2)
    v_max3_f32 v184, v184, v185, v186
    v_max_f32 v246, v184, v187
    s_waitcnt lgkmcnt(1)
    v_max3_f32 v188, v188, v189, v190
    v_max_f32 v247, v188, v191
    s_waitcnt lgkmcnt(0)
    v_max3_f32 v192, v192, v193, v194
    v_max_f32 v248, v192, v195
    v_accvgpr_write_b32 a192, v244
    v_accvgpr_write_b32 a193, v245
    v_accvgpr_write_b32 a194, v246
    v_accvgpr_write_b32 a195, v247
    v_accvgpr_write_b32 a196, v248
    s_waitcnt vmcnt(0) lgkmcnt(0)
    s_barrier
    s_add_u32 m0, s29, 16896
    s_add_u32 s74, s86, 0
    s_and_b32 s74, s74, 0x7ffff
    s_add_u32 s74, s74, s92
    buffer_load_dwordx4 v9, s[12:15], s74 offen lds
    buffer_load_dwordx4 v10, s[12:15], s74 offen offset:1056 lds
    buffer_load_dwordx4 v11, s[12:15], s74 offen offset:2112 lds
    buffer_load_dwordx4 v12, s[12:15], s74 offen offset:3168 lds
    s_add_u32 m0, s29, 21120
    s_add_u32 s74, s86, 0
    s_and_b32 s74, s74, 0x7ffff
    s_add_u32 s74, s74, s93
    buffer_load_dwordx4 v9, s[12:15], s74 offen lds
    buffer_load_dwordx4 v10, s[12:15], s74 offen offset:1056 lds
    buffer_load_dwordx4 v11, s[12:15], s74 offen offset:2112 lds
    buffer_load_dwordx4 v12, s[12:15], s74 offen offset:3168 lds
    s_add_u32 m0, s29, 8448
    s_add_u32 s74, s86, 0
    s_and_b32 s74, s74, 0x7ffff
    s_add_u32 s74, s74, s94
    buffer_load_dwordx4 v9, s[12:15], s74 offen lds
    buffer_load_dwordx4 v10, s[12:15], s74 offen offset:1056 lds
    buffer_load_dwordx4 v11, s[12:15], s74 offen offset:2112 lds
    buffer_load_dwordx4 v12, s[12:15], s74 offen offset:3168 lds
    s_add_u32 m0, s29, 12672
    s_add_u32 s74, s86, 0
    s_and_b32 s74, s74, 0x7ffff
    s_add_u32 s74, s74, s95
    buffer_load_dwordx4 v9, s[12:15], s74 offen lds
    buffer_load_dwordx4 v10, s[12:15], s74 offen offset:1056 lds
    buffer_load_dwordx4 v11, s[12:15], s74 offen offset:2112 lds
    buffer_load_dwordx4 v12, s[12:15], s74 offen offset:3168 lds
    s_add_u32 m0, s29, 0
    s_add_u32 s74, s86, 65536
    s_and_b32 s74, s74, 0x7ffff
    s_add_u32 s74, s74, s92
    buffer_load_dwordx4 v9, s[12:15], s74 offen lds
    buffer_load_dwordx4 v10, s[12:15], s74 offen offset:1056 lds
    buffer_load_dwordx4 v11, s[12:15], s74 offen offset:2112 lds
    buffer_load_dwordx4 v12, s[12:15], s74 offen offset:3168 lds
    s_add_u32 m0, s29, 4224
    s_add_u32 s74, s86, 65536
    s_and_b32 s74, s74, 0x7ffff
    s_add_u32 s74, s74, s93
    buffer_load_dwordx4 v9, s[12:15], s74 offen lds
    buffer_load_dwordx4 v10, s[12:15], s74 offen offset:1056 lds
    buffer_load_dwordx4 v11, s[12:15], s74 offen offset:2112 lds
    buffer_load_dwordx4 v12, s[12:15], s74 offen offset:3168 lds
    s_branch L_att
.globl gqa_reduce_kernel
.p2align 8
.type gqa_reduce_kernel,@function
gqa_reduce_kernel:
    s_cmp_ge_u32 s2, 320
    s_cbranch_scc1 L_red_done
    s_load_dwordx2 s[4:5], s[0:1], 56
    s_load_dwordx2 s[6:7], s[0:1], 40
    v_lshrrev_b32 v1, 6, v0
    v_and_b32 v2, 63, v0
    v_readfirstlane_b32 s16, v1
    v_and_b32 v3, 15, v2
    v_lshrrev_b32 v4, 4, v2
    s_mul_hi_u32 s17, s2, 0x33333334
    s_mul_i32 s18, s17, 5
    s_sub_u32 s18, s2, s18
    s_and_b32 s19, s17, 3
    s_lshr_b32 s20, s17, 2
    s_mul_i32 s21, s2, 3584
    s_lshl_b32 s22, s16, 10
    s_add_u32 s21, s21, s22
    s_mul_i32 s22, s20, 72
    s_lshl_b32 s23, s18, 4
    s_add_u32 s22, s22, s23
    v_add_u32 v5, s22, v3
    v_mul_u32_u24 v5, 896, v5
    v_lshl_add_u32 v5, v4, 3, v5
    s_mul_i32 s22, s19, 224
    s_lshl_b32 s23, s16, 6
    s_add_u32 s22, s22, s23
    v_add_u32 v5, s22, v5
    s_waitcnt lgkmcnt(0)
    s_mov_b32 s8, s4
    s_mov_b32 s9, s5
    s_mov_b32 s10, 18350080
    s_mov_b32 s11, 0x00020000
    s_mov_b32 s12, s6
    s_mov_b32 s13, s7
    s_mov_b32 s14, 1032192
    s_mov_b32 s15, 0x00020000
    s_cmp_eq_u32 s18, 4
    s_cbranch_scc0 L_red_full
    s_mov_b32 s24, 0x00ff00ff
    s_mov_b32 s25, 0x00ff00ff
    s_mov_b64 exec, s[24:25]
L_red_full:
    s_add_u32 s32, s21, 0
    s_add_u32 s33, s21, 1146880
    s_add_u32 s34, s21, 2293760
    s_add_u32 s35, s21, 3440640
    s_add_u32 s36, s21, 4587520
    s_add_u32 s37, s21, 5734400
    s_add_u32 s38, s21, 6881280
    s_add_u32 s39, s21, 8028160
    s_add_u32 s40, s21, 9175040
    s_add_u32 s41, s21, 10321920
    s_add_u32 s42, s21, 11468800
    s_add_u32 s43, s21, 12615680
    s_add_u32 s44, s21, 13762560
    s_add_u32 s45, s21, 14909440
    s_add_u32 s46, s21, 16056320
    s_add_u32 s47, s21, 17203200
    s_cmp_eq_u32 s16, 3
    s_cbranch_scc1 L_red_single
    v_lshlrev_b32 v1, 4, v2
    buffer_load_dwordx4 v[16:19], v1, s[8:11], s32 offen
    buffer_load_dwordx4 v[20:23], v1, s[8:11], s33 offen
    buffer_load_dwordx4 v[24:27], v1, s[8:11], s34 offen
    buffer_load_dwordx4 v[28:31], v1, s[8:11], s35 offen
    buffer_load_dwordx4 v[32:35], v1, s[8:11], s36 offen
    buffer_load_dwordx4 v[36:39], v1, s[8:11], s37 offen
    buffer_load_dwordx4 v[40:43], v1, s[8:11], s38 offen
    buffer_load_dwordx4 v[44:47], v1, s[8:11], s39 offen
    buffer_load_dwordx4 v[48:51], v1, s[8:11], s40 offen
    buffer_load_dwordx4 v[52:55], v1, s[8:11], s41 offen
    buffer_load_dwordx4 v[56:59], v1, s[8:11], s42 offen
    buffer_load_dwordx4 v[60:63], v1, s[8:11], s43 offen
    buffer_load_dwordx4 v[64:67], v1, s[8:11], s44 offen
    buffer_load_dwordx4 v[68:71], v1, s[8:11], s45 offen
    buffer_load_dwordx4 v[72:75], v1, s[8:11], s46 offen
    buffer_load_dwordx4 v[76:79], v1, s[8:11], s47 offen
    s_waitcnt vmcnt(15)
    v_lshlrev_b32 v6, 16, v16
    v_and_b32 v7, 0xffff0000, v16
    v_lshlrev_b32 v8, 16, v17
    v_and_b32 v9, 0xffff0000, v17
    v_lshlrev_b32 v10, 16, v18
    v_and_b32 v11, 0xffff0000, v18
    v_lshlrev_b32 v12, 16, v19
    v_and_b32 v13, 0xffff0000, v19
    s_waitcnt vmcnt(14)
    v_lshlrev_b32 v14, 16, v20
    v_and_b32 v15, 0xffff0000, v20
    v_add_f32 v6, v6, v14
    v_add_f32 v7, v7, v15
    v_lshlrev_b32 v14, 16, v21
    v_and_b32 v15, 0xffff0000, v21
    v_add_f32 v8, v8, v14
    v_add_f32 v9, v9, v15
    v_lshlrev_b32 v14, 16, v22
    v_and_b32 v15, 0xffff0000, v22
    v_add_f32 v10, v10, v14
    v_add_f32 v11, v11, v15
    v_lshlrev_b32 v14, 16, v23
    v_and_b32 v15, 0xffff0000, v23
    v_add_f32 v12, v12, v14
    v_add_f32 v13, v13, v15
    s_waitcnt vmcnt(13)
    v_lshlrev_b32 v14, 16, v24
    v_and_b32 v15, 0xffff0000, v24
    v_add_f32 v6, v6, v14
    v_add_f32 v7, v7, v15
    v_lshlrev_b32 v14, 16, v25
    v_and_b32 v15, 0xffff0000, v25
    v_add_f32 v8, v8, v14
    v_add_f32 v9, v9, v15
    v_lshlrev_b32 v14, 16, v26
    v_and_b32 v15, 0xffff0000, v26
    v_add_f32 v10, v10, v14
    v_add_f32 v11, v11, v15
    v_lshlrev_b32 v14, 16, v27
    v_and_b32 v15, 0xffff0000, v27
    v_add_f32 v12, v12, v14
    v_add_f32 v13, v13, v15
    s_waitcnt vmcnt(12)
    v_lshlrev_b32 v14, 16, v28
    v_and_b32 v15, 0xffff0000, v28
    v_add_f32 v6, v6, v14
    v_add_f32 v7, v7, v15
    v_lshlrev_b32 v14, 16, v29
    v_and_b32 v15, 0xffff0000, v29
    v_add_f32 v8, v8, v14
    v_add_f32 v9, v9, v15
    v_lshlrev_b32 v14, 16, v30
    v_and_b32 v15, 0xffff0000, v30
    v_add_f32 v10, v10, v14
    v_add_f32 v11, v11, v15
    v_lshlrev_b32 v14, 16, v31
    v_and_b32 v15, 0xffff0000, v31
    v_add_f32 v12, v12, v14
    v_add_f32 v13, v13, v15
    s_waitcnt vmcnt(11)
    v_lshlrev_b32 v14, 16, v32
    v_and_b32 v15, 0xffff0000, v32
    v_add_f32 v6, v6, v14
    v_add_f32 v7, v7, v15
    v_lshlrev_b32 v14, 16, v33
    v_and_b32 v15, 0xffff0000, v33
    v_add_f32 v8, v8, v14
    v_add_f32 v9, v9, v15
    v_lshlrev_b32 v14, 16, v34
    v_and_b32 v15, 0xffff0000, v34
    v_add_f32 v10, v10, v14
    v_add_f32 v11, v11, v15
    v_lshlrev_b32 v14, 16, v35
    v_and_b32 v15, 0xffff0000, v35
    v_add_f32 v12, v12, v14
    v_add_f32 v13, v13, v15
    s_waitcnt vmcnt(10)
    v_lshlrev_b32 v14, 16, v36
    v_and_b32 v15, 0xffff0000, v36
    v_add_f32 v6, v6, v14
    v_add_f32 v7, v7, v15
    v_lshlrev_b32 v14, 16, v37
    v_and_b32 v15, 0xffff0000, v37
    v_add_f32 v8, v8, v14
    v_add_f32 v9, v9, v15
    v_lshlrev_b32 v14, 16, v38
    v_and_b32 v15, 0xffff0000, v38
    v_add_f32 v10, v10, v14
    v_add_f32 v11, v11, v15
    v_lshlrev_b32 v14, 16, v39
    v_and_b32 v15, 0xffff0000, v39
    v_add_f32 v12, v12, v14
    v_add_f32 v13, v13, v15
    s_waitcnt vmcnt(9)
    v_lshlrev_b32 v14, 16, v40
    v_and_b32 v15, 0xffff0000, v40
    v_add_f32 v6, v6, v14
    v_add_f32 v7, v7, v15
    v_lshlrev_b32 v14, 16, v41
    v_and_b32 v15, 0xffff0000, v41
    v_add_f32 v8, v8, v14
    v_add_f32 v9, v9, v15
    v_lshlrev_b32 v14, 16, v42
    v_and_b32 v15, 0xffff0000, v42
    v_add_f32 v10, v10, v14
    v_add_f32 v11, v11, v15
    v_lshlrev_b32 v14, 16, v43
    v_and_b32 v15, 0xffff0000, v43
    v_add_f32 v12, v12, v14
    v_add_f32 v13, v13, v15
    s_waitcnt vmcnt(8)
    v_lshlrev_b32 v14, 16, v44
    v_and_b32 v15, 0xffff0000, v44
    v_add_f32 v6, v6, v14
    v_add_f32 v7, v7, v15
    v_lshlrev_b32 v14, 16, v45
    v_and_b32 v15, 0xffff0000, v45
    v_add_f32 v8, v8, v14
    v_add_f32 v9, v9, v15
    v_lshlrev_b32 v14, 16, v46
    v_and_b32 v15, 0xffff0000, v46
    v_add_f32 v10, v10, v14
    v_add_f32 v11, v11, v15
    v_lshlrev_b32 v14, 16, v47
    v_and_b32 v15, 0xffff0000, v47
    v_add_f32 v12, v12, v14
    v_add_f32 v13, v13, v15
    s_waitcnt vmcnt(7)
    v_lshlrev_b32 v14, 16, v48
    v_and_b32 v15, 0xffff0000, v48
    v_add_f32 v6, v6, v14
    v_add_f32 v7, v7, v15
    v_lshlrev_b32 v14, 16, v49
    v_and_b32 v15, 0xffff0000, v49
    v_add_f32 v8, v8, v14
    v_add_f32 v9, v9, v15
    v_lshlrev_b32 v14, 16, v50
    v_and_b32 v15, 0xffff0000, v50
    v_add_f32 v10, v10, v14
    v_add_f32 v11, v11, v15
    v_lshlrev_b32 v14, 16, v51
    v_and_b32 v15, 0xffff0000, v51
    v_add_f32 v12, v12, v14
    v_add_f32 v13, v13, v15
    s_waitcnt vmcnt(6)
    v_lshlrev_b32 v14, 16, v52
    v_and_b32 v15, 0xffff0000, v52
    v_add_f32 v6, v6, v14
    v_add_f32 v7, v7, v15
    v_lshlrev_b32 v14, 16, v53
    v_and_b32 v15, 0xffff0000, v53
    v_add_f32 v8, v8, v14
    v_add_f32 v9, v9, v15
    v_lshlrev_b32 v14, 16, v54
    v_and_b32 v15, 0xffff0000, v54
    v_add_f32 v10, v10, v14
    v_add_f32 v11, v11, v15
    v_lshlrev_b32 v14, 16, v55
    v_and_b32 v15, 0xffff0000, v55
    v_add_f32 v12, v12, v14
    v_add_f32 v13, v13, v15
    s_waitcnt vmcnt(5)
    v_lshlrev_b32 v14, 16, v56
    v_and_b32 v15, 0xffff0000, v56
    v_add_f32 v6, v6, v14
    v_add_f32 v7, v7, v15
    v_lshlrev_b32 v14, 16, v57
    v_and_b32 v15, 0xffff0000, v57
    v_add_f32 v8, v8, v14
    v_add_f32 v9, v9, v15
    v_lshlrev_b32 v14, 16, v58
    v_and_b32 v15, 0xffff0000, v58
    v_add_f32 v10, v10, v14
    v_add_f32 v11, v11, v15
    v_lshlrev_b32 v14, 16, v59
    v_and_b32 v15, 0xffff0000, v59
    v_add_f32 v12, v12, v14
    v_add_f32 v13, v13, v15
    s_waitcnt vmcnt(4)
    v_lshlrev_b32 v14, 16, v60
    v_and_b32 v15, 0xffff0000, v60
    v_add_f32 v6, v6, v14
    v_add_f32 v7, v7, v15
    v_lshlrev_b32 v14, 16, v61
    v_and_b32 v15, 0xffff0000, v61
    v_add_f32 v8, v8, v14
    v_add_f32 v9, v9, v15
    v_lshlrev_b32 v14, 16, v62
    v_and_b32 v15, 0xffff0000, v62
    v_add_f32 v10, v10, v14
    v_add_f32 v11, v11, v15
    v_lshlrev_b32 v14, 16, v63
    v_and_b32 v15, 0xffff0000, v63
    v_add_f32 v12, v12, v14
    v_add_f32 v13, v13, v15
    s_waitcnt vmcnt(3)
    v_lshlrev_b32 v14, 16, v64
    v_and_b32 v15, 0xffff0000, v64
    v_add_f32 v6, v6, v14
    v_add_f32 v7, v7, v15
    v_lshlrev_b32 v14, 16, v65
    v_and_b32 v15, 0xffff0000, v65
    v_add_f32 v8, v8, v14
    v_add_f32 v9, v9, v15
    v_lshlrev_b32 v14, 16, v66
    v_and_b32 v15, 0xffff0000, v66
    v_add_f32 v10, v10, v14
    v_add_f32 v11, v11, v15
    v_lshlrev_b32 v14, 16, v67
    v_and_b32 v15, 0xffff0000, v67
    v_add_f32 v12, v12, v14
    v_add_f32 v13, v13, v15
    s_waitcnt vmcnt(2)
    v_lshlrev_b32 v14, 16, v68
    v_and_b32 v15, 0xffff0000, v68
    v_add_f32 v6, v6, v14
    v_add_f32 v7, v7, v15
    v_lshlrev_b32 v14, 16, v69
    v_and_b32 v15, 0xffff0000, v69
    v_add_f32 v8, v8, v14
    v_add_f32 v9, v9, v15
    v_lshlrev_b32 v14, 16, v70
    v_and_b32 v15, 0xffff0000, v70
    v_add_f32 v10, v10, v14
    v_add_f32 v11, v11, v15
    v_lshlrev_b32 v14, 16, v71
    v_and_b32 v15, 0xffff0000, v71
    v_add_f32 v12, v12, v14
    v_add_f32 v13, v13, v15
    s_waitcnt vmcnt(1)
    v_lshlrev_b32 v14, 16, v72
    v_and_b32 v15, 0xffff0000, v72
    v_add_f32 v6, v6, v14
    v_add_f32 v7, v7, v15
    v_lshlrev_b32 v14, 16, v73
    v_and_b32 v15, 0xffff0000, v73
    v_add_f32 v8, v8, v14
    v_add_f32 v9, v9, v15
    v_lshlrev_b32 v14, 16, v74
    v_and_b32 v15, 0xffff0000, v74
    v_add_f32 v10, v10, v14
    v_add_f32 v11, v11, v15
    v_lshlrev_b32 v14, 16, v75
    v_and_b32 v15, 0xffff0000, v75
    v_add_f32 v12, v12, v14
    v_add_f32 v13, v13, v15
    s_waitcnt vmcnt(0)
    v_lshlrev_b32 v14, 16, v76
    v_and_b32 v15, 0xffff0000, v76
    v_add_f32 v6, v6, v14
    v_add_f32 v7, v7, v15
    v_lshlrev_b32 v14, 16, v77
    v_and_b32 v15, 0xffff0000, v77
    v_add_f32 v8, v8, v14
    v_add_f32 v9, v9, v15
    v_lshlrev_b32 v14, 16, v78
    v_and_b32 v15, 0xffff0000, v78
    v_add_f32 v10, v10, v14
    v_add_f32 v11, v11, v15
    v_lshlrev_b32 v14, 16, v79
    v_and_b32 v15, 0xffff0000, v79
    v_add_f32 v12, v12, v14
    v_add_f32 v13, v13, v15
    v_cvt_pk_bf16_f32 v16, v6, v7
    v_cvt_pk_bf16_f32 v17, v8, v9
    v_cvt_pk_bf16_f32 v18, v10, v11
    v_cvt_pk_bf16_f32 v19, v12, v13
    buffer_store_dwordx2 v[16:17], v5, s[12:15], 0 offen
    buffer_store_dwordx2 v[18:19], v5, s[12:15], 0 offen offset:32
    s_endpgm
L_red_single:
    v_lshlrev_b32 v1, 3, v2
    buffer_load_dwordx2 v[16:17], v1, s[8:11], s32 offen
    buffer_load_dwordx2 v[20:21], v1, s[8:11], s33 offen
    buffer_load_dwordx2 v[24:25], v1, s[8:11], s34 offen
    buffer_load_dwordx2 v[28:29], v1, s[8:11], s35 offen
    buffer_load_dwordx2 v[32:33], v1, s[8:11], s36 offen
    buffer_load_dwordx2 v[36:37], v1, s[8:11], s37 offen
    buffer_load_dwordx2 v[40:41], v1, s[8:11], s38 offen
    buffer_load_dwordx2 v[44:45], v1, s[8:11], s39 offen
    buffer_load_dwordx2 v[48:49], v1, s[8:11], s40 offen
    buffer_load_dwordx2 v[52:53], v1, s[8:11], s41 offen
    buffer_load_dwordx2 v[56:57], v1, s[8:11], s42 offen
    buffer_load_dwordx2 v[60:61], v1, s[8:11], s43 offen
    buffer_load_dwordx2 v[64:65], v1, s[8:11], s44 offen
    buffer_load_dwordx2 v[68:69], v1, s[8:11], s45 offen
    buffer_load_dwordx2 v[72:73], v1, s[8:11], s46 offen
    buffer_load_dwordx2 v[76:77], v1, s[8:11], s47 offen
    s_waitcnt vmcnt(15)
    v_lshlrev_b32 v6, 16, v16
    v_and_b32 v7, 0xffff0000, v16
    v_lshlrev_b32 v8, 16, v17
    v_and_b32 v9, 0xffff0000, v17
    s_waitcnt vmcnt(14)
    v_lshlrev_b32 v14, 16, v20
    v_and_b32 v15, 0xffff0000, v20
    v_add_f32 v6, v6, v14
    v_add_f32 v7, v7, v15
    v_lshlrev_b32 v14, 16, v21
    v_and_b32 v15, 0xffff0000, v21
    v_add_f32 v8, v8, v14
    v_add_f32 v9, v9, v15
    s_waitcnt vmcnt(13)
    v_lshlrev_b32 v14, 16, v24
    v_and_b32 v15, 0xffff0000, v24
    v_add_f32 v6, v6, v14
    v_add_f32 v7, v7, v15
    v_lshlrev_b32 v14, 16, v25
    v_and_b32 v15, 0xffff0000, v25
    v_add_f32 v8, v8, v14
    v_add_f32 v9, v9, v15
    s_waitcnt vmcnt(12)
    v_lshlrev_b32 v14, 16, v28
    v_and_b32 v15, 0xffff0000, v28
    v_add_f32 v6, v6, v14
    v_add_f32 v7, v7, v15
    v_lshlrev_b32 v14, 16, v29
    v_and_b32 v15, 0xffff0000, v29
    v_add_f32 v8, v8, v14
    v_add_f32 v9, v9, v15
    s_waitcnt vmcnt(11)
    v_lshlrev_b32 v14, 16, v32
    v_and_b32 v15, 0xffff0000, v32
    v_add_f32 v6, v6, v14
    v_add_f32 v7, v7, v15
    v_lshlrev_b32 v14, 16, v33
    v_and_b32 v15, 0xffff0000, v33
    v_add_f32 v8, v8, v14
    v_add_f32 v9, v9, v15
    s_waitcnt vmcnt(10)
    v_lshlrev_b32 v14, 16, v36
    v_and_b32 v15, 0xffff0000, v36
    v_add_f32 v6, v6, v14
    v_add_f32 v7, v7, v15
    v_lshlrev_b32 v14, 16, v37
    v_and_b32 v15, 0xffff0000, v37
    v_add_f32 v8, v8, v14
    v_add_f32 v9, v9, v15
    s_waitcnt vmcnt(9)
    v_lshlrev_b32 v14, 16, v40
    v_and_b32 v15, 0xffff0000, v40
    v_add_f32 v6, v6, v14
    v_add_f32 v7, v7, v15
    v_lshlrev_b32 v14, 16, v41
    v_and_b32 v15, 0xffff0000, v41
    v_add_f32 v8, v8, v14
    v_add_f32 v9, v9, v15
    s_waitcnt vmcnt(8)
    v_lshlrev_b32 v14, 16, v44
    v_and_b32 v15, 0xffff0000, v44
    v_add_f32 v6, v6, v14
    v_add_f32 v7, v7, v15
    v_lshlrev_b32 v14, 16, v45
    v_and_b32 v15, 0xffff0000, v45
    v_add_f32 v8, v8, v14
    v_add_f32 v9, v9, v15
    s_waitcnt vmcnt(7)
    v_lshlrev_b32 v14, 16, v48
    v_and_b32 v15, 0xffff0000, v48
    v_add_f32 v6, v6, v14
    v_add_f32 v7, v7, v15
    v_lshlrev_b32 v14, 16, v49
    v_and_b32 v15, 0xffff0000, v49
    v_add_f32 v8, v8, v14
    v_add_f32 v9, v9, v15
    s_waitcnt vmcnt(6)
    v_lshlrev_b32 v14, 16, v52
    v_and_b32 v15, 0xffff0000, v52
    v_add_f32 v6, v6, v14
    v_add_f32 v7, v7, v15
    v_lshlrev_b32 v14, 16, v53
    v_and_b32 v15, 0xffff0000, v53
    v_add_f32 v8, v8, v14
    v_add_f32 v9, v9, v15
    s_waitcnt vmcnt(5)
    v_lshlrev_b32 v14, 16, v56
    v_and_b32 v15, 0xffff0000, v56
    v_add_f32 v6, v6, v14
    v_add_f32 v7, v7, v15
    v_lshlrev_b32 v14, 16, v57
    v_and_b32 v15, 0xffff0000, v57
    v_add_f32 v8, v8, v14
    v_add_f32 v9, v9, v15
    s_waitcnt vmcnt(4)
    v_lshlrev_b32 v14, 16, v60
    v_and_b32 v15, 0xffff0000, v60
    v_add_f32 v6, v6, v14
    v_add_f32 v7, v7, v15
    v_lshlrev_b32 v14, 16, v61
    v_and_b32 v15, 0xffff0000, v61
    v_add_f32 v8, v8, v14
    v_add_f32 v9, v9, v15
    s_waitcnt vmcnt(3)
    v_lshlrev_b32 v14, 16, v64
    v_and_b32 v15, 0xffff0000, v64
    v_add_f32 v6, v6, v14
    v_add_f32 v7, v7, v15
    v_lshlrev_b32 v14, 16, v65
    v_and_b32 v15, 0xffff0000, v65
    v_add_f32 v8, v8, v14
    v_add_f32 v9, v9, v15
    s_waitcnt vmcnt(2)
    v_lshlrev_b32 v14, 16, v68
    v_and_b32 v15, 0xffff0000, v68
    v_add_f32 v6, v6, v14
    v_add_f32 v7, v7, v15
    v_lshlrev_b32 v14, 16, v69
    v_and_b32 v15, 0xffff0000, v69
    v_add_f32 v8, v8, v14
    v_add_f32 v9, v9, v15
    s_waitcnt vmcnt(1)
    v_lshlrev_b32 v14, 16, v72
    v_and_b32 v15, 0xffff0000, v72
    v_add_f32 v6, v6, v14
    v_add_f32 v7, v7, v15
    v_lshlrev_b32 v14, 16, v73
    v_and_b32 v15, 0xffff0000, v73
    v_add_f32 v8, v8, v14
    v_add_f32 v9, v9, v15
    s_waitcnt vmcnt(0)
    v_lshlrev_b32 v14, 16, v76
    v_and_b32 v15, 0xffff0000, v76
    v_add_f32 v6, v6, v14
    v_add_f32 v7, v7, v15
    v_lshlrev_b32 v14, 16, v77
    v_and_b32 v15, 0xffff0000, v77
    v_add_f32 v8, v8, v14
    v_add_f32 v9, v9, v15
    v_cvt_pk_bf16_f32 v16, v6, v7
    v_cvt_pk_bf16_f32 v17, v8, v9
    buffer_store_dwordx2 v[16:17], v5, s[12:15], 0 offen
    s_endpgm
L_red_done:
    s_endpgm
.section .rodata,"a"
.p2align 6
.amdhsa_kernel gqa_main_kernel
  .amdhsa_next_free_vgpr 512
  .amdhsa_next_free_sgpr 102
  .amdhsa_accum_offset 256
  .amdhsa_group_segment_fixed_size 0
  .amdhsa_kernarg_size 64
  .amdhsa_user_sgpr_count 2
  .amdhsa_user_sgpr_kernarg_segment_ptr 1
  .amdhsa_system_sgpr_workgroup_id_x 1
.end_amdhsa_kernel
.text
.section .rodata,"a"
.p2align 6
.amdhsa_kernel gqa_reduce_kernel
  .amdhsa_next_free_vgpr 80
  .amdhsa_next_free_sgpr 56
  .amdhsa_accum_offset 80
  .amdhsa_group_segment_fixed_size 0
  .amdhsa_kernarg_size 64
  .amdhsa_user_sgpr_count 2
  .amdhsa_user_sgpr_kernarg_segment_ptr 1
  .amdhsa_system_sgpr_workgroup_id_x 1
.end_amdhsa_kernel
.text
```
